```python
import torch

def _softmax(x, axis=-1):
    return torch.softmax(x, dim=axis)

def _gelu(x):
    return torch.nn.functional.gelu(x, approximate='tanh')

def _silu(x):
    return torch.nn.functional.silu(x)

def _sigmoid(x):
    return torch.sigmoid(x)

def _layernorm(x, axis=-1, eps=1e-05):
    m = x.mean(dim=axis, keepdim=True)
    v = x.var(dim=axis, keepdim=True, unbiased=False)
    return (x - m) / torch.sqrt(v + eps)

def _scatter_add(tgt, idx, src, axis=0):
    return tgt.clone().index_add_(axis, idx, src)

def _segment_sum(src, seg, n):
    out = torch.zeros((n,) + src.shape[1:], dtype=src.dtype)
    return out.index_add_(0, seg, src)

def _pad(x, pw):
    flat = tuple((v for pair in reversed(pw) for v in pair))
    return torch.nn.functional.pad(x, flat)
kernel_name = 'adaLN_cond__gqa_block_cached__moe_arch_mod__prompt'

def setup_inputs():

    _w = lambda a: (lambda t: t.to(torch.bfloat16) if t.is_floating_point() else t)(torch.as_tensor(a))

    def _A_setup():
        B, Sq, D = (1, 2048, 512)
        Hq, Hkv, Sk, Dh = (32, 32, 2048, 128)
        assert Hq % Hkv == 0, (Hq, Hkv)
        return {'x': _w((lambda *s: torch.randn(*s, dtype=torch.bfloat16) * 0.1)(B, Sq, D)), 'k_cache': _w((lambda *s: torch.randn(*s, dtype=torch.bfloat16) * 0.8)(B, Hkv, Sk, Dh)), 'v_cache': _w((lambda *s: torch.randn(*s, dtype=torch.bfloat16) * 0.8)(B, Hkv, Sk, Dh)), 'wq': _w((lambda *s: torch.randn(*s, dtype=torch.bfloat16) * 0.8)(D, Hq * Dh) * D ** (-0.5)), 'wo': _w((lambda *s: torch.randn(*s, dtype=torch.bfloat16) * 0.8)(Hq * Dh, D) * (Hq * Dh) ** (-0.5))}
    _A_in = _A_setup()

    def _B_setup():
        B, S, D, F, C = (1, 2048, 512, 1376, 1)
        return {'x': _w((lambda *s: torch.randn(*s, dtype=torch.bfloat16) * 0.1)(B, S, D)), 'w_r': _w((lambda *s: torch.randn(*s, dtype=torch.bfloat16) * 3.2)(D)), 'w_gate': _w((lambda *s: torch.randn(*s, dtype=torch.bfloat16) * 0.2)(D, F)), 'w_up': _w((lambda *s: torch.randn(*s, dtype=torch.bfloat16) * 0.2)(D, F)), 'w_down': _w((lambda *s: torch.randn(*s, dtype=torch.bfloat16) * 0.2)(F, D))}
    _B_in = _B_setup()
    return {'A_x': _A_in['x'], 'A_k_cache': _A_in['k_cache'], 'A_v_cache': _A_in['v_cache'], 'A_wq': _A_in['wq'], 'A_wo': _A_in['wo'], 'B_x': _B_in['x'], 'B_w_r': _B_in['w_r'], 'B_w_gate': _B_in['w_gate'], 'B_w_up': _B_in['w_up'], 'B_w_down': _B_in['w_down'], 'c': _w((lambda *s: torch.randn(*s, dtype=torch.bfloat16) * 0.2)(1, 512) * 8.0), 'w_mod': _w((lambda *s: torch.randn(*s, dtype=torch.bfloat16) * 0.2)(512, 6 * 512) * 512 ** (-0.5) * 8.0)}

def reference(A_x, A_k_cache, A_v_cache, A_wq, A_wo, B_x, B_w_r, B_w_gate, B_w_up, B_w_down, c, w_mod):

    def _A_ref(x, k_cache, v_cache, wq, wo):
        B, Sq, D = x.shape
        Hq, Dh = (32, 128)
        Hkv = k_cache.shape[1]
        rep = Hq // Hkv
        q = (lambda x, *d: x.permute(*d))((x @ wq).reshape(B, Sq, Hq, Dh), 0, 2, 1, 3)
        k = (lambda x, n, axis: torch.repeat_interleave(x, n, dim=axis))(k_cache, rep, axis=1)
        v = (lambda x, n, axis: torch.repeat_interleave(x, n, dim=axis))(v_cache, rep, axis=1)
        scores = torch.einsum('bhqd,bhkd->bhqk', q, k) * Dh ** (-0.5)
        p = _softmax(scores, axis=-1)
        o = torch.einsum('bhqk,bhkd->bhqd', p, v)
        return (lambda x, *d: x.permute(*d))(o, 0, 2, 1, 3).reshape(B, Sq, Hq * Dh) @ wo

    def _B_ref(x, w_r, w_gate, w_up, w_down):
        B, S, D = x.shape
        C = 1
        r = x @ w_r
        idx = torch.argsort(-r, axis=-1)[:, :C]
        idx_e = (lambda x, n, axis: torch.repeat_interleave(x, n, dim=axis))(idx.reshape(B, C, 1), D, axis=2)
        x_sel = (lambda x, i, axis: torch.take_along_dim(x, i, dim=axis))(x, idx_e, axis=1)
        g = _silu(x_sel @ w_gate)
        u = x_sel @ w_up
        y = g * u @ w_down
        r_sel = _sigmoid((lambda x, i, axis: torch.take_along_dim(x, i, dim=axis))(r, idx, axis=1))
        y = y * r_sel.reshape(B, C, 1)
        b_off = (torch.arange(B) * S).reshape(B, 1)
        flat_idx = (idx + b_off).reshape(B * C)
        zero = (x * 0.0).reshape(B * S, D)
        upd = _scatter_add(zero, flat_idx, y.reshape(B * C, D), axis=0)
        return x + upd.reshape(B, S, D)
    x = A_x
    mod = (_silu(c) @ w_mod).reshape(c.shape[0], 6, 1, -1)
    sa, ca, ga, sb, cb, gb = (mod[:, 0].clone(), mod[:, 1].clone(), mod[:, 2].clone(), mod[:, 3].clone(), mod[:, 4].clone(), mod[:, 5].clone())
    h = _layernorm(x, axis=-1) * (1 + ca) + sa
    x = x + ga * _A_ref(h, A_k_cache, A_v_cache, A_wq, A_wo)
    h = _layernorm(x, axis=-1) * (1 + cb) + sb
    x = x + gb * _B_ref(h, B_w_r, B_w_gate, B_w_up, B_w_down)
    return x
```

```asm
; @launch grid=(256,1,1) block=(256,1,1) lds=156672
.amdgcn_target "amdgcn-amd-amdhsa--gfx950"
.text
.globl adaLN_cond__gqa_block_cached__moe_arch_mod__prompt_kernel
.p2align 8
.type adaLN_cond__gqa_block_cached__moe_arch_mod__prompt_kernel,@function
adaLN_cond__gqa_block_cached__moe_arch_mod__prompt_kernel:
  s_cmp_ge_u32 s2, 256
  s_cbranch_scc1 L_attn_done
  s_mov_b32 s28, 0
L_attn_start:
  s_load_dwordx4 s[60:63], s[0:1], 80
  s_load_dwordx2 s[16:17], s[0:1], 112
  s_load_dwordx2 s[64:65], s[0:1], 0
  s_load_dwordx4 s[36:39], s[0:1], 24
  s_load_dwordx8 s[40:47], s[0:1], 48
  s_load_dwordx4 s[4:7], s[0:1], 8
  v_lshrrev_b32 v44, 3, v0
  v_and_b32 v45, 7, v0
  v_lshrrev_b32 v24, 6, v0
  v_mul_u32_u24 v46, 24576, v44
  v_lshl_add_u32 v46, v45, 4, v46
  v_lshlrev_b32 v47, 3, v44
  v_readfirstlane_b32 s20, v24
  s_and_b32 s8, s2, 3
  s_lshr_b32 s9, s2, 2
  s_mul_i32 s10, s8, 786432
  s_lshl_b32 s11, s9, 7
  s_add_u32 s10, s10, s11
  s_cmp_lt_u32 s2, 192
  s_cselect_b32 s10, s10, 0x7f000000
  s_lshl_b32 s11, s8, 8
  s_and_b32 s72, s2, 7
  s_xor_b32 s72, s72, 4
  s_lshl_b32 s72, s72, 5
  s_lshr_b32 s34, s2, 3
  s_add_u32 s72, s72, s34
  v_and_b32 v0, 63, v0
  v_and_b32 v44, 7, v44
  v_lshlrev_b32 v48, 4, v44
  v_lshl_add_u32 v48, v45, 10, v48
  s_lshl_b32 s34, s72, 13
  s_lshl_b32 s35, s20, 8
  s_add_u32 s34, s34, s35
  s_waitcnt lgkmcnt(0)
  s_add_u32 s48, s16, 2203648
  s_addc_u32 s49, s17, 0
  s_mov_b32 s68, s62
  s_mov_b32 s69, s63
  s_mov_b32 s70, 3145728
  s_mov_b32 s71, 0x20000
  s_mov_b32 s62, 1024
  s_mov_b32 s63, 0x20000
  s_load_dword s30, s[48:49], 0
  buffer_load_dwordx4 v[64:67], v46, s[68:71], s10 offen
  buffer_load_dwordx2 v[80:81], v47, s[60:63], s11 offen
  s_add_u32 s10, s10, 6144
  buffer_load_dwordx4 v[68:71], v46, s[68:71], s10 offen
  s_add_u32 s10, s10, 6144
  buffer_load_dwordx4 v[72:75], v46, s[68:71], s10 offen
  s_add_u32 s10, s10, 6144
  buffer_load_dwordx4 v[76:79], v46, s[68:71], s10 offen
  s_mov_b32 s66, 2097152
  s_mov_b32 s67, 0x20000
  buffer_load_dwordx4 v[100:103], v48, s[64:67], s34 offen offset:0
  buffer_load_dwordx4 v[104:107], v48, s[64:67], s34 offen offset:128
  s_mov_b32 s18, 30408704
  s_mov_b32 s19, 0x20000
  s_and_b32 s34, s2, 7
  s_lshr_b32 s35, s2, 3
  s_and_b32 s22, s34, 4
  s_lshr_b32 s21, s35, 3
  s_add_u32 s22, s22, s21
  s_and_b32 s21, s35, 7
  s_and_b32 s34, s34, 3
  s_lshl_b32 s34, s34, 3
  s_add_u32 s21, s21, s34
  v_and_b32 v25, 15, v0
  v_lshrrev_b32 v26, 4, v0
  v_lshrrev_b32 v27, 2, v25
  v_and_b32 v28, 3, v0
  v_lshlrev_b32 v0, 4, v0
  s_lshl_b32 s26, s20, 12
  v_lshlrev_b32 v29, 2, v26
  v_xor_b32 v29, v25, v29
  v_lshlrev_b32 v29, 4, v29
  v_lshl_add_u32 v31, v24, 4, v26
  v_lshl_add_u32 v40, v31, 13, v29
  v_add_u32 v41, 31744, v40
  v_add_u32 v42, 63488, v40
  v_add_u32 v43, 95232, v40
  s_getpc_b64 s[60:61]
L_pc1:
  s_add_u32 s60, s60, adaLN_cond__gqa_block_cached__moe_arch_mod__prompt_kernel-L_pc1
  s_addc_u32 s61, s61, (adaLN_cond__gqa_block_cached__moe_arch_mod__prompt_kernel-L_pc1)>>32
  s_mov_b32 s62, L_attn_codeend-adaLN_cond__gqa_block_cached__moe_arch_mod__prompt_kernel
  s_mov_b32 s63, 0x20000
  s_lshr_b32 s34, s2, 3
  s_lshl_b32 s34, s34, 2
  s_add_u32 s34, s34, s20
  s_lshl_b32 s34, s34, 7
  v_lshlrev_b32 v57, 10, v0
  buffer_load_dword v56, v57, s[60:63], s34 offen
  s_lshl_b32 s34, s21, 8
  s_mov_b32 s27, 0
  s_add_u32 s12, s36, s34
  s_addc_u32 s13, s37, 0
  s_mov_b32 s14, 4186368
  s_mov_b32 s15, 0x20000
  s_mul_i32 s10, s8, 24576
  s_lshl_b32 s11, s9, 9
  s_add_u32 s10, s10, s11
  s_add_u32 s10, s10, 2097152
  s_lshl_b32 s11, s20, 8
  v_lshlrev_b32 v49, 5, v45
  v_lshl_add_u32 v49, v26, 3, v49
  v_add_u32 v49, s11, v49
  s_waitcnt vmcnt(6)
  v_lshlrev_b32 v82, 16, v80
  v_and_b32 v83, 0xffff0000, v80
  v_lshlrev_b32 v84, 16, v81
  v_and_b32 v85, 0xffff0000, v81
  v_mul_f32 v88, 0xbfb8aa3b, v82
  v_mul_f32 v89, 0xbfb8aa3b, v83
  v_mul_f32 v90, 0xbfb8aa3b, v84
  v_mul_f32 v91, 0xbfb8aa3b, v85
  v_exp_f32 v88, v88
  v_exp_f32 v89, v89
  v_exp_f32 v90, v90
  v_exp_f32 v91, v91
  v_add_f32 v88, 1.0, v88
  v_add_f32 v89, 1.0, v89
  v_add_f32 v90, 1.0, v90
  v_add_f32 v91, 1.0, v91
  v_rcp_f32 v88, v88
  v_rcp_f32 v89, v89
  v_rcp_f32 v90, v90
  v_rcp_f32 v91, v91
  v_mul_f32 v82, v82, v88
  v_mul_f32 v83, v83, v89
  v_mul_f32 v84, v84, v90
  v_mul_f32 v85, v85, v91
  v_cvt_pk_bf16_f32 v80, v82, v83
  v_cvt_pk_bf16_f32 v81, v84, v85
  v_lshlrev_b32 v82, 16, v80
  v_and_b32 v83, 0xffff0000, v80
  v_lshlrev_b32 v84, 16, v81
  v_and_b32 v85, 0xffff0000, v81
  v_lshlrev_b32 v96, 16, v64
  v_and_b32 v97, 0xffff0000, v64
  v_pk_mul_f32 v[88:89], v[96:97], v[82:83] op_sel:[0,0] op_sel_hi:[1,0]
  v_lshlrev_b32 v98, 16, v65
  v_and_b32 v99, 0xffff0000, v65
  v_pk_mul_f32 v[90:91], v[98:99], v[82:83] op_sel:[0,0] op_sel_hi:[1,0]
  v_lshlrev_b32 v96, 16, v66
  v_and_b32 v97, 0xffff0000, v66
  v_pk_mul_f32 v[92:93], v[96:97], v[82:83] op_sel:[0,0] op_sel_hi:[1,0]
  v_lshlrev_b32 v98, 16, v67
  v_and_b32 v99, 0xffff0000, v67
  v_pk_mul_f32 v[94:95], v[98:99], v[82:83] op_sel:[0,0] op_sel_hi:[1,0]
  s_waitcnt vmcnt(5)
  v_lshlrev_b32 v96, 16, v68
  v_and_b32 v97, 0xffff0000, v68
  v_pk_fma_f32 v[88:89], v[96:97], v[82:83], v[88:89] op_sel:[0,1,0] op_sel_hi:[1,1,1]
  v_lshlrev_b32 v98, 16, v69
  v_and_b32 v99, 0xffff0000, v69
  v_pk_fma_f32 v[90:91], v[98:99], v[82:83], v[90:91] op_sel:[0,1,0] op_sel_hi:[1,1,1]
  v_lshlrev_b32 v96, 16, v70
  v_and_b32 v97, 0xffff0000, v70
  v_pk_fma_f32 v[92:93], v[96:97], v[82:83], v[92:93] op_sel:[0,1,0] op_sel_hi:[1,1,1]
  v_lshlrev_b32 v98, 16, v71
  v_and_b32 v99, 0xffff0000, v71
  v_pk_fma_f32 v[94:95], v[98:99], v[82:83], v[94:95] op_sel:[0,1,0] op_sel_hi:[1,1,1]
  s_waitcnt vmcnt(4)
  v_lshlrev_b32 v96, 16, v72
  v_and_b32 v97, 0xffff0000, v72
  v_pk_fma_f32 v[88:89], v[96:97], v[84:85], v[88:89] op_sel:[0,0,0] op_sel_hi:[1,0,1]
  v_lshlrev_b32 v98, 16, v73
  v_and_b32 v99, 0xffff0000, v73
  v_pk_fma_f32 v[90:91], v[98:99], v[84:85], v[90:91] op_sel:[0,0,0] op_sel_hi:[1,0,1]
  v_lshlrev_b32 v96, 16, v74
  v_and_b32 v97, 0xffff0000, v74
  v_pk_fma_f32 v[92:93], v[96:97], v[84:85], v[92:93] op_sel:[0,0,0] op_sel_hi:[1,0,1]
  v_lshlrev_b32 v98, 16, v75
  v_and_b32 v99, 0xffff0000, v75
  v_pk_fma_f32 v[94:95], v[98:99], v[84:85], v[94:95] op_sel:[0,0,0] op_sel_hi:[1,0,1]
  s_waitcnt vmcnt(3)
  v_lshlrev_b32 v96, 16, v76
  v_and_b32 v97, 0xffff0000, v76
  v_pk_fma_f32 v[88:89], v[96:97], v[84:85], v[88:89] op_sel:[0,1,0] op_sel_hi:[1,1,1]
  v_lshlrev_b32 v98, 16, v77
  v_and_b32 v99, 0xffff0000, v77
  v_pk_fma_f32 v[90:91], v[98:99], v[84:85], v[90:91] op_sel:[0,1,0] op_sel_hi:[1,1,1]
  v_lshlrev_b32 v96, 16, v78
  v_and_b32 v97, 0xffff0000, v78
  v_pk_fma_f32 v[92:93], v[96:97], v[84:85], v[92:93] op_sel:[0,1,0] op_sel_hi:[1,1,1]
  v_lshlrev_b32 v98, 16, v79
  v_and_b32 v99, 0xffff0000, v79
  v_pk_fma_f32 v[94:95], v[98:99], v[84:85], v[94:95] op_sel:[0,1,0] op_sel_hi:[1,1,1]
  s_nop 0
  v_permlane32_swap_b32 v88, v92
  v_permlane32_swap_b32 v89, v93
  v_permlane32_swap_b32 v90, v94
  v_permlane32_swap_b32 v91, v95
  v_add_f32 v88, v88, v92
  v_add_f32 v89, v89, v93
  v_add_f32 v90, v90, v94
  v_add_f32 v91, v91, v95
  s_nop 0
  v_permlane16_swap_b32 v88, v90
  v_permlane16_swap_b32 v89, v91
  v_add_f32 v88, v88, v90
  v_add_f32 v89, v89, v91
  s_nop 0
  v_add_f32_dpp v88, v88, v88 row_ror:8 row_mask:0xf bank_mask:0xf
  v_add_f32_dpp v89, v89, v89 row_ror:8 row_mask:0xf bank_mask:0xf
  ds_write_b64 v49, v[88:89]
  v_lshrrev_b32 v50, 2, v0
  v_lshrrev_b32 v51, 1, v0
  s_waitcnt lgkmcnt(0)
  s_barrier
  s_add_u32 s30, s30, 1
  s_mul_i32 s29, s30, 0x9e3779b1
  s_or_b32 s29, s29, 1
  s_cmp_lg_u32 s20, 0
  s_cbranch_scc1 L_st_np
  s_cmp_ge_u32 s2, 192
  s_cbranch_scc1 L_st_np
  ds_read2st64_b32 v[88:89], v50 offset0:0 offset1:1
  ds_read2st64_b32 v[90:91], v50 offset0:2 offset1:3
  s_waitcnt lgkmcnt(0)
  v_add_f32 v88, v88, v89
  v_add_f32 v90, v90, v91
  v_add_f32 v88, v88, v90
  v_xor_b32 v89, s29, v88
  buffer_store_dwordx2 v[88:89], v51, s[16:19], s10 offen sc1
L_st_np:
  s_add_u32 m0, s26, 16384
  s_nop 0
  buffer_load_dwordx4 v40, s[12:15], s27 offen offset:0 lds
  buffer_load_dwordx4 v41, s[12:15], s27 offen offset:1024 lds
  buffer_load_dwordx4 v42, s[12:15], s27 offen offset:2048 lds
  buffer_load_dwordx4 v43, s[12:15], s27 offen offset:3072 lds
  s_add_u32 s27, s27, 524288
  s_add_u32 m0, s26, 65536
  s_nop 0
  buffer_load_dwordx4 v40, s[12:15], s27 offen offset:0 lds
  buffer_load_dwordx4 v41, s[12:15], s27 offen offset:1024 lds
  buffer_load_dwordx4 v42, s[12:15], s27 offen offset:2048 lds
  buffer_load_dwordx4 v43, s[12:15], s27 offen offset:3072 lds
  s_add_u32 s27, s27, 524288
  s_add_u32 m0, s26, 32768
  s_nop 0
  buffer_load_dwordx4 v40, s[12:15], s27 offen offset:0 lds
  buffer_load_dwordx4 v41, s[12:15], s27 offen offset:1024 lds
  buffer_load_dwordx4 v42, s[12:15], s27 offen offset:2048 lds
  buffer_load_dwordx4 v43, s[12:15], s27 offen offset:3072 lds
  s_add_u32 s27, s27, 524288
  s_waitcnt vmcnt(13)
  v_lshlrev_b32 v112, 16, v100
  v_and_b32 v113, 0xffff0000, v100
  v_lshlrev_b32 v114, 16, v101
  v_and_b32 v115, 0xffff0000, v101
  v_lshlrev_b32 v116, 16, v102
  v_and_b32 v117, 0xffff0000, v102
  v_lshlrev_b32 v118, 16, v103
  v_and_b32 v119, 0xffff0000, v103
  v_lshlrev_b32 v120, 16, v104
  v_and_b32 v121, 0xffff0000, v104
  v_lshlrev_b32 v122, 16, v105
  v_and_b32 v123, 0xffff0000, v105
  v_lshlrev_b32 v124, 16, v106
  v_and_b32 v125, 0xffff0000, v106
  v_lshlrev_b32 v126, 16, v107
  v_and_b32 v127, 0xffff0000, v107
  v_pk_add_f32 v[64:65], v[112:113], v[114:115]
  v_pk_add_f32 v[66:67], v[116:117], v[118:119]
  v_pk_add_f32 v[64:65], v[64:65], v[120:121]
  v_pk_add_f32 v[66:67], v[66:67], v[122:123]
  v_pk_add_f32 v[64:65], v[64:65], v[124:125]
  v_pk_add_f32 v[66:67], v[66:67], v[126:127]
  v_pk_add_f32 v[64:65], v[64:65], v[66:67]
  v_add_f32 v64, v64, v65
  s_nop 0
  s_nop 1
  v_add_f32_dpp v64, v64, v64 row_ror:8 row_mask:0xf bank_mask:0xf
  v_mov_b32 v66, v64
  s_nop 1
  v_permlane16_swap_b32 v66, v64
  v_add_f32 v64, v64, v66
  v_mov_b32 v66, v64
  s_nop 1
  v_permlane32_swap_b32 v66, v64
  v_add_f32 v64, v64, v66
  v_mul_f32 v66, 0xbc000000, v64
  v_pk_add_f32 v[72:73], v[112:113], v[66:67] op_sel_hi:[1,0]
  v_pk_add_f32 v[74:75], v[114:115], v[66:67] op_sel_hi:[1,0]
  v_pk_add_f32 v[76:77], v[116:117], v[66:67] op_sel_hi:[1,0]
  v_pk_add_f32 v[78:79], v[118:119], v[66:67] op_sel_hi:[1,0]
  v_pk_add_f32 v[80:81], v[120:121], v[66:67] op_sel_hi:[1,0]
  v_pk_add_f32 v[82:83], v[122:123], v[66:67] op_sel_hi:[1,0]
  v_pk_add_f32 v[84:85], v[124:125], v[66:67] op_sel_hi:[1,0]
  v_pk_add_f32 v[86:87], v[126:127], v[66:67] op_sel_hi:[1,0]
  v_pk_mul_f32 v[68:69], v[72:73], v[72:73]
  v_pk_mul_f32 v[70:71], v[74:75], v[74:75]
  v_pk_fma_f32 v[68:69], v[76:77], v[76:77], v[68:69]
  v_pk_fma_f32 v[70:71], v[78:79], v[78:79], v[70:71]
  v_pk_fma_f32 v[68:69], v[80:81], v[80:81], v[68:69]
  v_pk_fma_f32 v[70:71], v[82:83], v[82:83], v[70:71]
  v_pk_fma_f32 v[68:69], v[84:85], v[84:85], v[68:69]
  v_pk_fma_f32 v[70:71], v[86:87], v[86:87], v[70:71]
  v_pk_add_f32 v[68:69], v[68:69], v[70:71]
  v_add_f32 v65, v68, v69
  s_lshl_b32 s11, s20, 6
  s_nop 1
  v_add_f32_dpp v65, v65, v65 row_ror:8 row_mask:0xf bank_mask:0xf
  v_mov_b32 v66, v65
  s_nop 1
  v_permlane16_swap_b32 v66, v65
  v_add_f32 v65, v65, v66
  v_mov_b32 v66, v65
  s_nop 1
  v_permlane32_swap_b32 v66, v65
  v_add_f32 v65, v65, v66
  v_lshlrev_b32 v49, 3, v45
  v_add_u32 v50, s11, v49
  ds_write_b64 v50, v[64:65] offset:1024
  s_lshl_b32 s34, s21, 19
  s_add_u32 s8, s6, s34
  s_addc_u32 s9, s7, 0
  s_mov_b32 s10, 524288
  s_mov_b32 s11, 0x20000
  s_add_u32 s4, s4, s34
  s_addc_u32 s5, s5, 0
  s_mov_b32 s6, 524288
  s_mov_b32 s7, 0x20000
  s_mov_b32 s24, 0
  s_mov_b32 s25, 0
  s_waitcnt lgkmcnt(0)
  s_barrier
  ds_read_b64 v[64:65], v49 offset:1024
  ds_read_b64 v[66:67], v49 offset:1088
  ds_read_b64 v[68:69], v49 offset:1152
  ds_read_b64 v[70:71], v49 offset:1216
  s_lshl_b32 s34, s20, 10
  v_add_u32 v50, s34, v51
  v_lshl_add_u32 v51, v44, 5, s34
  s_add_u32 s60, s34, 2097152
  s_add_u32 s61, s34, 2121728
  s_add_u32 s62, s34, 2146304
  s_add_u32 s63, s34, 2170880
  v_add_u32 v55, 4096, v0
  v_lshrrev_b32 v52, 2, v44
  v_and_b32 v53, 3, v44
  v_lshlrev_b32 v54, 4, v45
  v_lshl_add_u32 v54, v53, 8, v54
  v_lshl_add_u32 v54, v52, 12, v54
  s_lshr_b32 s68, s72, 3
  s_lshl_b32 s68, s68, 16
  s_bfe_u32 s69, s72, 0x20001
  s_lshl_b32 s69, s69, 10
  s_add_u32 s68, s68, s69
  s_and_b32 s69, s72, 1
  s_lshl_b32 s69, s69, 7
  s_add_u32 s68, s68, s69
  s_lshl_b32 s69, s20, 14
  s_add_u32 s68, s68, s69
  s_add_u32 s69, s68, 8192
  s_lshl_b32 s70, s72, 2
  s_add_u32 s70, s70, s20
  s_lshl_b32 s70, s70, 7
  s_add_u32 s70, s70, 2228224
  s_waitcnt lgkmcnt(0)
  v_pk_add_f32 v[72:73], v[64:65], v[66:67]
  v_pk_add_f32 v[74:75], v[68:69], v[70:71]
  v_pk_add_f32 v[72:73], v[72:73], v[74:75]
  v_mul_f32 v72, 0xbb000000, v72
  s_mov_b32 s34, 0x3c000000
  v_fma_f32 v64, v64, s34, v72
  v_fma_f32 v66, v66, s34, v72
  v_fma_f32 v68, v68, s34, v72
  v_fma_f32 v70, v70, s34, v72
  v_mul_f32 v74, v64, v64
  v_fmac_f32 v74, v66, v66
  v_fmac_f32 v74, v68, v68
  v_fmac_f32 v74, v70, v70
  v_fmac_f32 v73, 0x43000000, v74
  v_mov_b32 v74, 0x3727c5ac
  v_fmac_f32 v74, 0x3b000000, v73
  v_rsq_f32 v74, v74
  v_pk_add_f32 v[112:113], v[112:113], v[72:73] op_sel_hi:[1,0]
  v_pk_add_f32 v[114:115], v[114:115], v[72:73] op_sel_hi:[1,0]
  v_pk_add_f32 v[116:117], v[116:117], v[72:73] op_sel_hi:[1,0]
  v_pk_add_f32 v[118:119], v[118:119], v[72:73] op_sel_hi:[1,0]
  v_pk_add_f32 v[120:121], v[120:121], v[72:73] op_sel_hi:[1,0]
  v_pk_add_f32 v[122:123], v[122:123], v[72:73] op_sel_hi:[1,0]
  v_pk_add_f32 v[124:125], v[124:125], v[72:73] op_sel_hi:[1,0]
  v_pk_add_f32 v[126:127], v[126:127], v[72:73] op_sel_hi:[1,0]
  v_pk_mul_f32 v[112:113], v[112:113], v[74:75] op_sel_hi:[1,0]
  v_pk_mul_f32 v[114:115], v[114:115], v[74:75] op_sel_hi:[1,0]
  v_pk_mul_f32 v[116:117], v[116:117], v[74:75] op_sel_hi:[1,0]
  v_pk_mul_f32 v[118:119], v[118:119], v[74:75] op_sel_hi:[1,0]
  v_pk_mul_f32 v[120:121], v[120:121], v[74:75] op_sel_hi:[1,0]
  v_pk_mul_f32 v[122:123], v[122:123], v[74:75] op_sel_hi:[1,0]
  v_pk_mul_f32 v[124:125], v[124:125], v[74:75] op_sel_hi:[1,0]
  v_pk_mul_f32 v[126:127], v[126:127], v[74:75] op_sel_hi:[1,0]
  s_mov_b32 s34, 0
L_st_p1:
  buffer_load_dwordx4 v[128:131], v0, s[16:19], s60 offen sc1
  buffer_load_dwordx4 v[132:135], v0, s[16:19], s61 offen sc1
  buffer_load_dwordx4 v[136:139], v0, s[16:19], s62 offen sc1
  buffer_load_dwordx4 v[140:143], v0, s[16:19], s63 offen sc1
  buffer_load_dwordx4 v[144:147], v55, s[16:19], s60 offen sc1
  buffer_load_dwordx4 v[148:151], v55, s[16:19], s61 offen sc1
  buffer_load_dwordx4 v[152:155], v55, s[16:19], s62 offen sc1
  buffer_load_dwordx4 v[156:159], v55, s[16:19], s63 offen sc1
  s_add_u32 s34, s34, 1
  s_waitcnt vmcnt(0)
  v_bitop3_b32 v65, v128, v129, s29 bitop3:0x96
  v_bitop3_b32 v66, v130, v131, s29 bitop3:0x96
  v_or_b32 v64, v65, v66
  v_bitop3_b32 v65, v132, v133, s29 bitop3:0x96
  v_bitop3_b32 v66, v134, v135, s29 bitop3:0x96
  v_or3_b32 v64, v64, v65, v66
  v_bitop3_b32 v65, v136, v137, s29 bitop3:0x96
  v_bitop3_b32 v66, v138, v139, s29 bitop3:0x96
  v_or3_b32 v64, v64, v65, v66
  v_bitop3_b32 v65, v140, v141, s29 bitop3:0x96
  v_bitop3_b32 v66, v142, v143, s29 bitop3:0x96
  v_or3_b32 v64, v64, v65, v66
  v_bitop3_b32 v65, v144, v145, s29 bitop3:0x96
  v_bitop3_b32 v66, v146, v147, s29 bitop3:0x96
  v_or3_b32 v64, v64, v65, v66
  v_bitop3_b32 v65, v148, v149, s29 bitop3:0x96
  v_bitop3_b32 v66, v150, v151, s29 bitop3:0x96
  v_or3_b32 v64, v64, v65, v66
  v_bitop3_b32 v65, v152, v153, s29 bitop3:0x96
  v_bitop3_b32 v66, v154, v155, s29 bitop3:0x96
  v_or3_b32 v64, v64, v65, v66
  v_bitop3_b32 v65, v156, v157, s29 bitop3:0x96
  v_bitop3_b32 v66, v158, v159, s29 bitop3:0x96
  v_or3_b32 v64, v64, v65, v66
  v_cmp_eq_u32 vcc, 0, v64
  s_andn2_b64 exec, exec, vcc
  s_cbranch_scc0 L_st_p1_ok
  s_cmp_lt_u32 s34, 400000
  s_cbranch_scc1 L_st_p1
L_st_p1_ok:
  s_mov_b64 exec, -1
  v_add_f32 v128, v128, v132
  v_add_f32 v136, v136, v140
  v_add_f32 v130, v130, v134
  v_add_f32 v138, v138, v142
  v_add_f32 v144, v144, v148
  v_add_f32 v152, v152, v156
  v_add_f32 v146, v146, v150
  v_add_f32 v154, v154, v158
  v_add_f32 v128, v128, v136
  v_add_f32 v130, v130, v138
  v_add_f32 v144, v144, v152
  v_add_f32 v146, v146, v154
  v_cvt_pk_bf16_f32 v64, v128, v130
  v_cvt_pk_bf16_f32 v65, v144, v146
  s_mov_b32 s34, 0x3e0293ee
  v_lshlrev_b32 v68, 16, v65
  v_and_b32 v69, 0xffff0000, v65
  v_lshlrev_b32 v66, 16, v64
  v_and_b32 v67, 0xffff0000, v64
  v_add_f32 v68, 1.0, v68
  v_add_f32 v69, 1.0, v69
  v_mul_f32 v66, s34, v66
  v_mul_f32 v67, s34, v67
  v_cvt_pk_bf16_f32 v65, v68, v69
  ds_write_b64 v50, v[66:67] offset:2048
  v_lshlrev_b32 v68, 16, v65
  v_and_b32 v69, 0xffff0000, v65
  v_mul_f32 v68, s34, v68
  v_mul_f32 v69, s34, v69
  ds_write_b64 v50, v[68:69] offset:2560
  ds_read_b128 v[128:131], v51 offset:2048
  ds_read_b128 v[132:135], v51 offset:2064
  ds_read_b128 v[144:147], v51 offset:2560
  ds_read_b128 v[148:151], v51 offset:2576
  ds_read_b128 v[136:139], v51 offset:2304
  ds_read_b128 v[140:143], v51 offset:2320
  ds_read_b128 v[152:155], v51 offset:2816
  ds_read_b128 v[156:159], v51 offset:2832
  v_mov_b32 v72, s29
  v_not_b32 v73, v72
  v_mov_b32 v74, 0
  v_mov_b32 v75, 0
  v_lshl_add_u32 v55, v44, 25, v0
  s_waitcnt lgkmcnt(4)
  v_pk_fma_f32 v[112:113], v[112:113], v[144:145], v[128:129]
  v_pk_fma_f32 v[114:115], v[114:115], v[146:147], v[130:131]
  v_pk_fma_f32 v[116:117], v[116:117], v[148:149], v[132:133]
  v_pk_fma_f32 v[118:119], v[118:119], v[150:151], v[134:135]
  v_cvt_pk_bf16_f32 v64, v112, v113
  v_cvt_pk_bf16_f32 v65, v114, v115
  v_cvt_pk_bf16_f32 v66, v116, v117
  v_cvt_pk_bf16_f32 v67, v118, v119
  buffer_store_dwordx4 v[64:67], v54, s[16:19], s68 offen sc1
  s_waitcnt lgkmcnt(0)
  v_pk_fma_f32 v[120:121], v[120:121], v[152:153], v[136:137]
  v_pk_fma_f32 v[122:123], v[122:123], v[154:155], v[138:139]
  v_pk_fma_f32 v[124:125], v[124:125], v[156:157], v[140:141]
  v_pk_fma_f32 v[126:127], v[126:127], v[158:159], v[142:143]
  v_cvt_pk_bf16_f32 v68, v120, v121
  v_cvt_pk_bf16_f32 v69, v122, v123
  v_cvt_pk_bf16_f32 v70, v124, v125
  v_cvt_pk_bf16_f32 v71, v126, v127
  buffer_store_dwordx4 v[68:71], v54, s[16:19], s69 offen sc1
  v_lshlrev_b32 v31, 8, v31
  v_xor_b32 v29, v25, v26
  v_xor_b32 v30, 0, v29
  v_lshl_add_u32 v13, v30, 4, v31
  v_xor_b32 v30, 4, v29
  v_lshl_add_u32 v14, v30, 4, v31
  v_xor_b32 v30, 8, v29
  v_lshl_add_u32 v15, v30, 4, v31
  v_xor_b32 v30, 12, v29
  v_lshl_add_u32 v16, v30, 4, v31
  v_lshlrev_b32 v30, 1, v26
  v_xor_b32 v30, v25, v30
  v_lshl_add_u32 v17, v30, 4, v31
  v_xor_b32 v30, 8, v30
  v_lshl_add_u32 v18, v30, 4, v31
  v_lshlrev_b32 v31, 8, v25
  v_xor_b32 v30, 0, v29
  v_lshl_add_u32 v1, v30, 4, v31
  v_xor_b32 v30, 4, v29
  v_lshl_add_u32 v2, v30, 4, v31
  v_xor_b32 v30, 8, v29
  v_lshl_add_u32 v3, v30, 4, v31
  v_xor_b32 v30, 12, v29
  v_lshl_add_u32 v4, v30, 4, v31
  v_lshl_add_u32 v31, v26, 3, v27
  v_lshlrev_b32 v31, 8, v31
  v_lshl_add_u32 v31, v28, 4, v31
  v_xor_b32 v30, 0, v27
  v_lshl_add_u32 v30, v30, 6, v31
  v_add_u32 v32, 16384, v30
  v_add_u32 v36, 81920, v30
  v_xor_b32 v30, 1, v27
  v_lshl_add_u32 v30, v30, 6, v31
  v_add_u32 v33, 16384, v30
  v_add_u32 v37, 81920, v30
  v_xor_b32 v30, 2, v27
  v_lshl_add_u32 v30, v30, 6, v31
  v_add_u32 v34, 16384, v30
  v_add_u32 v38, 81920, v30
  v_xor_b32 v30, 3, v27
  v_lshl_add_u32 v30, v30, 6, v31
  v_add_u32 v35, 16384, v30
  v_add_u32 v39, 81920, v30
  v_lshrrev_b32 v24, 6, v0
  v_lshlrev_b32 v31, 3, v28
  v_lshl_add_u32 v31, v24, 8, v31
  v_add_u32 v31, 65536, v31
  v_and_b32 v24, 7, v24
  v_xor_b32 v30, 0, v24
  v_lshl_add_u32 v5, v30, 5, v31
  v_xor_b32 v30, 1, v24
  v_lshl_add_u32 v6, v30, 5, v31
  v_xor_b32 v30, 2, v24
  v_lshl_add_u32 v7, v30, 5, v31
  v_xor_b32 v30, 3, v24
  v_lshl_add_u32 v8, v30, 5, v31
  v_xor_b32 v30, 4, v24
  v_lshl_add_u32 v9, v30, 5, v31
  v_xor_b32 v30, 5, v24
  v_lshl_add_u32 v10, v30, 5, v31
  v_xor_b32 v30, 6, v24
  v_lshl_add_u32 v11, v30, 5, v31
  v_xor_b32 v30, 7, v24
  v_lshl_add_u32 v12, v30, 5, v31
  v_bfe_u32 v30, v0, 7, 1
  v_and_b32 v19, 16, v0
  v_lshl_add_u32 v19, v30, 15, v19
  v_bfe_u32 v30, v0, 5, 2
  v_lshl_add_u32 v19, v30, 11, v19
  v_lshl_add_u32 v19, v26, 5, v19
  v_and_b32 v46, 3, v44
  v_mul_u32_u24 v46, 24576, v46
  v_lshl_add_u32 v46, v45, 3, v46
  s_lshl_b32 s71, s2, 6
  s_add_u32 s71, s71, 2105344
  s_waitcnt vmcnt(0)
  buffer_store_dwordx4 v[72:75], v55, s[16:19], s70 offen sc1
  s_barrier
  s_cmp_lg_u32 s20, 3
  s_cbranch_scc1 L_st_nf
  s_mov_b32 s34, 0
L_st_p2:
  buffer_load_dwordx2 v[64:65], v46, s[16:19], s71 offen sc1
  s_add_u32 s34, s34, 1
  s_waitcnt vmcnt(0)
  v_bitop3_b32 v67, v64, v65, s29 bitop3:0x96
  v_bitop3_b32 v68, v64, v65, s29 bitop3:0x96
  v_or_b32 v66, v67, v68
  v_cmp_eq_u32 vcc, 0, v66
  s_andn2_b64 exec, exec, vcc
  s_cbranch_scc0 L_st_p2_ok
  s_cmp_lt_u32 s34, 400000
  s_cbranch_scc1 L_st_p2
L_st_p2_ok:
  s_mov_b64 exec, -1
  s_nop 1
  v_add_f32_dpp v64, v64, v64 row_ror:8 row_mask:0xf bank_mask:0xf
  v_mov_b32 v65, v64
  s_nop 1
  v_permlane16_swap_b32 v65, v64
  v_add_f32 v64, v64, v65
  s_lshr_b32 s34, s2, 6
  s_cmp_eq_u32 s34, 2
  s_cselect_b32 s34, 1.0, 0
  s_lshr_b32 s35, s29, 16
  v_cvt_pk_bf16_f32 v64, v64, v64
  v_and_b32 v64, 0xffff0000, v64
  v_add_f32 v64, s34, v64
  v_cvt_pk_bf16_f32 v64, v64, v64
  v_and_b32 v64, 0xffff0000, v64
  v_or_b32 v64, s35, v64
  s_lshl_b32 s34, s2, 5
  s_add_u32 s34, s34, 2195456
  v_lshlrev_b32 v65, 2, v45
  v_lshl_add_u32 v65, v44, 25, v65
  buffer_store_dword v64, v65, s[16:19], s34 offen sc1
L_st_nf:
  v_cmp_eq_u32 vcc, 0, v28
  v_mov_b32 v30, 0x3f803f80
  s_nop 0
  v_cndmask_b32 v20, 0, v30, vcc
  v_cndmask_b32 v21, 0, v30, vcc
  v_cndmask_b32 v22, 0, v30, vcc
  v_cndmask_b32 v23, 0, v30, vcc
  s_and_b32 s56, s2, 7
  s_lshr_b32 s57, s2, 3
  s_mul_i32 s58, s56, 29
  s_add_u32 s58, s58, s57
  s_lshl_b32 s59, s56, 5
  s_add_u32 s59, s59, s57
  s_sub_u32 s59, s59, 192
  s_cmp_lt_u32 s58, 172
  s_cselect_b32 s31, 1, 0
  s_cmp_lt_u32 s57, 29
  s_cselect_b32 s31, s31, 0
  s_cmp_ge_u32 s56, 6
  s_cselect_b32 s31, 2, s31
  s_cselect_b32 s3, s59, s58
  s_mov_b64 s[68:69], s[64:65]
  v_lshrrev_b32 v30, 4, v0
  s_lshl_b32 s60, s3, 4
  s_cmp_eq_u32 s31, 2
  s_cbranch_scc1 L_fw_2
  s_cmp_lt_u32 s20, 2
  s_cselect_b32 s64, s42, s44
  s_cselect_b32 s65, s43, s45
  s_and_b32 s61, s20, 1
  s_lshl_b32 s61, s61, 6
  v_add_u32 v30, s61, v30
  v_mul_u32_u24 v30, 11008, v30
  s_add_u32 s62, s26, 132096
  s_mov_b32 s61, 2752
  s_cmp_eq_u32 s31, 1
  s_cselect_b32 s63, 0x1111, 0
  s_branch L_fw_e
L_fw_2:
  s_mov_b32 s64, s46
  s_mov_b32 s65, s47
  s_lshl_b32 s61, s20, 6
  v_add_u32 v30, s61, v30
  v_lshlrev_b32 v30, 13, v30
  s_lshl_b32 s62, s20, 13
  s_add_u32 s62, s62, 132096
  s_mov_b32 s61, 1024
  s_cmp_lt_u32 s20, 3
  s_cselect_b32 s63, 0x249249, 0
L_fw_e:
  s_lshl_b32 s63, s63, s20
  s_mov_b32 s66, 1409024
  s_mov_b32 s67, 0x20000
  s_mov_b64 s[42:43], s[68:69]
  s_lshl_b32 s48, s22, 2
  s_add_u32 s48, s48, s20
  s_lshl_b32 s32, s48, 16
  s_lshl_b32 s68, s48, 12
  s_add_u32 s68, s68, 2228224
  s_lshl_b32 s58, s22, 3
  s_and_b32 s34, s21, 4
  s_add_u32 s58, s58, s34
  s_add_u32 s58, s58, s20
  s_lshr_b32 s59, s21, 3
  s_lshl_b32 s56, s58, 17
  s_lshl_b32 s34, s59, 13
  s_add_u32 s56, s56, s34
  s_and_b32 s34, s21, 3
  s_lshl_b32 s34, s34, 8
  s_add_u32 s56, s56, s34
  s_add_u32 s56, s56, 20971520
  s_add_u32 s57, s56, 65536
  s_lshr_b32 s58, s58, 1
  s_lshl_b32 s58, s58, 2
  s_add_u32 s58, s58, s59
  s_lshl_b32 s54, s58, 10
  s_add_u32 s54, s54, 2359296
  s_lshl_b32 s55, s58, 17
  s_and_b32 s34, s20, 1
  s_lshl_b32 s34, s34, 11
  s_add_u32 s55, s55, s34
  s_add_u32 s55, s55, 4194304
  s_lshl_b32 s48, s48, 5
  s_add_u32 s48, s48, s21
  s_lshl_b32 s53, s48, 7
  s_add_u32 s53, s53, 2359296
  s_lshl_b32 s48, s48, 14
  s_add_u32 s48, s48, 4194304
  s_add_u32 s49, s48, 4096
  s_add_u32 s50, s48, 8192
  s_add_u32 s51, s48, 12288
  ds_read_b64_tr_b16 a[192:193], v32 offset:0
  ds_read_b64_tr_b16 a[194:195], v32 offset:1024
  ds_read_b64_tr_b16 a[196:197], v32 offset:8192
  ds_read_b64_tr_b16 a[198:199], v32 offset:9216
  ds_read_b64_tr_b16 a[200:201], v32 offset:8
  ds_read_b64_tr_b16 a[202:203], v32 offset:1032
  ds_read_b64_tr_b16 a[204:205], v32 offset:8200
  ds_read_b64_tr_b16 a[206:207], v32 offset:9224
  ds_read_b64_tr_b16 a[208:209], v33 offset:0
  ds_read_b64_tr_b16 a[210:211], v33 offset:1024
  ds_read_b64_tr_b16 a[212:213], v33 offset:8192
  ds_read_b64_tr_b16 a[214:215], v33 offset:9216
  ds_read_b64_tr_b16 a[216:217], v33 offset:8
  ds_read_b64_tr_b16 a[218:219], v33 offset:1032
  ds_read_b64_tr_b16 a[220:221], v33 offset:8200
  ds_read_b64_tr_b16 a[222:223], v33 offset:9224
  v_lshlrev_b32 v46, 3, v0
  v_and_b32 v46, 0xf80, v46
  s_mov_b32 s34, 0
L_st_p3:
  buffer_load_dwordx2 v[64:65], v46, s[16:19], s68 offen sc1
  s_add_u32 s34, s34, 1
  s_waitcnt vmcnt(0)
  v_xor_b32 v66, s29, v64
  v_bitop3_b32 v66, v66, v65, s29 bitop3:0xf9
  v_cmp_eq_u32 vcc, 0, v66
  s_andn2_b64 exec, exec, vcc
  s_cbranch_scc0 L_st_p3_ok
  s_cmp_lt_u32 s34, 400000
  s_cbranch_scc1 L_st_p3
L_st_p3_ok:
  s_mov_b64 exec, -1
  s_add_u32 s33, s32, 0
  buffer_load_dwordx4 a[0:3], v0, s[16:19], s33 offen offset:0 sc1
  buffer_load_dwordx4 a[4:7], v0, s[16:19], s33 offen offset:1024 sc1
  buffer_load_dwordx4 a[8:11], v0, s[16:19], s33 offen offset:2048 sc1
  buffer_load_dwordx4 a[12:15], v0, s[16:19], s33 offen offset:3072 sc1
  s_add_u32 s33, s32, 4096
  buffer_load_dwordx4 a[16:19], v0, s[16:19], s33 offen offset:0 sc1
  buffer_load_dwordx4 a[20:23], v0, s[16:19], s33 offen offset:1024 sc1
  buffer_load_dwordx4 a[24:27], v0, s[16:19], s33 offen offset:2048 sc1
  buffer_load_dwordx4 a[28:31], v0, s[16:19], s33 offen offset:3072 sc1
  s_add_u32 s33, s32, 8192
  buffer_load_dwordx4 a[32:35], v0, s[16:19], s33 offen offset:0 sc1
  buffer_load_dwordx4 a[36:39], v0, s[16:19], s33 offen offset:1024 sc1
  buffer_load_dwordx4 a[40:43], v0, s[16:19], s33 offen offset:2048 sc1
  buffer_load_dwordx4 a[44:47], v0, s[16:19], s33 offen offset:3072 sc1
  s_waitcnt vmcnt(11) lgkmcnt(14)
  v_mfma_f32_16x16x32_bf16 v[64:67], a[192:195], a[0:3], 0
  s_waitcnt vmcnt(7) lgkmcnt(12)
  ds_read_b64_tr_b16 a[224:225], v34 offset:0
  v_mfma_f32_16x16x32_bf16 v[64:67], a[196:199], a[16:19], v[64:67]
  s_add_u32 s33, s32, 12288
  buffer_load_dwordx4 a[48:51], v0, s[16:19], s33 offen offset:0 sc1
  v_mfma_f32_16x16x32_bf16 v[68:71], a[192:195], a[4:7], 0
  s_waitcnt vmcnt(7)
  ds_read_b64_tr_b16 a[226:227], v34 offset:1024
  v_mfma_f32_16x16x32_bf16 v[68:71], a[196:199], a[20:23], v[68:71]
  v_mfma_f32_16x16x32_bf16 v[72:75], a[192:195], a[8:11], 0
  s_waitcnt vmcnt(6)
  ds_read_b64_tr_b16 a[228:229], v34 offset:8192
  v_mfma_f32_16x16x32_bf16 v[72:75], a[196:199], a[24:27], v[72:75]
  buffer_load_dwordx4 a[52:55], v0, s[16:19], s33 offen offset:1024 sc1
  v_mfma_f32_16x16x32_bf16 v[76:79], a[192:195], a[12:15], 0
  s_waitcnt vmcnt(6)
  ds_read_b64_tr_b16 a[230:231], v34 offset:9216
  v_mfma_f32_16x16x32_bf16 v[76:79], a[196:199], a[28:31], v[76:79]
  s_waitcnt lgkmcnt(14)
  v_mfma_f32_16x16x32_bf16 v[92:95], a[200:203], a[12:15], 0
  s_waitcnt lgkmcnt(12)
  ds_read_b64_tr_b16 a[232:233], v34 offset:8
  v_mfma_f32_16x16x32_bf16 v[92:95], a[204:207], a[28:31], v[92:95]
  v_mfma_f32_16x16x32_bf16 v[88:91], a[200:203], a[8:11], 0
  ds_read_b64_tr_b16 a[234:235], v34 offset:1032
  v_mfma_f32_16x16x32_bf16 v[88:91], a[204:207], a[24:27], v[88:91]
  buffer_load_dwordx4 a[56:59], v0, s[16:19], s33 offen offset:2048 sc1
  v_mfma_f32_16x16x32_bf16 v[84:87], a[200:203], a[4:7], 0
  ds_read_b64_tr_b16 a[236:237], v34 offset:8200
  v_mfma_f32_16x16x32_bf16 v[84:87], a[204:207], a[20:23], v[84:87]
  v_mfma_f32_16x16x32_bf16 v[80:83], a[200:203], a[0:3], 0
  ds_read_b64_tr_b16 a[238:239], v34 offset:9224
  v_mfma_f32_16x16x32_bf16 v[80:83], a[204:207], a[16:19], v[80:83]
  s_waitcnt lgkmcnt(14)
  buffer_load_dwordx4 a[60:63], v0, s[16:19], s33 offen offset:3072 sc1
  v_mfma_f32_16x16x32_bf16 v[96:99], a[208:211], a[0:3], 0
  s_waitcnt lgkmcnt(12)
  ds_read_b64_tr_b16 a[240:241], v35 offset:0
  v_mfma_f32_16x16x32_bf16 v[96:99], a[212:215], a[16:19], v[96:99]
  v_mfma_f32_16x16x32_bf16 v[100:103], a[208:211], a[4:7], 0
  ds_read_b64_tr_b16 a[242:243], v35 offset:1024
  v_mfma_f32_16x16x32_bf16 v[100:103], a[212:215], a[20:23], v[100:103]
  v_mfma_f32_16x16x32_bf16 v[104:107], a[208:211], a[8:11], 0
  ds_read_b64_tr_b16 a[244:245], v35 offset:8192
  v_mfma_f32_16x16x32_bf16 v[104:107], a[212:215], a[24:27], v[104:107]
  s_add_u32 s33, s32, 16384
  buffer_load_dwordx4 a[64:67], v0, s[16:19], s33 offen offset:0 sc1
  v_mfma_f32_16x16x32_bf16 v[108:111], a[208:211], a[12:15], 0
  ds_read_b64_tr_b16 a[246:247], v35 offset:9216
  v_mfma_f32_16x16x32_bf16 v[108:111], a[212:215], a[28:31], v[108:111]
  s_waitcnt lgkmcnt(14)
  v_mfma_f32_16x16x32_bf16 v[124:127], a[216:219], a[12:15], 0
  s_waitcnt lgkmcnt(12)
  s_add_u32 m0, s26, 81920
  ds_read_b64_tr_b16 a[248:249], v35 offset:8
  v_mfma_f32_16x16x32_bf16 v[124:127], a[220:223], a[28:31], v[124:127]
  buffer_load_dwordx4 v40, s[12:15], s27 offen offset:0 lds
  v_mfma_f32_16x16x32_bf16 v[120:123], a[216:219], a[8:11], 0
  ds_read_b64_tr_b16 a[250:251], v35 offset:1032
  v_mfma_f32_16x16x32_bf16 v[120:123], a[220:223], a[24:27], v[120:123]
  v_mfma_f32_16x16x32_bf16 v[116:119], a[216:219], a[4:7], 0
  ds_read_b64_tr_b16 a[252:253], v35 offset:8200
  v_mfma_f32_16x16x32_bf16 v[116:119], a[220:223], a[20:23], v[116:119]
  v_mfma_f32_16x16x32_bf16 v[112:115], a[216:219], a[0:3], 0
  ds_read_b64_tr_b16 a[254:255], v35 offset:9224
  v_mfma_f32_16x16x32_bf16 v[112:115], a[220:223], a[16:19], v[112:115]
  s_waitcnt lgkmcnt(14)
  buffer_load_dwordx4 v41, s[12:15], s27 offen offset:1024 lds
  v_mfma_f32_16x16x32_bf16 v[128:131], a[224:227], a[0:3], 0
  s_waitcnt lgkmcnt(12)
  ds_read_b64_tr_b16 a[192:193], v32 offset:49152
  v_mfma_f32_16x16x32_bf16 v[128:131], a[228:231], a[16:19], v[128:131]
  v_mfma_f32_16x16x32_bf16 v[132:135], a[224:227], a[4:7], 0
  ds_read_b64_tr_b16 a[194:195], v32 offset:50176
  v_mfma_f32_16x16x32_bf16 v[132:135], a[228:231], a[20:23], v[132:135]
  buffer_load_dwordx4 v42, s[12:15], s27 offen offset:2048 lds
  v_mfma_f32_16x16x32_bf16 v[136:139], a[224:227], a[8:11], 0
  ds_read_b64_tr_b16 a[196:197], v32 offset:57344
  v_mfma_f32_16x16x32_bf16 v[136:139], a[228:231], a[24:27], v[136:139]
  v_mfma_f32_16x16x32_bf16 v[140:143], a[224:227], a[12:15], 0
  ds_read_b64_tr_b16 a[198:199], v32 offset:58368
  v_mfma_f32_16x16x32_bf16 v[140:143], a[228:231], a[28:31], v[140:143]
  s_waitcnt lgkmcnt(14)
  v_mfma_f32_16x16x32_bf16 v[156:159], a[232:235], a[12:15], 0
  s_waitcnt lgkmcnt(12)
  ds_read_b64_tr_b16 a[200:201], v32 offset:49160
  v_mfma_f32_16x16x32_bf16 v[156:159], a[236:239], a[28:31], v[156:159]
  buffer_load_dwordx4 v43, s[12:15], s27 offen offset:3072 lds
  v_mfma_f32_16x16x32_bf16 v[152:155], a[232:235], a[8:11], 0
  s_add_u32 s27, s27, 524288
  ds_read_b64_tr_b16 a[202:203], v32 offset:50184
  v_mfma_f32_16x16x32_bf16 v[152:155], a[236:239], a[24:27], v[152:155]
  v_mfma_f32_16x16x32_bf16 v[148:151], a[232:235], a[4:7], 0
  ds_read_b64_tr_b16 a[204:205], v32 offset:57352
  v_mfma_f32_16x16x32_bf16 v[148:151], a[236:239], a[20:23], v[148:151]
  buffer_load_dwordx4 a[68:71], v0, s[16:19], s33 offen offset:1024 sc1
  v_mfma_f32_16x16x32_bf16 v[144:147], a[232:235], a[0:3], 0
  ds_read_b64_tr_b16 a[206:207], v32 offset:58376
  v_mfma_f32_16x16x32_bf16 v[144:147], a[236:239], a[16:19], v[144:147]
  s_waitcnt lgkmcnt(14)
  v_mfma_f32_16x16x32_bf16 v[160:163], a[240:243], a[0:3], 0
  s_waitcnt lgkmcnt(12)
  ds_read_b64_tr_b16 a[208:209], v33 offset:49152
  v_mfma_f32_16x16x32_bf16 v[160:163], a[244:247], a[16:19], v[160:163]
  v_mfma_f32_16x16x32_bf16 v[164:167], a[240:243], a[4:7], 0
  ds_read_b64_tr_b16 a[210:211], v33 offset:50176
  v_mfma_f32_16x16x32_bf16 v[164:167], a[244:247], a[20:23], v[164:167]
  buffer_load_dwordx4 a[72:75], v0, s[16:19], s33 offen offset:2048 sc1
  v_mfma_f32_16x16x32_bf16 v[168:171], a[240:243], a[8:11], 0
  ds_read_b64_tr_b16 a[212:213], v33 offset:57344
  v_mfma_f32_16x16x32_bf16 v[168:171], a[244:247], a[24:27], v[168:171]
  v_mfma_f32_16x16x32_bf16 v[172:175], a[240:243], a[12:15], 0
  ds_read_b64_tr_b16 a[214:215], v33 offset:58368
  v_mfma_f32_16x16x32_bf16 v[172:175], a[244:247], a[28:31], v[172:175]
  s_waitcnt lgkmcnt(14)
  buffer_load_dwordx4 a[76:79], v0, s[16:19], s33 offen offset:3072 sc1
  v_mfma_f32_16x16x32_bf16 v[188:191], a[248:251], a[12:15], 0
  s_waitcnt lgkmcnt(12)
  ds_read_b64_tr_b16 a[216:217], v33 offset:49160
  v_mfma_f32_16x16x32_bf16 v[188:191], a[252:255], a[28:31], v[188:191]
  v_mfma_f32_16x16x32_bf16 v[184:187], a[248:251], a[8:11], 0
  ds_read_b64_tr_b16 a[218:219], v33 offset:50184
  v_mfma_f32_16x16x32_bf16 v[184:187], a[252:255], a[24:27], v[184:187]
  v_mfma_f32_16x16x32_bf16 v[180:183], a[248:251], a[4:7], 0
  ds_read_b64_tr_b16 a[220:221], v33 offset:57352
  v_mfma_f32_16x16x32_bf16 v[180:183], a[252:255], a[20:23], v[180:183]
  s_add_u32 s33, s32, 20480
  buffer_load_dwordx4 a[80:83], v0, s[16:19], s33 offen offset:0 sc1
  v_mfma_f32_16x16x32_bf16 v[176:179], a[248:251], a[0:3], 0
  ds_read_b64_tr_b16 a[222:223], v33 offset:58376
  v_mfma_f32_16x16x32_bf16 v[176:179], a[252:255], a[16:19], v[176:179]
  s_waitcnt vmcnt(16) lgkmcnt(14)
  v_mfma_f32_16x16x32_bf16 v[64:67], a[192:195], a[32:35], v[64:67]
  s_waitcnt vmcnt(12) lgkmcnt(12)
  ds_read_b64_tr_b16 a[224:225], v34 offset:49152
  v_mfma_f32_16x16x32_bf16 v[64:67], a[196:199], a[48:51], v[64:67]
  buffer_load_dwordx4 a[84:87], v0, s[16:19], s33 offen offset:1024 sc1
  v_mfma_f32_16x16x32_bf16 v[68:71], a[192:195], a[36:39], v[68:71]
  s_waitcnt vmcnt(12)
  ds_read_b64_tr_b16 a[226:227], v34 offset:50176
  v_mfma_f32_16x16x32_bf16 v[68:71], a[196:199], a[52:55], v[68:71]
  v_mfma_f32_16x16x32_bf16 v[72:75], a[192:195], a[40:43], v[72:75]
  s_waitcnt vmcnt(11)
  ds_read_b64_tr_b16 a[228:229], v34 offset:57344
  v_mfma_f32_16x16x32_bf16 v[72:75], a[196:199], a[56:59], v[72:75]
  v_mfma_f32_16x16x32_bf16 v[76:79], a[192:195], a[44:47], v[76:79]
  s_waitcnt vmcnt(10)
  ds_read_b64_tr_b16 a[230:231], v34 offset:58368
  v_mfma_f32_16x16x32_bf16 v[76:79], a[196:199], a[60:63], v[76:79]
  s_waitcnt lgkmcnt(14)
  buffer_load_dwordx4 a[88:91], v0, s[16:19], s33 offen offset:2048 sc1
  v_mfma_f32_16x16x32_bf16 v[92:95], a[200:203], a[44:47], v[92:95]
  s_waitcnt lgkmcnt(12)
  ds_read_b64_tr_b16 a[232:233], v34 offset:49160
  v_mfma_f32_16x16x32_bf16 v[92:95], a[204:207], a[60:63], v[92:95]
  v_mfma_f32_16x16x32_bf16 v[88:91], a[200:203], a[40:43], v[88:91]
  ds_read_b64_tr_b16 a[234:235], v34 offset:50184
  v_mfma_f32_16x16x32_bf16 v[88:91], a[204:207], a[56:59], v[88:91]
  buffer_load_dwordx4 a[92:95], v0, s[16:19], s33 offen offset:3072 sc1
  v_mfma_f32_16x16x32_bf16 v[84:87], a[200:203], a[36:39], v[84:87]
  ds_read_b64_tr_b16 a[236:237], v34 offset:57352
  v_mfma_f32_16x16x32_bf16 v[84:87], a[204:207], a[52:55], v[84:87]
  v_mfma_f32_16x16x32_bf16 v[80:83], a[200:203], a[32:35], v[80:83]
  ds_read_b64_tr_b16 a[238:239], v34 offset:58376
  v_mfma_f32_16x16x32_bf16 v[80:83], a[204:207], a[48:51], v[80:83]
  s_waitcnt lgkmcnt(14)
  v_mfma_f32_16x16x32_bf16 v[96:99], a[208:211], a[32:35], v[96:99]
  s_waitcnt lgkmcnt(12)
  ds_read_b64_tr_b16 a[240:241], v35 offset:49152
  v_mfma_f32_16x16x32_bf16 v[96:99], a[212:215], a[48:51], v[96:99]
  s_add_u32 s33, s32, 24576
  buffer_load_dwordx4 a[96:99], v0, s[16:19], s33 offen offset:0 sc1
  v_mfma_f32_16x16x32_bf16 v[100:103], a[208:211], a[36:39], v[100:103]
  ds_read_b64_tr_b16 a[242:243], v35 offset:50176
  v_mfma_f32_16x16x32_bf16 v[100:103], a[212:215], a[52:55], v[100:103]
  v_mfma_f32_16x16x32_bf16 v[104:107], a[208:211], a[40:43], v[104:107]
  s_add_u32 m0, s26, 49152
  ds_read_b64_tr_b16 a[244:245], v35 offset:57344
  v_mfma_f32_16x16x32_bf16 v[104:107], a[212:215], a[56:59], v[104:107]
  buffer_load_dwordx4 v40, s[12:15], s27 offen offset:0 lds
  v_mfma_f32_16x16x32_bf16 v[108:111], a[208:211], a[44:47], v[108:111]
  ds_read_b64_tr_b16 a[246:247], v35 offset:58368
  v_mfma_f32_16x16x32_bf16 v[108:111], a[212:215], a[60:63], v[108:111]
  s_waitcnt lgkmcnt(14)
  v_mfma_f32_16x16x32_bf16 v[124:127], a[216:219], a[44:47], v[124:127]
  s_waitcnt lgkmcnt(12)
  ds_read_b64_tr_b16 a[248:249], v35 offset:49160
  v_mfma_f32_16x16x32_bf16 v[124:127], a[220:223], a[60:63], v[124:127]
  v_mfma_f32_16x16x32_bf16 v[120:123], a[216:219], a[40:43], v[120:123]
  ds_read_b64_tr_b16 a[250:251], v35 offset:50184
  v_mfma_f32_16x16x32_bf16 v[120:123], a[220:223], a[56:59], v[120:123]
  buffer_load_dwordx4 v41, s[12:15], s27 offen offset:1024 lds
  v_mfma_f32_16x16x32_bf16 v[116:119], a[216:219], a[36:39], v[116:119]
  ds_read_b64_tr_b16 a[252:253], v35 offset:57352
  v_mfma_f32_16x16x32_bf16 v[116:119], a[220:223], a[52:55], v[116:119]
  v_mfma_f32_16x16x32_bf16 v[112:115], a[216:219], a[32:35], v[112:115]
  ds_read_b64_tr_b16 a[254:255], v35 offset:58376
  v_mfma_f32_16x16x32_bf16 v[112:115], a[220:223], a[48:51], v[112:115]
  s_waitcnt lgkmcnt(14)
  buffer_load_dwordx4 v42, s[12:15], s27 offen offset:2048 lds
  v_mfma_f32_16x16x32_bf16 v[128:131], a[224:227], a[32:35], v[128:131]
  s_waitcnt lgkmcnt(12)
  ds_read_b64_tr_b16 a[192:193], v32 offset:16384
  v_mfma_f32_16x16x32_bf16 v[128:131], a[228:231], a[48:51], v[128:131]
  v_mfma_f32_16x16x32_bf16 v[132:135], a[224:227], a[36:39], v[132:135]
  ds_read_b64_tr_b16 a[194:195], v32 offset:17408
  v_mfma_f32_16x16x32_bf16 v[132:135], a[228:231], a[52:55], v[132:135]
  v_mfma_f32_16x16x32_bf16 v[136:139], a[224:227], a[40:43], v[136:139]
  ds_read_b64_tr_b16 a[196:197], v32 offset:24576
  v_mfma_f32_16x16x32_bf16 v[136:139], a[228:231], a[56:59], v[136:139]
  buffer_load_dwordx4 v43, s[12:15], s27 offen offset:3072 lds
  v_mfma_f32_16x16x32_bf16 v[140:143], a[224:227], a[44:47], v[140:143]
  s_add_u32 s27, s27, 524288
  ds_read_b64_tr_b16 a[198:199], v32 offset:25600
  v_mfma_f32_16x16x32_bf16 v[140:143], a[228:231], a[60:63], v[140:143]
  s_waitcnt lgkmcnt(14)
  v_mfma_f32_16x16x32_bf16 v[156:159], a[232:235], a[44:47], v[156:159]
  s_waitcnt lgkmcnt(12)
  s_add_u32 m0, s26, 98304
  ds_read_b64_tr_b16 a[200:201], v32 offset:16392
  v_mfma_f32_16x16x32_bf16 v[156:159], a[236:239], a[60:63], v[156:159]
  buffer_load_dwordx4 v40, s[12:15], s27 offen offset:0 lds
  v_mfma_f32_16x16x32_bf16 v[152:155], a[232:235], a[40:43], v[152:155]
  ds_read_b64_tr_b16 a[202:203], v32 offset:17416
  v_mfma_f32_16x16x32_bf16 v[152:155], a[236:239], a[56:59], v[152:155]
  v_mfma_f32_16x16x32_bf16 v[148:151], a[232:235], a[36:39], v[148:151]
  ds_read_b64_tr_b16 a[204:205], v32 offset:24584
  v_mfma_f32_16x16x32_bf16 v[148:151], a[236:239], a[52:55], v[148:151]
  v_mfma_f32_16x16x32_bf16 v[144:147], a[232:235], a[32:35], v[144:147]
  ds_read_b64_tr_b16 a[206:207], v32 offset:25608
  v_mfma_f32_16x16x32_bf16 v[144:147], a[236:239], a[48:51], v[144:147]
  s_waitcnt lgkmcnt(14)
  buffer_load_dwordx4 v41, s[12:15], s27 offen offset:1024 lds
  v_mfma_f32_16x16x32_bf16 v[160:163], a[240:243], a[32:35], v[160:163]
  s_waitcnt lgkmcnt(12)
  ds_read_b64_tr_b16 a[208:209], v33 offset:16384
  v_mfma_f32_16x16x32_bf16 v[160:163], a[244:247], a[48:51], v[160:163]
  v_mfma_f32_16x16x32_bf16 v[164:167], a[240:243], a[36:39], v[164:167]
  ds_read_b64_tr_b16 a[210:211], v33 offset:17408
  v_mfma_f32_16x16x32_bf16 v[164:167], a[244:247], a[52:55], v[164:167]
  buffer_load_dwordx4 v42, s[12:15], s27 offen offset:2048 lds
  v_mfma_f32_16x16x32_bf16 v[168:171], a[240:243], a[40:43], v[168:171]
  ds_read_b64_tr_b16 a[212:213], v33 offset:24576
  v_mfma_f32_16x16x32_bf16 v[168:171], a[244:247], a[56:59], v[168:171]
  v_mfma_f32_16x16x32_bf16 v[172:175], a[240:243], a[44:47], v[172:175]
  ds_read_b64_tr_b16 a[214:215], v33 offset:25600
  v_mfma_f32_16x16x32_bf16 v[172:175], a[244:247], a[60:63], v[172:175]
  s_waitcnt lgkmcnt(14)
  v_mfma_f32_16x16x32_bf16 v[188:191], a[248:251], a[44:47], v[188:191]
  s_waitcnt lgkmcnt(12)
  ds_read_b64_tr_b16 a[216:217], v33 offset:16392
  v_mfma_f32_16x16x32_bf16 v[188:191], a[252:255], a[60:63], v[188:191]
  buffer_load_dwordx4 v43, s[12:15], s27 offen offset:3072 lds
  v_mfma_f32_16x16x32_bf16 v[184:187], a[248:251], a[40:43], v[184:187]
  s_add_u32 s27, s27, 524288
  ds_read_b64_tr_b16 a[218:219], v33 offset:17416
  v_mfma_f32_16x16x32_bf16 v[184:187], a[252:255], a[56:59], v[184:187]
  v_mfma_f32_16x16x32_bf16 v[180:183], a[248:251], a[36:39], v[180:183]
  ds_read_b64_tr_b16 a[220:221], v33 offset:24584
  v_mfma_f32_16x16x32_bf16 v[180:183], a[252:255], a[52:55], v[180:183]
  buffer_load_dwordx4 a[100:103], v0, s[16:19], s33 offen offset:1024 sc1
  v_mfma_f32_16x16x32_bf16 v[176:179], a[248:251], a[32:35], v[176:179]
  ds_read_b64_tr_b16 a[222:223], v33 offset:25608
  v_mfma_f32_16x16x32_bf16 v[176:179], a[252:255], a[48:51], v[176:179]
  s_waitcnt vmcnt(21) lgkmcnt(14)
  v_mfma_f32_16x16x32_bf16 v[64:67], a[192:195], a[64:67], v[64:67]
  s_waitcnt vmcnt(13) lgkmcnt(12)
  ds_read_b64_tr_b16 a[224:225], v34 offset:16384
  v_mfma_f32_16x16x32_bf16 v[64:67], a[196:199], a[80:83], v[64:67]
  v_mfma_f32_16x16x32_bf16 v[68:71], a[192:195], a[68:71], v[68:71]
  s_waitcnt vmcnt(12)
  ds_read_b64_tr_b16 a[226:227], v34 offset:17408
  v_mfma_f32_16x16x32_bf16 v[68:71], a[196:199], a[84:87], v[68:71]
  buffer_load_dwordx4 a[104:107], v0, s[16:19], s33 offen offset:2048 sc1
  v_mfma_f32_16x16x32_bf16 v[72:75], a[192:195], a[72:75], v[72:75]
  s_waitcnt vmcnt(12)
  ds_read_b64_tr_b16 a[228:229], v34 offset:24576
  v_mfma_f32_16x16x32_bf16 v[72:75], a[196:199], a[88:91], v[72:75]
  v_mfma_f32_16x16x32_bf16 v[76:79], a[192:195], a[76:79], v[76:79]
  s_waitcnt vmcnt(11)
  ds_read_b64_tr_b16 a[230:231], v34 offset:25600
  v_mfma_f32_16x16x32_bf16 v[76:79], a[196:199], a[92:95], v[76:79]
  s_waitcnt lgkmcnt(14)
  buffer_load_dwordx4 a[108:111], v0, s[16:19], s33 offen offset:3072 sc1
  v_mfma_f32_16x16x32_bf16 v[92:95], a[200:203], a[76:79], v[92:95]
  s_waitcnt lgkmcnt(12)
  ds_read_b64_tr_b16 a[232:233], v34 offset:16392
  v_mfma_f32_16x16x32_bf16 v[92:95], a[204:207], a[92:95], v[92:95]
  v_mfma_f32_16x16x32_bf16 v[88:91], a[200:203], a[72:75], v[88:91]
  ds_read_b64_tr_b16 a[234:235], v34 offset:17416
  v_mfma_f32_16x16x32_bf16 v[88:91], a[204:207], a[88:91], v[88:91]
  v_mfma_f32_16x16x32_bf16 v[84:87], a[200:203], a[68:71], v[84:87]
  ds_read_b64_tr_b16 a[236:237], v34 offset:24584
  v_mfma_f32_16x16x32_bf16 v[84:87], a[204:207], a[84:87], v[84:87]
  s_add_u32 s33, s32, 28672
  buffer_load_dwordx4 a[112:115], v0, s[16:19], s33 offen offset:0 sc1
  v_mfma_f32_16x16x32_bf16 v[80:83], a[200:203], a[64:67], v[80:83]
  ds_read_b64_tr_b16 a[238:239], v34 offset:25608
  v_mfma_f32_16x16x32_bf16 v[80:83], a[204:207], a[80:83], v[80:83]
  s_waitcnt lgkmcnt(14)
  v_mfma_f32_16x16x32_bf16 v[96:99], a[208:211], a[64:67], v[96:99]
  s_waitcnt lgkmcnt(12)
  ds_read_b64_tr_b16 a[240:241], v35 offset:16384
  v_mfma_f32_16x16x32_bf16 v[96:99], a[212:215], a[80:83], v[96:99]
  buffer_load_dwordx4 a[116:119], v0, s[16:19], s33 offen offset:1024 sc1
  v_mfma_f32_16x16x32_bf16 v[100:103], a[208:211], a[68:71], v[100:103]
  ds_read_b64_tr_b16 a[242:243], v35 offset:17408
  v_mfma_f32_16x16x32_bf16 v[100:103], a[212:215], a[84:87], v[100:103]
  v_mfma_f32_16x16x32_bf16 v[104:107], a[208:211], a[72:75], v[104:107]
  ds_read_b64_tr_b16 a[244:245], v35 offset:24576
  v_mfma_f32_16x16x32_bf16 v[104:107], a[212:215], a[88:91], v[104:107]
  v_mfma_f32_16x16x32_bf16 v[108:111], a[208:211], a[76:79], v[108:111]
  ds_read_b64_tr_b16 a[246:247], v35 offset:25600
  v_mfma_f32_16x16x32_bf16 v[108:111], a[212:215], a[92:95], v[108:111]
  s_waitcnt lgkmcnt(14)
  buffer_load_dwordx4 a[120:123], v0, s[16:19], s33 offen offset:2048 sc1
  v_mfma_f32_16x16x32_bf16 v[124:127], a[216:219], a[76:79], v[124:127]
  s_waitcnt lgkmcnt(12)
  ds_read_b64_tr_b16 a[248:249], v35 offset:16392
  v_mfma_f32_16x16x32_bf16 v[124:127], a[220:223], a[92:95], v[124:127]
  v_mfma_f32_16x16x32_bf16 v[120:123], a[216:219], a[72:75], v[120:123]
  ds_read_b64_tr_b16 a[250:251], v35 offset:17416
  v_mfma_f32_16x16x32_bf16 v[120:123], a[220:223], a[88:91], v[120:123]
  buffer_load_dwordx4 a[124:127], v0, s[16:19], s33 offen offset:3072 sc1
  v_mfma_f32_16x16x32_bf16 v[116:119], a[216:219], a[68:71], v[116:119]
  ds_read_b64_tr_b16 a[252:253], v35 offset:24584
  v_mfma_f32_16x16x32_bf16 v[116:119], a[220:223], a[84:87], v[116:119]
  v_mfma_f32_16x16x32_bf16 v[112:115], a[216:219], a[64:67], v[112:115]
  ds_read_b64_tr_b16 a[254:255], v35 offset:25608
  v_mfma_f32_16x16x32_bf16 v[112:115], a[220:223], a[80:83], v[112:115]
  s_waitcnt lgkmcnt(14)
  s_barrier
  v_mfma_f32_16x16x32_bf16 v[128:131], a[224:227], a[64:67], v[128:131]
  s_waitcnt lgkmcnt(12)
  ds_read_b64_tr_b16 a[192:193], v36 offset:0
  v_mfma_f32_16x16x32_bf16 v[128:131], a[228:231], a[80:83], v[128:131]
  s_add_u32 s33, s32, 32768
  buffer_load_dwordx4 a[0:3], v0, s[16:19], s33 offen offset:0 sc1
  v_mfma_f32_16x16x32_bf16 v[132:135], a[224:227], a[68:71], v[132:135]
  ds_read_b64_tr_b16 a[194:195], v36 offset:1024
  v_mfma_f32_16x16x32_bf16 v[132:135], a[228:231], a[84:87], v[132:135]
  v_mfma_f32_16x16x32_bf16 v[136:139], a[224:227], a[72:75], v[136:139]
  ds_read_b64_tr_b16 a[196:197], v36 offset:8192
  v_mfma_f32_16x16x32_bf16 v[136:139], a[228:231], a[88:91], v[136:139]
  buffer_load_dwordx4 a[4:7], v0, s[16:19], s33 offen offset:1024 sc1
  v_mfma_f32_16x16x32_bf16 v[140:143], a[224:227], a[76:79], v[140:143]
  ds_read_b64_tr_b16 a[198:199], v36 offset:9216
  v_mfma_f32_16x16x32_bf16 v[140:143], a[228:231], a[92:95], v[140:143]
  s_waitcnt lgkmcnt(14)
  v_mfma_f32_16x16x32_bf16 v[156:159], a[232:235], a[76:79], v[156:159]
  s_waitcnt lgkmcnt(12)
  ds_read_b64_tr_b16 a[200:201], v36 offset:8
  v_mfma_f32_16x16x32_bf16 v[156:159], a[236:239], a[92:95], v[156:159]
  v_mfma_f32_16x16x32_bf16 v[152:155], a[232:235], a[72:75], v[152:155]
  ds_read_b64_tr_b16 a[202:203], v36 offset:1032
  v_mfma_f32_16x16x32_bf16 v[152:155], a[236:239], a[88:91], v[152:155]
  buffer_load_dwordx4 a[8:11], v0, s[16:19], s33 offen offset:2048 sc1
  v_mfma_f32_16x16x32_bf16 v[148:151], a[232:235], a[68:71], v[148:151]
  ds_read_b64_tr_b16 a[204:205], v36 offset:8200
  v_mfma_f32_16x16x32_bf16 v[148:151], a[236:239], a[84:87], v[148:151]
  v_mfma_f32_16x16x32_bf16 v[144:147], a[232:235], a[64:67], v[144:147]
  ds_read_b64_tr_b16 a[206:207], v36 offset:9224
  v_mfma_f32_16x16x32_bf16 v[144:147], a[236:239], a[80:83], v[144:147]
  s_waitcnt lgkmcnt(14)
  buffer_load_dwordx4 a[12:15], v0, s[16:19], s33 offen offset:3072 sc1
  v_mfma_f32_16x16x32_bf16 v[160:163], a[240:243], a[64:67], v[160:163]
  s_waitcnt lgkmcnt(12)
  ds_read_b64_tr_b16 a[208:209], v37 offset:0
  v_mfma_f32_16x16x32_bf16 v[160:163], a[244:247], a[80:83], v[160:163]
  v_mfma_f32_16x16x32_bf16 v[164:167], a[240:243], a[68:71], v[164:167]
  ds_read_b64_tr_b16 a[210:211], v37 offset:1024
  v_mfma_f32_16x16x32_bf16 v[164:167], a[244:247], a[84:87], v[164:167]
  v_mfma_f32_16x16x32_bf16 v[168:171], a[240:243], a[72:75], v[168:171]
  ds_read_b64_tr_b16 a[212:213], v37 offset:8192
  v_mfma_f32_16x16x32_bf16 v[168:171], a[244:247], a[88:91], v[168:171]
  s_add_u32 s33, s32, 36864
  buffer_load_dwordx4 a[16:19], v0, s[16:19], s33 offen offset:0 sc1
  v_mfma_f32_16x16x32_bf16 v[172:175], a[240:243], a[76:79], v[172:175]
  ds_read_b64_tr_b16 a[214:215], v37 offset:9216
  v_mfma_f32_16x16x32_bf16 v[172:175], a[244:247], a[92:95], v[172:175]
  s_waitcnt lgkmcnt(14)
  v_mfma_f32_16x16x32_bf16 v[188:191], a[248:251], a[76:79], v[188:191]
  s_waitcnt lgkmcnt(12)
  ds_read_b64_tr_b16 a[216:217], v37 offset:8
  v_mfma_f32_16x16x32_bf16 v[188:191], a[252:255], a[92:95], v[188:191]
  buffer_load_dwordx4 a[20:23], v0, s[16:19], s33 offen offset:1024 sc1
  v_mfma_f32_16x16x32_bf16 v[184:187], a[248:251], a[72:75], v[184:187]
  ds_read_b64_tr_b16 a[218:219], v37 offset:1032
  v_mfma_f32_16x16x32_bf16 v[184:187], a[252:255], a[88:91], v[184:187]
  v_mfma_f32_16x16x32_bf16 v[180:183], a[248:251], a[68:71], v[180:183]
  ds_read_b64_tr_b16 a[220:221], v37 offset:8200
  v_mfma_f32_16x16x32_bf16 v[180:183], a[252:255], a[84:87], v[180:183]
  v_mfma_f32_16x16x32_bf16 v[176:179], a[248:251], a[64:67], v[176:179]
  ds_read_b64_tr_b16 a[222:223], v37 offset:9224
  v_mfma_f32_16x16x32_bf16 v[176:179], a[252:255], a[80:83], v[176:179]
  s_waitcnt vmcnt(21) lgkmcnt(14)
  buffer_load_dwordx4 a[24:27], v0, s[16:19], s33 offen offset:2048 sc1
  v_mfma_f32_16x16x32_bf16 v[64:67], a[192:195], a[96:99], v[64:67]
  s_waitcnt vmcnt(10) lgkmcnt(12)
  ds_read_b64_tr_b16 a[224:225], v38 offset:0
  v_mfma_f32_16x16x32_bf16 v[64:67], a[196:199], a[112:115], v[64:67]
  v_mfma_f32_16x16x32_bf16 v[68:71], a[192:195], a[100:103], v[68:71]
  s_waitcnt vmcnt(9)
  ds_read_b64_tr_b16 a[226:227], v38 offset:1024
  v_mfma_f32_16x16x32_bf16 v[68:71], a[196:199], a[116:119], v[68:71]
  buffer_load_dwordx4 a[28:31], v0, s[16:19], s33 offen offset:3072 sc1
  v_mfma_f32_16x16x32_bf16 v[72:75], a[192:195], a[104:107], v[72:75]
  s_waitcnt vmcnt(9)
  ds_read_b64_tr_b16 a[228:229], v38 offset:8192
  v_mfma_f32_16x16x32_bf16 v[72:75], a[196:199], a[120:123], v[72:75]
  v_mfma_f32_16x16x32_bf16 v[76:79], a[192:195], a[108:111], v[76:79]
  s_waitcnt vmcnt(8)
  ds_read_b64_tr_b16 a[230:231], v38 offset:9216
  v_mfma_f32_16x16x32_bf16 v[76:79], a[196:199], a[124:127], v[76:79]
  s_waitcnt lgkmcnt(14)
  v_mfma_f32_16x16x32_bf16 v[92:95], a[200:203], a[108:111], v[92:95]
  s_waitcnt lgkmcnt(12)
  ds_read_b64_tr_b16 a[232:233], v38 offset:8
  v_mfma_f32_16x16x32_bf16 v[92:95], a[204:207], a[124:127], v[92:95]
  s_add_u32 s33, s32, 40960
  buffer_load_dwordx4 a[32:35], v0, s[16:19], s33 offen offset:0 sc1
  v_mfma_f32_16x16x32_bf16 v[88:91], a[200:203], a[104:107], v[88:91]
  ds_read_b64_tr_b16 a[234:235], v38 offset:1032
  v_mfma_f32_16x16x32_bf16 v[88:91], a[204:207], a[120:123], v[88:91]
  v_mfma_f32_16x16x32_bf16 v[84:87], a[200:203], a[100:103], v[84:87]
  s_add_u32 m0, s26, 114688
  ds_read_b64_tr_b16 a[236:237], v38 offset:8200
  v_mfma_f32_16x16x32_bf16 v[84:87], a[204:207], a[116:119], v[84:87]
  buffer_load_dwordx4 v40, s[12:15], s27 offen offset:0 lds
  v_mfma_f32_16x16x32_bf16 v[80:83], a[200:203], a[96:99], v[80:83]
  ds_read_b64_tr_b16 a[238:239], v38 offset:9224
  v_mfma_f32_16x16x32_bf16 v[80:83], a[204:207], a[112:115], v[80:83]
  s_waitcnt lgkmcnt(14)
  v_mfma_f32_16x16x32_bf16 v[96:99], a[208:211], a[96:99], v[96:99]
  s_waitcnt lgkmcnt(12)
  ds_read_b64_tr_b16 a[240:241], v39 offset:0
  v_mfma_f32_16x16x32_bf16 v[96:99], a[212:215], a[112:115], v[96:99]
  v_mfma_f32_16x16x32_bf16 v[100:103], a[208:211], a[100:103], v[100:103]
  ds_read_b64_tr_b16 a[242:243], v39 offset:1024
  v_mfma_f32_16x16x32_bf16 v[100:103], a[212:215], a[116:119], v[100:103]
  buffer_load_dwordx4 v41, s[12:15], s27 offen offset:1024 lds
  v_mfma_f32_16x16x32_bf16 v[104:107], a[208:211], a[104:107], v[104:107]
  ds_read_b64_tr_b16 a[244:245], v39 offset:8192
  v_mfma_f32_16x16x32_bf16 v[104:107], a[212:215], a[120:123], v[104:107]
  v_mfma_f32_16x16x32_bf16 v[108:111], a[208:211], a[108:111], v[108:111]
  ds_read_b64_tr_b16 a[246:247], v39 offset:9216
  v_mfma_f32_16x16x32_bf16 v[108:111], a[212:215], a[124:127], v[108:111]
  s_waitcnt lgkmcnt(14)
  buffer_load_dwordx4 v42, s[12:15], s27 offen offset:2048 lds
  v_mfma_f32_16x16x32_bf16 v[124:127], a[216:219], a[108:111], v[124:127]
  s_waitcnt lgkmcnt(12)
  ds_read_b64_tr_b16 a[248:249], v39 offset:8
  v_mfma_f32_16x16x32_bf16 v[124:127], a[220:223], a[124:127], v[124:127]
  v_mfma_f32_16x16x32_bf16 v[120:123], a[216:219], a[104:107], v[120:123]
  ds_read_b64_tr_b16 a[250:251], v39 offset:1032
  v_mfma_f32_16x16x32_bf16 v[120:123], a[220:223], a[120:123], v[120:123]
  v_mfma_f32_16x16x32_bf16 v[116:119], a[216:219], a[100:103], v[116:119]
  ds_read_b64_tr_b16 a[252:253], v39 offset:8200
  v_mfma_f32_16x16x32_bf16 v[116:119], a[220:223], a[116:119], v[116:119]
  buffer_load_dwordx4 v43, s[12:15], s27 offen offset:3072 lds
  v_mfma_f32_16x16x32_bf16 v[112:115], a[216:219], a[96:99], v[112:115]
  s_add_u32 s27, s27, 524288
  ds_read_b64_tr_b16 a[254:255], v39 offset:9224
  v_mfma_f32_16x16x32_bf16 v[112:115], a[220:223], a[112:115], v[112:115]
  s_waitcnt lgkmcnt(14)
  s_barrier
  v_mfma_f32_16x16x32_bf16 v[128:131], a[224:227], a[96:99], v[128:131]
  s_waitcnt lgkmcnt(12)
  s_add_u32 m0, s26, 131072
  ds_read_b64_tr_b16 a[192:193], v32 offset:32768
  v_mfma_f32_16x16x32_bf16 v[128:131], a[228:231], a[112:115], v[128:131]
  buffer_load_dwordx4 v40, s[12:15], s27 offen offset:0 lds
  v_mfma_f32_16x16x32_bf16 v[132:135], a[224:227], a[100:103], v[132:135]
  ds_read_b64_tr_b16 a[194:195], v32 offset:33792
  v_mfma_f32_16x16x32_bf16 v[132:135], a[228:231], a[116:119], v[132:135]
  v_mfma_f32_16x16x32_bf16 v[136:139], a[224:227], a[104:107], v[136:139]
  ds_read_b64_tr_b16 a[196:197], v32 offset:40960
  v_mfma_f32_16x16x32_bf16 v[136:139], a[228:231], a[120:123], v[136:139]
  v_mfma_f32_16x16x32_bf16 v[140:143], a[224:227], a[108:111], v[140:143]
  ds_read_b64_tr_b16 a[198:199], v32 offset:41984
  v_mfma_f32_16x16x32_bf16 v[140:143], a[228:231], a[124:127], v[140:143]
  s_waitcnt lgkmcnt(14)
  buffer_load_dwordx4 v41, s[12:15], s27 offen offset:1024 lds
  v_mfma_f32_16x16x32_bf16 v[156:159], a[232:235], a[108:111], v[156:159]
  s_waitcnt lgkmcnt(12)
  ds_read_b64_tr_b16 a[200:201], v32 offset:32776
  v_mfma_f32_16x16x32_bf16 v[156:159], a[236:239], a[124:127], v[156:159]
  v_mfma_f32_16x16x32_bf16 v[152:155], a[232:235], a[104:107], v[152:155]
  ds_read_b64_tr_b16 a[202:203], v32 offset:33800
  v_mfma_f32_16x16x32_bf16 v[152:155], a[236:239], a[120:123], v[152:155]
  buffer_load_dwordx4 v42, s[12:15], s27 offen offset:2048 lds
  v_mfma_f32_16x16x32_bf16 v[148:151], a[232:235], a[100:103], v[148:151]
  ds_read_b64_tr_b16 a[204:205], v32 offset:40968
  v_mfma_f32_16x16x32_bf16 v[148:151], a[236:239], a[116:119], v[148:151]
  v_mfma_f32_16x16x32_bf16 v[144:147], a[232:235], a[96:99], v[144:147]
  ds_read_b64_tr_b16 a[206:207], v32 offset:41992
  v_mfma_f32_16x16x32_bf16 v[144:147], a[236:239], a[112:115], v[144:147]
  s_waitcnt lgkmcnt(14)
  v_mfma_f32_16x16x32_bf16 v[160:163], a[240:243], a[96:99], v[160:163]
  s_waitcnt lgkmcnt(12)
  ds_read_b64_tr_b16 a[208:209], v33 offset:32768
  v_mfma_f32_16x16x32_bf16 v[160:163], a[244:247], a[112:115], v[160:163]
  buffer_load_dwordx4 v43, s[12:15], s27 offen offset:3072 lds
  v_mfma_f32_16x16x32_bf16 v[164:167], a[240:243], a[100:103], v[164:167]
  s_add_u32 s27, s27, 524288
  ds_read_b64_tr_b16 a[210:211], v33 offset:33792
  v_mfma_f32_16x16x32_bf16 v[164:167], a[244:247], a[116:119], v[164:167]
  v_mfma_f32_16x16x32_bf16 v[168:171], a[240:243], a[104:107], v[168:171]
  ds_read_b64_tr_b16 a[212:213], v33 offset:40960
  v_mfma_f32_16x16x32_bf16 v[168:171], a[244:247], a[120:123], v[168:171]
  buffer_load_dwordx4 a[36:39], v0, s[16:19], s33 offen offset:1024 sc1
  v_mfma_f32_16x16x32_bf16 v[172:175], a[240:243], a[108:111], v[172:175]
  ds_read_b64_tr_b16 a[214:215], v33 offset:41984
  v_mfma_f32_16x16x32_bf16 v[172:175], a[244:247], a[124:127], v[172:175]
  s_waitcnt lgkmcnt(14)
  v_mfma_f32_16x16x32_bf16 v[188:191], a[248:251], a[108:111], v[188:191]
  s_waitcnt lgkmcnt(12)
  ds_read_b64_tr_b16 a[216:217], v33 offset:32776
  v_mfma_f32_16x16x32_bf16 v[188:191], a[252:255], a[124:127], v[188:191]
  v_mfma_f32_16x16x32_bf16 v[184:187], a[248:251], a[104:107], v[184:187]
  ds_read_b64_tr_b16 a[218:219], v33 offset:33800
  v_mfma_f32_16x16x32_bf16 v[184:187], a[252:255], a[120:123], v[184:187]
  buffer_load_dwordx4 a[40:43], v0, s[16:19], s33 offen offset:2048 sc1
  v_mfma_f32_16x16x32_bf16 v[180:183], a[248:251], a[100:103], v[180:183]
  ds_read_b64_tr_b16 a[220:221], v33 offset:40968
  v_mfma_f32_16x16x32_bf16 v[180:183], a[252:255], a[116:119], v[180:183]
  v_mfma_f32_16x16x32_bf16 v[176:179], a[248:251], a[96:99], v[176:179]
  ds_read_b64_tr_b16 a[222:223], v33 offset:41992
  v_mfma_f32_16x16x32_bf16 v[176:179], a[252:255], a[112:115], v[176:179]
  s_waitcnt vmcnt(18) lgkmcnt(14)
  buffer_load_dwordx4 a[44:47], v0, s[16:19], s33 offen offset:3072 sc1
  v_mfma_f32_16x16x32_bf16 v[64:67], a[192:195], a[0:3], v[64:67]
  s_waitcnt vmcnt(15) lgkmcnt(12)
  ds_read_b64_tr_b16 a[224:225], v34 offset:32768
  v_mfma_f32_16x16x32_bf16 v[64:67], a[196:199], a[16:19], v[64:67]
  v_mfma_f32_16x16x32_bf16 v[68:71], a[192:195], a[4:7], v[68:71]
  s_waitcnt vmcnt(14)
  ds_read_b64_tr_b16 a[226:227], v34 offset:33792
  v_mfma_f32_16x16x32_bf16 v[68:71], a[196:199], a[20:23], v[68:71]
  v_mfma_f32_16x16x32_bf16 v[72:75], a[192:195], a[8:11], v[72:75]
  s_waitcnt vmcnt(13)
  ds_read_b64_tr_b16 a[228:229], v34 offset:40960
  v_mfma_f32_16x16x32_bf16 v[72:75], a[196:199], a[24:27], v[72:75]
  s_add_u32 s33, s32, 45056
  buffer_load_dwordx4 a[48:51], v0, s[16:19], s33 offen offset:0 sc1
  v_mfma_f32_16x16x32_bf16 v[76:79], a[192:195], a[12:15], v[76:79]
  s_waitcnt vmcnt(13)
  ds_read_b64_tr_b16 a[230:231], v34 offset:41984
  v_mfma_f32_16x16x32_bf16 v[76:79], a[196:199], a[28:31], v[76:79]
  s_waitcnt lgkmcnt(14)
  v_mfma_f32_16x16x32_bf16 v[92:95], a[200:203], a[12:15], v[92:95]
  s_waitcnt lgkmcnt(12)
  ds_read_b64_tr_b16 a[232:233], v34 offset:32776
  v_mfma_f32_16x16x32_bf16 v[92:95], a[204:207], a[28:31], v[92:95]
  buffer_load_dwordx4 a[52:55], v0, s[16:19], s33 offen offset:1024 sc1
  v_mfma_f32_16x16x32_bf16 v[88:91], a[200:203], a[8:11], v[88:91]
  ds_read_b64_tr_b16 a[234:235], v34 offset:33800
  v_mfma_f32_16x16x32_bf16 v[88:91], a[204:207], a[24:27], v[88:91]
  v_mfma_f32_16x16x32_bf16 v[84:87], a[200:203], a[4:7], v[84:87]
  ds_read_b64_tr_b16 a[236:237], v34 offset:40968
  v_mfma_f32_16x16x32_bf16 v[84:87], a[204:207], a[20:23], v[84:87]
  v_mfma_f32_16x16x32_bf16 v[80:83], a[200:203], a[0:3], v[80:83]
  ds_read_b64_tr_b16 a[238:239], v34 offset:41992
  v_mfma_f32_16x16x32_bf16 v[80:83], a[204:207], a[16:19], v[80:83]
  s_waitcnt lgkmcnt(14)
  buffer_load_dwordx4 a[56:59], v0, s[16:19], s33 offen offset:2048 sc1
  v_mfma_f32_16x16x32_bf16 v[96:99], a[208:211], a[0:3], v[96:99]
  s_waitcnt lgkmcnt(12)
  ds_read_b64_tr_b16 a[240:241], v35 offset:32768
  v_mfma_f32_16x16x32_bf16 v[96:99], a[212:215], a[16:19], v[96:99]
  v_mfma_f32_16x16x32_bf16 v[100:103], a[208:211], a[4:7], v[100:103]
  ds_read_b64_tr_b16 a[242:243], v35 offset:33792
  v_mfma_f32_16x16x32_bf16 v[100:103], a[212:215], a[20:23], v[100:103]
  buffer_load_dwordx4 a[60:63], v0, s[16:19], s33 offen offset:3072 sc1
  v_mfma_f32_16x16x32_bf16 v[104:107], a[208:211], a[8:11], v[104:107]
  ds_read_b64_tr_b16 a[244:245], v35 offset:40960
  v_mfma_f32_16x16x32_bf16 v[104:107], a[212:215], a[24:27], v[104:107]
  v_mfma_f32_16x16x32_bf16 v[108:111], a[208:211], a[12:15], v[108:111]
  ds_read_b64_tr_b16 a[246:247], v35 offset:41984
  v_mfma_f32_16x16x32_bf16 v[108:111], a[212:215], a[28:31], v[108:111]
  s_waitcnt lgkmcnt(14)
  v_mfma_f32_16x16x32_bf16 v[124:127], a[216:219], a[12:15], v[124:127]
  s_waitcnt lgkmcnt(12)
  ds_read_b64_tr_b16 a[248:249], v35 offset:32776
  v_mfma_f32_16x16x32_bf16 v[124:127], a[220:223], a[28:31], v[124:127]
  s_add_u32 s33, s32, 49152
  buffer_load_dwordx4 a[64:67], v0, s[16:19], s33 offen offset:0 sc1
  v_mfma_f32_16x16x32_bf16 v[120:123], a[216:219], a[8:11], v[120:123]
  ds_read_b64_tr_b16 a[250:251], v35 offset:33800
  v_mfma_f32_16x16x32_bf16 v[120:123], a[220:223], a[24:27], v[120:123]
  v_mfma_f32_16x16x32_bf16 v[116:119], a[216:219], a[4:7], v[116:119]
  ds_read_b64_tr_b16 a[252:253], v35 offset:40968
  v_mfma_f32_16x16x32_bf16 v[116:119], a[220:223], a[20:23], v[116:119]
  buffer_load_dwordx4 a[68:71], v0, s[16:19], s33 offen offset:1024 sc1
  v_mfma_f32_16x16x32_bf16 v[112:115], a[216:219], a[0:3], v[112:115]
  ds_read_b64_tr_b16 a[254:255], v35 offset:41992
  v_mfma_f32_16x16x32_bf16 v[112:115], a[220:223], a[16:19], v[112:115]
  s_waitcnt lgkmcnt(14)
  v_mfma_f32_16x16x32_bf16 v[128:131], a[224:227], a[0:3], v[128:131]
  s_waitcnt lgkmcnt(12)
  ds_read_b64_tr_b16 a[192:193], v36 offset:16384
  v_mfma_f32_16x16x32_bf16 v[128:131], a[228:231], a[16:19], v[128:131]
  v_mfma_f32_16x16x32_bf16 v[132:135], a[224:227], a[4:7], v[132:135]
  ds_read_b64_tr_b16 a[194:195], v36 offset:17408
  v_mfma_f32_16x16x32_bf16 v[132:135], a[228:231], a[20:23], v[132:135]
  buffer_load_dwordx4 a[72:75], v0, s[16:19], s33 offen offset:2048 sc1
  v_mfma_f32_16x16x32_bf16 v[136:139], a[224:227], a[8:11], v[136:139]
  ds_read_b64_tr_b16 a[196:197], v36 offset:24576
  v_mfma_f32_16x16x32_bf16 v[136:139], a[228:231], a[24:27], v[136:139]
  v_mfma_f32_16x16x32_bf16 v[140:143], a[224:227], a[12:15], v[140:143]
  ds_read_b64_tr_b16 a[198:199], v36 offset:25600
  v_mfma_f32_16x16x32_bf16 v[140:143], a[228:231], a[28:31], v[140:143]
  s_waitcnt lgkmcnt(14)
  buffer_load_dwordx4 a[76:79], v0, s[16:19], s33 offen offset:3072 sc1
  v_mfma_f32_16x16x32_bf16 v[156:159], a[232:235], a[12:15], v[156:159]
  s_waitcnt lgkmcnt(12)
  ds_read_b64_tr_b16 a[200:201], v36 offset:16392
  v_mfma_f32_16x16x32_bf16 v[156:159], a[236:239], a[28:31], v[156:159]
  v_mfma_f32_16x16x32_bf16 v[152:155], a[232:235], a[8:11], v[152:155]
  ds_read_b64_tr_b16 a[202:203], v36 offset:17416
  v_mfma_f32_16x16x32_bf16 v[152:155], a[236:239], a[24:27], v[152:155]
  v_mfma_f32_16x16x32_bf16 v[148:151], a[232:235], a[4:7], v[148:151]
  ds_read_b64_tr_b16 a[204:205], v36 offset:24584
  v_mfma_f32_16x16x32_bf16 v[148:151], a[236:239], a[20:23], v[148:151]
  s_add_u32 s33, s32, 53248
  buffer_load_dwordx4 a[80:83], v0, s[16:19], s33 offen offset:0 sc1
  v_mfma_f32_16x16x32_bf16 v[144:147], a[232:235], a[0:3], v[144:147]
  ds_read_b64_tr_b16 a[206:207], v36 offset:25608
  v_mfma_f32_16x16x32_bf16 v[144:147], a[236:239], a[16:19], v[144:147]
  s_waitcnt lgkmcnt(14)
  v_mfma_f32_16x16x32_bf16 v[160:163], a[240:243], a[0:3], v[160:163]
  s_waitcnt lgkmcnt(12)
  ds_read_b64_tr_b16 a[208:209], v37 offset:16384
  v_mfma_f32_16x16x32_bf16 v[160:163], a[244:247], a[16:19], v[160:163]
  buffer_load_dwordx4 a[84:87], v0, s[16:19], s33 offen offset:1024 sc1
  v_mfma_f32_16x16x32_bf16 v[164:167], a[240:243], a[4:7], v[164:167]
  ds_read_b64_tr_b16 a[210:211], v37 offset:17408
  v_mfma_f32_16x16x32_bf16 v[164:167], a[244:247], a[20:23], v[164:167]
  v_mfma_f32_16x16x32_bf16 v[168:171], a[240:243], a[8:11], v[168:171]
  ds_read_b64_tr_b16 a[212:213], v37 offset:24576
  v_mfma_f32_16x16x32_bf16 v[168:171], a[244:247], a[24:27], v[168:171]
  v_mfma_f32_16x16x32_bf16 v[172:175], a[240:243], a[12:15], v[172:175]
  ds_read_b64_tr_b16 a[214:215], v37 offset:25600
  v_mfma_f32_16x16x32_bf16 v[172:175], a[244:247], a[28:31], v[172:175]
  s_waitcnt lgkmcnt(14)
  buffer_load_dwordx4 a[88:91], v0, s[16:19], s33 offen offset:2048 sc1
  v_mfma_f32_16x16x32_bf16 v[188:191], a[248:251], a[12:15], v[188:191]
  s_waitcnt lgkmcnt(12)
  ds_read_b64_tr_b16 a[216:217], v37 offset:16392
  v_mfma_f32_16x16x32_bf16 v[188:191], a[252:255], a[28:31], v[188:191]
  v_mfma_f32_16x16x32_bf16 v[184:187], a[248:251], a[8:11], v[184:187]
  ds_read_b64_tr_b16 a[218:219], v37 offset:17416
  v_mfma_f32_16x16x32_bf16 v[184:187], a[252:255], a[24:27], v[184:187]
  buffer_load_dwordx4 a[92:95], v0, s[16:19], s33 offen offset:3072 sc1
  v_mfma_f32_16x16x32_bf16 v[180:183], a[248:251], a[4:7], v[180:183]
  ds_read_b64_tr_b16 a[220:221], v37 offset:24584
  v_mfma_f32_16x16x32_bf16 v[180:183], a[252:255], a[20:23], v[180:183]
  v_mfma_f32_16x16x32_bf16 v[176:179], a[248:251], a[0:3], v[176:179]
  ds_read_b64_tr_b16 a[222:223], v37 offset:25608
  v_mfma_f32_16x16x32_bf16 v[176:179], a[252:255], a[16:19], v[176:179]
  s_waitcnt vmcnt(23) lgkmcnt(14)
  v_mfma_f32_16x16x32_bf16 v[64:67], a[192:195], a[32:35], v[64:67]
  s_waitcnt vmcnt(11) lgkmcnt(12)
  ds_read_b64_tr_b16 a[224:225], v38 offset:16384
  v_mfma_f32_16x16x32_bf16 v[64:67], a[196:199], a[48:51], v[64:67]
  s_add_u32 s33, s32, 57344
  buffer_load_dwordx4 a[96:99], v0, s[16:19], s33 offen offset:0 sc1
  v_mfma_f32_16x16x32_bf16 v[68:71], a[192:195], a[36:39], v[68:71]
  s_waitcnt vmcnt(11)
  ds_read_b64_tr_b16 a[226:227], v38 offset:17408
  v_mfma_f32_16x16x32_bf16 v[68:71], a[196:199], a[52:55], v[68:71]
  v_mfma_f32_16x16x32_bf16 v[72:75], a[192:195], a[40:43], v[72:75]
  s_waitcnt vmcnt(10)
  ds_read_b64_tr_b16 a[228:229], v38 offset:24576
  v_mfma_f32_16x16x32_bf16 v[72:75], a[196:199], a[56:59], v[72:75]
  buffer_load_dwordx4 a[100:103], v0, s[16:19], s33 offen offset:1024 sc1
  v_mfma_f32_16x16x32_bf16 v[76:79], a[192:195], a[44:47], v[76:79]
  s_waitcnt vmcnt(10)
  ds_read_b64_tr_b16 a[230:231], v38 offset:25600
  v_mfma_f32_16x16x32_bf16 v[76:79], a[196:199], a[60:63], v[76:79]
  s_waitcnt lgkmcnt(14)
  v_mfma_f32_16x16x32_bf16 v[92:95], a[200:203], a[44:47], v[92:95]
  s_waitcnt lgkmcnt(12)
  ds_read_b64_tr_b16 a[232:233], v38 offset:16392
  v_mfma_f32_16x16x32_bf16 v[92:95], a[204:207], a[60:63], v[92:95]
  v_mfma_f32_16x16x32_bf16 v[88:91], a[200:203], a[40:43], v[88:91]
  ds_read_b64_tr_b16 a[234:235], v38 offset:17416
  v_mfma_f32_16x16x32_bf16 v[88:91], a[204:207], a[56:59], v[88:91]
  buffer_load_dwordx4 a[104:107], v0, s[16:19], s33 offen offset:2048 sc1
  v_mfma_f32_16x16x32_bf16 v[84:87], a[200:203], a[36:39], v[84:87]
  ds_read_b64_tr_b16 a[236:237], v38 offset:24584
  v_mfma_f32_16x16x32_bf16 v[84:87], a[204:207], a[52:55], v[84:87]
  v_mfma_f32_16x16x32_bf16 v[80:83], a[200:203], a[32:35], v[80:83]
  ds_read_b64_tr_b16 a[238:239], v38 offset:25608
  v_mfma_f32_16x16x32_bf16 v[80:83], a[204:207], a[48:51], v[80:83]
  s_waitcnt lgkmcnt(14)
  buffer_load_dwordx4 a[108:111], v0, s[16:19], s33 offen offset:3072 sc1
  v_mfma_f32_16x16x32_bf16 v[96:99], a[208:211], a[32:35], v[96:99]
  s_waitcnt lgkmcnt(12)
  ds_read_b64_tr_b16 a[240:241], v39 offset:16384
  v_mfma_f32_16x16x32_bf16 v[96:99], a[212:215], a[48:51], v[96:99]
  v_mfma_f32_16x16x32_bf16 v[100:103], a[208:211], a[36:39], v[100:103]
  ds_read_b64_tr_b16 a[242:243], v39 offset:17408
  v_mfma_f32_16x16x32_bf16 v[100:103], a[212:215], a[52:55], v[100:103]
  v_mfma_f32_16x16x32_bf16 v[104:107], a[208:211], a[40:43], v[104:107]
  ds_read_b64_tr_b16 a[244:245], v39 offset:24576
  v_mfma_f32_16x16x32_bf16 v[104:107], a[212:215], a[56:59], v[104:107]
  s_add_u32 s33, s32, 61440
  buffer_load_dwordx4 a[112:115], v0, s[16:19], s33 offen offset:0 sc1
  v_mfma_f32_16x16x32_bf16 v[108:111], a[208:211], a[44:47], v[108:111]
  ds_read_b64_tr_b16 a[246:247], v39 offset:25600
  v_mfma_f32_16x16x32_bf16 v[108:111], a[212:215], a[60:63], v[108:111]
  s_waitcnt lgkmcnt(14)
  v_mfma_f32_16x16x32_bf16 v[124:127], a[216:219], a[44:47], v[124:127]
  s_waitcnt lgkmcnt(12)
  ds_read_b64_tr_b16 a[248:249], v39 offset:16392
  v_mfma_f32_16x16x32_bf16 v[124:127], a[220:223], a[60:63], v[124:127]
  buffer_load_dwordx4 a[116:119], v0, s[16:19], s33 offen offset:1024 sc1
  v_mfma_f32_16x16x32_bf16 v[120:123], a[216:219], a[40:43], v[120:123]
  ds_read_b64_tr_b16 a[250:251], v39 offset:17416
  v_mfma_f32_16x16x32_bf16 v[120:123], a[220:223], a[56:59], v[120:123]
  v_mfma_f32_16x16x32_bf16 v[116:119], a[216:219], a[36:39], v[116:119]
  ds_read_b64_tr_b16 a[252:253], v39 offset:24584
  v_mfma_f32_16x16x32_bf16 v[116:119], a[220:223], a[52:55], v[116:119]
  v_mfma_f32_16x16x32_bf16 v[112:115], a[216:219], a[32:35], v[112:115]
  ds_read_b64_tr_b16 a[254:255], v39 offset:25608
  v_mfma_f32_16x16x32_bf16 v[112:115], a[220:223], a[48:51], v[112:115]
  s_waitcnt lgkmcnt(14)
  s_barrier
  buffer_load_dwordx4 a[120:123], v0, s[16:19], s33 offen offset:2048 sc1
  v_mfma_f32_16x16x32_bf16 v[128:131], a[224:227], a[32:35], v[128:131]
  s_waitcnt lgkmcnt(12)
  ds_read_b64_tr_b16 a[192:193], v36 offset:32768
  v_mfma_f32_16x16x32_bf16 v[128:131], a[228:231], a[48:51], v[128:131]
  v_mfma_f32_16x16x32_bf16 v[132:135], a[224:227], a[36:39], v[132:135]
  ds_read_b64_tr_b16 a[194:195], v36 offset:33792
  v_mfma_f32_16x16x32_bf16 v[132:135], a[228:231], a[52:55], v[132:135]
  buffer_load_dwordx4 a[124:127], v0, s[16:19], s33 offen offset:3072 sc1
  v_mfma_f32_16x16x32_bf16 v[136:139], a[224:227], a[40:43], v[136:139]
  ds_read_b64_tr_b16 a[196:197], v36 offset:40960
  v_mfma_f32_16x16x32_bf16 v[136:139], a[228:231], a[56:59], v[136:139]
  v_mfma_f32_16x16x32_bf16 v[140:143], a[224:227], a[44:47], v[140:143]
  ds_read_b64_tr_b16 a[198:199], v36 offset:41984
  v_mfma_f32_16x16x32_bf16 v[140:143], a[228:231], a[60:63], v[140:143]
  s_waitcnt lgkmcnt(14)
  v_mfma_f32_16x16x32_bf16 v[156:159], a[232:235], a[44:47], v[156:159]
  s_waitcnt lgkmcnt(12)
  s_add_u32 m0, s26, 0
  ds_read_b64_tr_b16 a[200:201], v36 offset:49152
  v_mfma_f32_16x16x32_bf16 v[156:159], a[236:239], a[60:63], v[156:159]
  buffer_load_dwordx4 v13, s[4:7], s24 offen offset:0 lds
  v_mfma_f32_16x16x32_bf16 v[152:155], a[232:235], a[40:43], v[152:155]
  ds_read_b64_tr_b16 a[202:203], v36 offset:50176
  v_mfma_f32_16x16x32_bf16 v[152:155], a[236:239], a[56:59], v[152:155]
  v_mfma_f32_16x16x32_bf16 v[148:151], a[232:235], a[36:39], v[148:151]
  ds_read_b64_tr_b16 a[204:205], v36 offset:57344
  v_mfma_f32_16x16x32_bf16 v[148:151], a[236:239], a[52:55], v[148:151]
  buffer_load_dwordx4 v14, s[4:7], s24 offen offset:1024 lds
  v_mfma_f32_16x16x32_bf16 v[144:147], a[232:235], a[32:35], v[144:147]
  ds_read_b64_tr_b16 a[206:207], v36 offset:58368
  v_mfma_f32_16x16x32_bf16 v[144:147], a[236:239], a[48:51], v[144:147]
  s_waitcnt lgkmcnt(14)
  v_mfma_f32_16x16x32_bf16 v[160:163], a[240:243], a[32:35], v[160:163]
  s_waitcnt lgkmcnt(12)
  ds_read_b64_tr_b16 a[208:209], v36 offset:57352
  v_mfma_f32_16x16x32_bf16 v[160:163], a[244:247], a[48:51], v[160:163]
  v_mfma_f32_16x16x32_bf16 v[164:167], a[240:243], a[36:39], v[164:167]
  ds_read_b64_tr_b16 a[210:211], v36 offset:58376
  v_mfma_f32_16x16x32_bf16 v[164:167], a[244:247], a[52:55], v[164:167]
  buffer_load_dwordx4 v15, s[4:7], s24 offen offset:2048 lds
  v_mfma_f32_16x16x32_bf16 v[168:171], a[240:243], a[40:43], v[168:171]
  ds_read_b64_tr_b16 a[212:213], v36 offset:49160
  v_mfma_f32_16x16x32_bf16 v[168:171], a[244:247], a[56:59], v[168:171]
  v_mfma_f32_16x16x32_bf16 v[172:175], a[240:243], a[44:47], v[172:175]
  ds_read_b64_tr_b16 a[214:215], v36 offset:50184
  v_mfma_f32_16x16x32_bf16 v[172:175], a[244:247], a[60:63], v[172:175]
  s_waitcnt lgkmcnt(14)
  buffer_load_dwordx4 v16, s[4:7], s24 offen offset:3072 lds
  v_mfma_f32_16x16x32_bf16 v[188:191], a[248:251], a[44:47], v[188:191]
  s_waitcnt lgkmcnt(12)
  s_add_u32 s24, s24, 16384
  ds_read_b64_tr_b16 a[216:217], v36 offset:40968
  v_mfma_f32_16x16x32_bf16 v[188:191], a[252:255], a[60:63], v[188:191]
  v_mfma_f32_16x16x32_bf16 v[184:187], a[248:251], a[40:43], v[184:187]
  ds_read_b64_tr_b16 a[218:219], v36 offset:41992
  v_mfma_f32_16x16x32_bf16 v[184:187], a[252:255], a[56:59], v[184:187]
  v_mfma_f32_16x16x32_bf16 v[180:183], a[248:251], a[36:39], v[180:183]
  s_add_u32 m0, s26, 16384
  ds_read_b64_tr_b16 a[220:221], v36 offset:32776
  v_mfma_f32_16x16x32_bf16 v[180:183], a[252:255], a[52:55], v[180:183]
  buffer_load_dwordx4 v13, s[4:7], s24 offen offset:0 lds
  v_mfma_f32_16x16x32_bf16 v[176:179], a[248:251], a[32:35], v[176:179]
  ds_read_b64_tr_b16 a[222:223], v36 offset:33800
  v_mfma_f32_16x16x32_bf16 v[176:179], a[252:255], a[48:51], v[176:179]
  s_waitcnt vmcnt(20) lgkmcnt(14)
  v_mfma_f32_16x16x32_bf16 v[64:67], a[192:195], a[64:67], v[64:67]
  s_waitcnt vmcnt(16) lgkmcnt(12)
  ds_read_b64_tr_b16 a[224:225], v37 offset:32768
  v_mfma_f32_16x16x32_bf16 v[64:67], a[196:199], a[80:83], v[64:67]
  s_waitcnt vmcnt(12) lgkmcnt(11)
  buffer_load_dwordx4 v14, s[4:7], s24 offen offset:1024 lds
  v_mfma_f32_16x16x32_bf16 v[64:67], a[200:203], a[96:99], v[64:67]
  s_waitcnt vmcnt(9) lgkmcnt(9)
  ds_read_b64_tr_b16 a[226:227], v37 offset:33792
  v_mfma_f32_16x16x32_bf16 v[64:67], a[204:207], a[112:115], v[64:67]
  s_waitcnt vmcnt(8)
  v_mfma_f32_16x16x32_bf16 v[68:71], a[204:207], a[116:119], v[68:71]
  ds_read_b64_tr_b16 a[228:229], v37 offset:40960
  v_mfma_f32_16x16x32_bf16 v[68:71], a[200:203], a[100:103], v[68:71]
  v_mfma_f32_16x16x32_bf16 v[68:71], a[196:199], a[84:87], v[68:71]
  ds_read_b64_tr_b16 a[230:231], v37 offset:41984
  v_mfma_f32_16x16x32_bf16 v[68:71], a[192:195], a[68:71], v[68:71]
  buffer_load_dwordx4 v15, s[4:7], s24 offen offset:2048 lds
  v_mfma_f32_16x16x32_bf16 v[72:75], a[192:195], a[72:75], v[72:75]
  ds_read_b64_tr_b16 a[232:233], v37 offset:49152
  v_mfma_f32_16x16x32_bf16 v[72:75], a[196:199], a[88:91], v[72:75]
  v_mfma_f32_16x16x32_bf16 v[72:75], a[200:203], a[104:107], v[72:75]
  s_waitcnt vmcnt(8)
  ds_read_b64_tr_b16 a[234:235], v37 offset:50176
  v_mfma_f32_16x16x32_bf16 v[72:75], a[204:207], a[120:123], v[72:75]
  s_waitcnt vmcnt(7)
  buffer_load_dwordx4 v16, s[4:7], s24 offen offset:3072 lds
  v_mfma_f32_16x16x32_bf16 v[76:79], a[204:207], a[124:127], v[76:79]
  s_add_u32 s24, s24, 16384
  ds_read_b64_tr_b16 a[236:237], v37 offset:57344
  v_mfma_f32_16x16x32_bf16 v[76:79], a[200:203], a[108:111], v[76:79]
  v_mfma_f32_16x16x32_bf16 v[76:79], a[196:199], a[92:95], v[76:79]
  ds_read_b64_tr_b16 a[238:239], v37 offset:58368
  v_mfma_f32_16x16x32_bf16 v[76:79], a[192:195], a[76:79], v[76:79]
  s_waitcnt lgkmcnt(14)
  v_mfma_f32_16x16x32_bf16 v[92:95], a[208:211], a[124:127], v[92:95]
  s_waitcnt lgkmcnt(12)
  s_add_u32 m0, s26, 65536
  ds_read_b64_tr_b16 a[240:241], v37 offset:57352
  v_mfma_f32_16x16x32_bf16 v[92:95], a[212:215], a[108:111], v[92:95]
  s_waitcnt lgkmcnt(11)
  buffer_load_dwordx4 v17, s[8:11], s25 offen offset:0 lds
  v_mfma_f32_16x16x32_bf16 v[92:95], a[216:219], a[92:95], v[92:95]
  s_waitcnt lgkmcnt(9)
  ds_read_b64_tr_b16 a[242:243], v37 offset:58376
  v_mfma_f32_16x16x32_bf16 v[92:95], a[220:223], a[76:79], v[92:95]
  v_mfma_f32_16x16x32_bf16 v[88:91], a[220:223], a[72:75], v[88:91]
  ds_read_b64_tr_b16 a[244:245], v37 offset:49160
  v_mfma_f32_16x16x32_bf16 v[88:91], a[216:219], a[88:91], v[88:91]
  buffer_load_dwordx4 v18, s[8:11], s25 offen offset:1024 lds
  v_mfma_f32_16x16x32_bf16 v[88:91], a[212:215], a[104:107], v[88:91]
  ds_read_b64_tr_b16 a[246:247], v37 offset:50184
  v_mfma_f32_16x16x32_bf16 v[88:91], a[208:211], a[120:123], v[88:91]
  v_mfma_f32_16x16x32_bf16 v[84:87], a[208:211], a[116:119], v[84:87]
  ds_read_b64_tr_b16 a[248:249], v37 offset:40968
  v_cvt_pk_bf16_f32 v240, v76, v77
  v_mfma_f32_16x16x32_bf16 v[84:87], a[212:215], a[100:103], v[84:87]
  v_cvt_pk_bf16_f32 v241, v78, v79
  v_cvt_pk_bf16_f32 v242, v92, v93
  v_mfma_f32_16x16x32_bf16 v[84:87], a[216:219], a[84:87], v[84:87]
  ds_read_b64_tr_b16 a[250:251], v37 offset:41992
  v_cvt_pk_bf16_f32 v243, v94, v95
  v_mfma_f32_16x16x32_bf16 v[84:87], a[220:223], a[68:71], v[84:87]
  buffer_load_dwordx4 v17, s[8:11], s25 offen offset:2048 lds
  v_mfma_f32_16x16x32_bf16 v[80:83], a[220:223], a[64:67], v[80:83]
  ds_read_b64_tr_b16 a[252:253], v37 offset:32776
  v_cvt_pk_bf16_f32 v224, v72, v73
  v_mfma_f32_16x16x32_bf16 v[80:83], a[216:219], a[80:83], v[80:83]
  v_cvt_pk_bf16_f32 v225, v74, v75
  v_cvt_pk_bf16_f32 v226, v88, v89
  v_mfma_f32_16x16x32_bf16 v[80:83], a[212:215], a[96:99], v[80:83]
  ds_read_b64_tr_b16 a[254:255], v37 offset:33800
  v_cvt_pk_bf16_f32 v227, v90, v91
  v_mfma_f32_16x16x32_bf16 v[80:83], a[208:211], a[112:115], v[80:83]
  s_waitcnt lgkmcnt(14)
  buffer_load_dwordx4 v18, s[8:11], s25 offen offset:3072 lds
  v_mfma_f32_16x16x32_bf16 v[96:99], a[224:227], a[64:67], v[96:99]
  s_waitcnt lgkmcnt(12)
  s_add_u32 s25, s25, 16384
  ds_read_b64_tr_b16 a[192:193], v38 offset:32768
  v_cvt_pk_bf16_f32 v208, v68, v69
  v_mfma_f32_16x16x32_bf16 v[96:99], a[228:231], a[80:83], v[96:99]
  s_waitcnt lgkmcnt(11)
  v_cvt_pk_bf16_f32 v209, v70, v71
  v_cvt_pk_bf16_f32 v210, v84, v85
  v_mfma_f32_16x16x32_bf16 v[96:99], a[232:235], a[96:99], v[96:99]
  s_waitcnt lgkmcnt(9)
  ds_read_b64_tr_b16 a[194:195], v38 offset:33792
  v_cvt_pk_bf16_f32 v211, v86, v87
  v_mfma_f32_16x16x32_bf16 v[96:99], a[236:239], a[112:115], v[96:99]
  v_mfma_f32_16x16x32_bf16 v[100:103], a[236:239], a[116:119], v[100:103]
  s_add_u32 m0, s26, 32768
  ds_read_b64_tr_b16 a[196:197], v38 offset:40960
  v_cvt_pk_bf16_f32 v192, v64, v65
  v_mfma_f32_16x16x32_bf16 v[100:103], a[232:235], a[100:103], v[100:103]
  buffer_load_dwordx4 v13, s[4:7], s24 offen offset:0 lds
  v_mfma_f32_16x16x32_bf16 v[100:103], a[228:231], a[84:87], v[100:103]
  ds_read_b64_tr_b16 a[198:199], v38 offset:41984
  v_cvt_pk_bf16_f32 v193, v66, v67
  v_mfma_f32_16x16x32_bf16 v[100:103], a[224:227], a[68:71], v[100:103]
  v_cvt_pk_bf16_f32 v194, v80, v81
  v_cvt_pk_bf16_f32 v195, v82, v83
  v_mfma_f32_16x16x32_bf16 v[104:107], a[224:227], a[72:75], v[104:107]
  ds_read_b64_tr_b16 a[200:201], v38 offset:49152
  v_mfma_f32_16x16x32_bf16 v[104:107], a[228:231], a[88:91], v[104:107]
  buffer_load_dwordx4 v14, s[4:7], s24 offen offset:1024 lds
  v_mfma_f32_16x16x32_bf16 v[104:107], a[232:235], a[104:107], v[104:107]
  ds_read_b64_tr_b16 a[202:203], v38 offset:50176
  v_mfma_f32_16x16x32_bf16 v[104:107], a[236:239], a[120:123], v[104:107]
  v_mfma_f32_16x16x32_bf16 v[108:111], a[236:239], a[124:127], v[108:111]
  ds_read_b64_tr_b16 a[204:205], v38 offset:57344
  v_mfma_f32_16x16x32_bf16 v[108:111], a[232:235], a[108:111], v[108:111]
  v_mfma_f32_16x16x32_bf16 v[108:111], a[228:231], a[92:95], v[108:111]
  ds_read_b64_tr_b16 a[206:207], v38 offset:58368
  v_mfma_f32_16x16x32_bf16 v[108:111], a[224:227], a[76:79], v[108:111]
  s_waitcnt lgkmcnt(14)
  buffer_load_dwordx4 v15, s[4:7], s24 offen offset:2048 lds
  v_mfma_f32_16x16x32_bf16 v[124:127], a[240:243], a[124:127], v[124:127]
  s_waitcnt lgkmcnt(12)
  ds_read_b64_tr_b16 a[208:209], v38 offset:57352
  v_mfma_f32_16x16x32_bf16 v[124:127], a[244:247], a[108:111], v[124:127]
  s_waitcnt lgkmcnt(11)
  v_mfma_f32_16x16x32_bf16 v[124:127], a[248:251], a[92:95], v[124:127]
  s_waitcnt lgkmcnt(9)
  ds_read_b64_tr_b16 a[210:211], v38 offset:58376
  v_mfma_f32_16x16x32_bf16 v[124:127], a[252:255], a[76:79], v[124:127]
  buffer_load_dwordx4 v16, s[4:7], s24 offen offset:3072 lds
  v_mfma_f32_16x16x32_bf16 v[120:123], a[252:255], a[72:75], v[120:123]
  s_add_u32 s24, s24, 16384
  ds_read_b64_tr_b16 a[212:213], v38 offset:49160
  v_mfma_f32_16x16x32_bf16 v[120:123], a[248:251], a[88:91], v[120:123]
  v_mfma_f32_16x16x32_bf16 v[120:123], a[244:247], a[104:107], v[120:123]
  ds_read_b64_tr_b16 a[214:215], v38 offset:50184
  v_mfma_f32_16x16x32_bf16 v[120:123], a[240:243], a[120:123], v[120:123]
  v_mfma_f32_16x16x32_bf16 v[116:119], a[240:243], a[116:119], v[116:119]
  s_add_u32 m0, s26, 81920
  ds_read_b64_tr_b16 a[216:217], v38 offset:40968
  v_cvt_pk_bf16_f32 v244, v108, v109
  v_mfma_f32_16x16x32_bf16 v[116:119], a[244:247], a[100:103], v[116:119]
  buffer_load_dwordx4 v17, s[8:11], s25 offen offset:0 lds
  v_mfma_f32_16x16x32_bf16 v[116:119], a[248:251], a[84:87], v[116:119]
  ds_read_b64_tr_b16 a[218:219], v38 offset:41992
  v_cvt_pk_bf16_f32 v245, v110, v111
  v_mfma_f32_16x16x32_bf16 v[116:119], a[252:255], a[68:71], v[116:119]
  v_cvt_pk_bf16_f32 v246, v124, v125
  v_cvt_pk_bf16_f32 v247, v126, v127
  v_mfma_f32_16x16x32_bf16 v[112:115], a[252:255], a[64:67], v[112:115]
  ds_read_b64_tr_b16 a[220:221], v38 offset:32776
  v_cvt_pk_bf16_f32 v228, v104, v105
  v_mfma_f32_16x16x32_bf16 v[112:115], a[248:251], a[80:83], v[112:115]
  buffer_load_dwordx4 v18, s[8:11], s25 offen offset:1024 lds
  v_mfma_f32_16x16x32_bf16 v[112:115], a[244:247], a[96:99], v[112:115]
  ds_read_b64_tr_b16 a[222:223], v38 offset:33800
  v_cvt_pk_bf16_f32 v229, v106, v107
  v_mfma_f32_16x16x32_bf16 v[112:115], a[240:243], a[112:115], v[112:115]
  s_waitcnt lgkmcnt(14)
  v_cvt_pk_bf16_f32 v230, v120, v121
  v_cvt_pk_bf16_f32 v231, v122, v123
  v_mfma_f32_16x16x32_bf16 v[128:131], a[192:195], a[64:67], v[128:131]
  s_waitcnt lgkmcnt(12)
  ds_read_b64_tr_b16 a[224:225], v39 offset:32768
  v_cvt_pk_bf16_f32 v212, v100, v101
  v_mfma_f32_16x16x32_bf16 v[128:131], a[196:199], a[80:83], v[128:131]
  s_waitcnt lgkmcnt(11)
  v_cvt_pk_bf16_f32 v213, v102, v103
  v_cvt_pk_bf16_f32 v214, v116, v117
  v_mfma_f32_16x16x32_bf16 v[128:131], a[200:203], a[96:99], v[128:131]
  s_waitcnt lgkmcnt(9)
  ds_read_b64_tr_b16 a[226:227], v39 offset:33792
  v_cvt_pk_bf16_f32 v215, v118, v119
  v_mfma_f32_16x16x32_bf16 v[128:131], a[204:207], a[112:115], v[128:131]
  buffer_load_dwordx4 v17, s[8:11], s25 offen offset:2048 lds
  v_mfma_f32_16x16x32_bf16 v[132:135], a[204:207], a[116:119], v[132:135]
  ds_read_b64_tr_b16 a[228:229], v39 offset:40960
  v_cvt_pk_bf16_f32 v196, v96, v97
  v_mfma_f32_16x16x32_bf16 v[132:135], a[200:203], a[100:103], v[132:135]
  v_cvt_pk_bf16_f32 v197, v98, v99
  v_cvt_pk_bf16_f32 v198, v112, v113
  v_mfma_f32_16x16x32_bf16 v[132:135], a[196:199], a[84:87], v[132:135]
  ds_read_b64_tr_b16 a[230:231], v39 offset:41984
  v_cvt_pk_bf16_f32 v199, v114, v115
  v_mfma_f32_16x16x32_bf16 v[132:135], a[192:195], a[68:71], v[132:135]
  buffer_load_dwordx4 v18, s[8:11], s25 offen offset:3072 lds
  v_mfma_f32_16x16x32_bf16 v[136:139], a[192:195], a[72:75], v[136:139]
  s_add_u32 s25, s25, 16384
  ds_read_b64_tr_b16 a[232:233], v39 offset:49152
  v_mfma_f32_16x16x32_bf16 v[136:139], a[196:199], a[88:91], v[136:139]
  v_mfma_f32_16x16x32_bf16 v[136:139], a[200:203], a[104:107], v[136:139]
  ds_read_b64_tr_b16 a[234:235], v39 offset:50176
  v_mfma_f32_16x16x32_bf16 v[136:139], a[204:207], a[120:123], v[136:139]
  v_mfma_f32_16x16x32_bf16 v[140:143], a[204:207], a[124:127], v[140:143]
  ds_read_b64_tr_b16 a[236:237], v39 offset:57344
  v_mfma_f32_16x16x32_bf16 v[140:143], a[200:203], a[108:111], v[140:143]
  v_mfma_f32_16x16x32_bf16 v[140:143], a[196:199], a[92:95], v[140:143]
  ds_read_b64_tr_b16 a[238:239], v39 offset:58368
  v_mfma_f32_16x16x32_bf16 v[140:143], a[192:195], a[76:79], v[140:143]
  s_waitcnt lgkmcnt(14)
  v_mfma_f32_16x16x32_bf16 v[156:159], a[208:211], a[124:127], v[156:159]
  s_waitcnt lgkmcnt(12)
  ds_read_b64_tr_b16 a[240:241], v39 offset:57352
  v_mfma_f32_16x16x32_bf16 v[156:159], a[212:215], a[108:111], v[156:159]
  s_waitcnt lgkmcnt(11)
  v_mfma_f32_16x16x32_bf16 v[156:159], a[216:219], a[92:95], v[156:159]
  s_waitcnt lgkmcnt(9)
  ds_read_b64_tr_b16 a[242:243], v39 offset:58376
  v_mfma_f32_16x16x32_bf16 v[156:159], a[220:223], a[76:79], v[156:159]
  v_mfma_f32_16x16x32_bf16 v[152:155], a[220:223], a[72:75], v[152:155]
  ds_read_b64_tr_b16 a[244:245], v39 offset:49160
  v_mfma_f32_16x16x32_bf16 v[152:155], a[216:219], a[88:91], v[152:155]
  v_mfma_f32_16x16x32_bf16 v[152:155], a[212:215], a[104:107], v[152:155]
  ds_read_b64_tr_b16 a[246:247], v39 offset:50184
  v_mfma_f32_16x16x32_bf16 v[152:155], a[208:211], a[120:123], v[152:155]
  v_mfma_f32_16x16x32_bf16 v[148:151], a[208:211], a[116:119], v[148:151]
  ds_read_b64_tr_b16 a[248:249], v39 offset:40968
  v_cvt_pk_bf16_f32 v248, v140, v141
  v_mfma_f32_16x16x32_bf16 v[148:151], a[212:215], a[100:103], v[148:151]
  v_cvt_pk_bf16_f32 v249, v142, v143
  v_cvt_pk_bf16_f32 v250, v156, v157
  v_mfma_f32_16x16x32_bf16 v[148:151], a[216:219], a[84:87], v[148:151]
  ds_read_b64_tr_b16 a[250:251], v39 offset:41992
  v_cvt_pk_bf16_f32 v251, v158, v159
  v_mfma_f32_16x16x32_bf16 v[148:151], a[220:223], a[68:71], v[148:151]
  v_mfma_f32_16x16x32_bf16 v[144:147], a[220:223], a[64:67], v[144:147]
  ds_read_b64_tr_b16 a[252:253], v39 offset:32776
  v_cvt_pk_bf16_f32 v232, v136, v137
  v_mfma_f32_16x16x32_bf16 v[144:147], a[216:219], a[80:83], v[144:147]
  v_cvt_pk_bf16_f32 v233, v138, v139
  v_cvt_pk_bf16_f32 v234, v152, v153
  v_mfma_f32_16x16x32_bf16 v[144:147], a[212:215], a[96:99], v[144:147]
  ds_read_b64_tr_b16 a[254:255], v39 offset:33800
  v_cvt_pk_bf16_f32 v235, v154, v155
  v_mfma_f32_16x16x32_bf16 v[144:147], a[208:211], a[112:115], v[144:147]
  s_waitcnt vmcnt(16) lgkmcnt(14)
  s_barrier
  v_mfma_f32_16x16x32_bf16 v[160:163], a[224:227], a[64:67], v[160:163]
  s_waitcnt lgkmcnt(12)
  ds_read_b128 a[128:131], v1 offset:0
  v_cvt_pk_bf16_f32 v216, v132, v133
  v_mfma_f32_16x16x32_bf16 v[160:163], a[228:231], a[80:83], v[160:163]
  s_waitcnt lgkmcnt(11)
  v_cvt_pk_bf16_f32 v217, v134, v135
  v_cvt_pk_bf16_f32 v218, v148, v149
  v_mfma_f32_16x16x32_bf16 v[160:163], a[232:235], a[96:99], v[160:163]
  s_waitcnt lgkmcnt(9)
  ds_read_b128 a[132:135], v2 offset:0
  v_cvt_pk_bf16_f32 v219, v150, v151
  v_mfma_f32_16x16x32_bf16 v[160:163], a[236:239], a[112:115], v[160:163]
  v_mfma_f32_16x16x32_bf16 v[164:167], a[236:239], a[116:119], v[164:167]
  ds_read_b128 a[136:139], v3 offset:0
  v_cvt_pk_bf16_f32 v200, v128, v129
  v_mfma_f32_16x16x32_bf16 v[164:167], a[232:235], a[100:103], v[164:167]
  v_cvt_pk_bf16_f32 v201, v130, v131
  v_cvt_pk_bf16_f32 v202, v144, v145
  v_mfma_f32_16x16x32_bf16 v[164:167], a[228:231], a[84:87], v[164:167]
  ds_read_b128 a[140:143], v4 offset:0
  v_cvt_pk_bf16_f32 v203, v146, v147
  v_mfma_f32_16x16x32_bf16 v[164:167], a[224:227], a[68:71], v[164:167]
  v_mfma_f32_16x16x32_bf16 v[168:171], a[224:227], a[72:75], v[168:171]
  ds_read_b128 a[144:147], v1 offset:4096
  v_mfma_f32_16x16x32_bf16 v[168:171], a[228:231], a[88:91], v[168:171]
  v_mfma_f32_16x16x32_bf16 v[168:171], a[232:235], a[104:107], v[168:171]
  ds_read_b128 a[148:151], v2 offset:4096
  v_mfma_f32_16x16x32_bf16 v[168:171], a[236:239], a[120:123], v[168:171]
  v_mfma_f32_16x16x32_bf16 v[172:175], a[236:239], a[124:127], v[172:175]
  ds_read_b128 a[152:155], v3 offset:4096
  v_mfma_f32_16x16x32_bf16 v[172:175], a[232:235], a[108:111], v[172:175]
  v_mfma_f32_16x16x32_bf16 v[172:175], a[228:231], a[92:95], v[172:175]
  ds_read_b128 a[156:159], v4 offset:4096
  v_mfma_f32_16x16x32_bf16 v[172:175], a[224:227], a[76:79], v[172:175]
  s_waitcnt lgkmcnt(14)
  v_mfma_f32_16x16x32_bf16 v[188:191], a[240:243], a[124:127], v[188:191]
  s_waitcnt lgkmcnt(12)
  ds_read_b128 a[160:163], v1 offset:8192
  v_mfma_f32_16x16x32_bf16 v[188:191], a[244:247], a[108:111], v[188:191]
  s_waitcnt lgkmcnt(11)
  v_mfma_f32_16x16x32_bf16 v[188:191], a[248:251], a[92:95], v[188:191]
  s_waitcnt lgkmcnt(9)
  ds_read_b128 a[164:167], v2 offset:8192
  v_mfma_f32_16x16x32_bf16 v[188:191], a[252:255], a[76:79], v[188:191]
  v_mfma_f32_16x16x32_bf16 v[184:187], a[252:255], a[72:75], v[184:187]
  ds_read_b128 a[168:171], v3 offset:8192
  v_mfma_f32_16x16x32_bf16 v[184:187], a[248:251], a[88:91], v[184:187]
  v_mfma_f32_16x16x32_bf16 v[184:187], a[244:247], a[104:107], v[184:187]
  ds_read_b128 a[172:175], v4 offset:8192
  v_mfma_f32_16x16x32_bf16 v[184:187], a[240:243], a[120:123], v[184:187]
  v_mfma_f32_16x16x32_bf16 v[180:183], a[240:243], a[116:119], v[180:183]
  ds_read_b128 a[176:179], v1 offset:12288
  v_cvt_pk_bf16_f32 v252, v172, v173
  v_mfma_f32_16x16x32_bf16 v[180:183], a[244:247], a[100:103], v[180:183]
  v_cvt_pk_bf16_f32 v253, v174, v175
  v_cvt_pk_bf16_f32 v254, v188, v189
  v_mfma_f32_16x16x32_bf16 v[180:183], a[248:251], a[84:87], v[180:183]
  ds_read_b128 a[180:183], v2 offset:12288
  v_cvt_pk_bf16_f32 v255, v190, v191
  v_mfma_f32_16x16x32_bf16 v[180:183], a[252:255], a[68:71], v[180:183]
  v_mfma_f32_16x16x32_bf16 v[176:179], a[252:255], a[64:67], v[176:179]
  ds_read_b128 a[184:187], v3 offset:12288
  v_cvt_pk_bf16_f32 v236, v168, v169
  v_mfma_f32_16x16x32_bf16 v[176:179], a[248:251], a[80:83], v[176:179]
  v_cvt_pk_bf16_f32 v237, v170, v171
  v_cvt_pk_bf16_f32 v238, v184, v185
  v_mfma_f32_16x16x32_bf16 v[176:179], a[244:247], a[96:99], v[176:179]
  ds_read_b128 a[188:191], v4 offset:12288
  v_cvt_pk_bf16_f32 v239, v186, v187
  v_mfma_f32_16x16x32_bf16 v[176:179], a[240:243], a[112:115], v[176:179]
  s_waitcnt lgkmcnt(15)
  v_mfma_f32_16x16x32_bf16 v[64:67], a[128:131], v[192:195], 0
  s_nop 0
  v_cvt_pk_bf16_f32 v220, v164, v165
  v_cvt_pk_bf16_f32 v221, v166, v167
  v_mfma_f32_16x16x32_bf16 v[68:71], a[128:131], v[208:211], 0
  s_nop 0
  v_cvt_pk_bf16_f32 v222, v180, v181
  v_cvt_pk_bf16_f32 v223, v182, v183
  v_mfma_f32_16x16x32_bf16 v[72:75], a[128:131], v[224:227], 0
  s_nop 0
  v_mfma_f32_16x16x32_bf16 v[76:79], a[128:131], v[240:243], 0
  s_waitcnt lgkmcnt(14)
  s_nop 0
  v_mfma_f32_16x16x32_bf16 v[64:67], a[132:135], v[196:199], v[64:67]
  s_nop 0
  v_cvt_pk_bf16_f32 v204, v160, v161
  v_cvt_pk_bf16_f32 v205, v162, v163
  v_mfma_f32_16x16x32_bf16 v[68:71], a[132:135], v[212:215], v[68:71]
  v_cvt_pk_bf16_f32 v206, v176, v177
  v_cvt_pk_bf16_f32 v207, v178, v179
  v_mfma_f32_16x16x32_bf16 v[72:75], a[132:135], v[228:231], v[72:75]
  v_mfma_f32_16x16x32_bf16 v[76:79], a[132:135], v[244:247], v[76:79]
  s_waitcnt lgkmcnt(13)
  v_mfma_f32_16x16x32_bf16 v[64:67], a[136:139], v[200:203], v[64:67]
  v_mfma_f32_16x16x32_bf16 v[68:71], a[136:139], v[216:219], v[68:71]
  v_mfma_f32_16x16x32_bf16 v[72:75], a[136:139], v[232:235], v[72:75]
  v_mfma_f32_16x16x32_bf16 v[76:79], a[136:139], v[248:251], v[76:79]
  s_waitcnt lgkmcnt(12)
  v_mfma_f32_16x16x32_bf16 v[64:67], a[140:143], v[204:207], v[64:67]
  v_mfma_f32_16x16x32_bf16 v[68:71], a[140:143], v[220:223], v[68:71]
  v_mfma_f32_16x16x32_bf16 v[72:75], a[140:143], v[236:239], v[72:75]
  v_mfma_f32_16x16x32_bf16 v[76:79], a[140:143], v[252:255], v[76:79]
  s_getpc_b64 s[12:13]
L_pc2:
  s_add_u32 s12, s12, L_attn_tailcode-L_pc2
  s_addc_u32 s13, s13, (L_attn_tailcode-L_pc2)>>32
  s_mov_b32 s14, L_attn_codeend-L_attn_tailcode
  s_mov_b32 s15, 0x20000
  s_cmp_lg_u32 s28, 0
  s_cbranch_scc1 L_attn_fb
  v_max3_f32 v24, v64, v65, v66
  v_max_f32 v24, v24, v67
  v_max3_f32 v25, v68, v69, v70
  v_max_f32 v25, v25, v71
  v_max3_f32 v26, v72, v73, v74
  v_max_f32 v26, v26, v75
  v_max3_f32 v27, v76, v77, v78
  v_max_f32 v27, v27, v79
L_attn_setm:
  v_mov_b32 v48, v24
  v_mov_b32 v49, v25
  v_mov_b32 v50, v26
  v_mov_b32 v51, v27
  v_permlane16_swap_b32 v48, v24
  v_permlane16_swap_b32 v49, v25
  v_permlane16_swap_b32 v50, v26
  v_permlane16_swap_b32 v51, v27
  v_max_f32 v24, v24, v48
  v_max_f32 v25, v25, v49
  v_max_f32 v26, v26, v50
  v_max_f32 v27, v27, v51
  v_mov_b32 v48, v24
  v_mov_b32 v49, v25
  v_mov_b32 v50, v26
  v_mov_b32 v51, v27
  v_permlane32_swap_b32 v48, v24
  v_permlane32_swap_b32 v49, v25
  v_permlane32_swap_b32 v50, v26
  v_permlane32_swap_b32 v51, v27
  v_max_f32 v24, v24, v48
  v_max_f32 v25, v25, v49
  v_max_f32 v26, v26, v50
  v_max_f32 v27, v27, v51
  v_sub_f32 v32, 0xc1a00000, v24
  v_sub_f32 v33, 0xc1a00000, v24
  v_sub_f32 v34, 0xc1a00000, v24
  v_sub_f32 v35, 0xc1a00000, v24
  v_sub_f32 v36, 0xc1a00000, v25
  v_sub_f32 v37, 0xc1a00000, v25
  v_sub_f32 v38, 0xc1a00000, v25
  v_sub_f32 v39, 0xc1a00000, v25
  v_sub_f32 v40, 0xc1a00000, v26
  v_sub_f32 v41, 0xc1a00000, v26
  v_sub_f32 v42, 0xc1a00000, v26
  v_sub_f32 v43, 0xc1a00000, v26
  v_sub_f32 v44, 0xc1a00000, v27
  v_sub_f32 v45, 0xc1a00000, v27
  v_sub_f32 v46, 0xc1a00000, v27
  v_sub_f32 v47, 0xc1a00000, v27
  v_mov_b32 v26, 0
  v_mov_b32 v27, 0
  v_mov_b32 v28, 0
  v_mov_b32 v29, 0
  s_waitcnt lgkmcnt(0)
  s_waitcnt vmcnt(12)
  s_barrier
  s_add_u32 m0, s26, 49152
  s_mov_b32 s23, 6
  v_mfma_f32_16x16x32_bf16 v[64:67], a[128:131], v[192:195], v[32:35]
  buffer_load_dwordx4 v13, s[4:7], s24 offen offset:0 lds
  v_mfma_f32_16x16x32_bf16 v[64:67], a[132:135], v[196:199], v[64:67]
  v_mfma_f32_16x16x32_bf16 v[64:67], a[136:139], v[200:203], v[64:67]
  v_mfma_f32_16x16x32_bf16 v[64:67], a[140:143], v[204:207], v[64:67]
  v_mfma_f32_16x16x32_bf16 v[68:71], a[140:143], v[220:223], v[36:39]
  s_nop 0
  v_mfma_f32_16x16x32_bf16 v[68:71], a[136:139], v[216:219], v[68:71]
  s_nop 0
  v_mfma_f32_16x16x32_bf16 v[68:71], a[132:135], v[212:215], v[68:71]
  s_nop 0
  v_mfma_f32_16x16x32_bf16 v[68:71], a[128:131], v[208:211], v[68:71]
  v_mfma_f32_16x16x32_bf16 v[72:75], a[128:131], v[224:227], v[40:43]
  v_mov_b32 v52, -1
  v_mfma_f32_16x16x32_bf16 v[72:75], a[132:135], v[228:231], v[72:75]
  v_exp_f32 v64, v64
  v_mfma_f32_16x16x32_bf16 v[72:75], a[136:139], v[232:235], v[72:75]
  v_mov_b32 v53, -1
  v_mfma_f32_16x16x32_bf16 v[72:75], a[140:143], v[236:239], v[72:75]
  v_exp_f32 v65, v65
  v_mfma_f32_16x16x32_bf16 v[76:79], a[140:143], v[252:255], v[44:47]
  v_mov_b32 v54, -1
  v_mfma_f32_16x16x32_bf16 v[76:79], a[136:139], v[248:251], v[76:79]
  v_exp_f32 v66, v66
  v_mfma_f32_16x16x32_bf16 v[76:79], a[132:135], v[244:247], v[76:79]
  v_cvt_pk_bf16_f32 v128, v64, v65
  v_mov_b32 v55, -1
  v_mfma_f32_16x16x32_bf16 v[76:79], a[128:131], v[240:243], v[76:79]
  v_exp_f32 v67, v67
  v_mfma_f32_16x16x32_bf16 v[80:83], a[144:147], v[192:195], v[32:35]
  buffer_load_dwordx4 v14, s[4:7], s24 offen offset:1024 lds
  v_mfma_f32_16x16x32_bf16 v[80:83], a[148:151], v[196:199], v[80:83]
  v_exp_f32 v68, v68
  v_mfma_f32_16x16x32_bf16 v[80:83], a[152:155], v[200:203], v[80:83]
  v_cvt_pk_bf16_f32 v129, v66, v67
  v_mfma_f32_16x16x32_bf16 v[80:83], a[156:159], v[204:207], v[80:83]
  v_exp_f32 v69, v69
  v_mfma_f32_16x16x32_bf16 v[84:87], a[156:159], v[220:223], v[36:39]
  v_add_f32 v26, v26, v68
  v_mfma_f32_16x16x32_bf16 v[84:87], a[152:155], v[216:219], v[84:87]
  v_exp_f32 v70, v70
  v_mfma_f32_16x16x32_bf16 v[84:87], a[148:151], v[212:215], v[84:87]
  v_add_f32 v27, v27, v69
  v_mfma_f32_16x16x32_bf16 v[84:87], a[144:147], v[208:211], v[84:87]
  v_exp_f32 v71, v71
  v_mfma_f32_16x16x32_bf16 v[88:91], a[144:147], v[224:227], v[40:43]
  v_cvt_pk_bf16_f32 v136, v68, v69
  v_add_f32 v26, v26, v70
  v_mfma_f32_16x16x32_bf16 v[88:91], a[148:151], v[228:231], v[88:91]
  v_exp_f32 v72, v72
  v_mfma_f32_16x16x32_bf16 v[88:91], a[152:155], v[232:235], v[88:91]
  v_add_f32 v27, v27, v71
  v_mfma_f32_16x16x32_bf16 v[88:91], a[156:159], v[236:239], v[88:91]
  v_exp_f32 v73, v73
  v_mfma_f32_16x16x32_bf16 v[92:95], a[156:159], v[252:255], v[44:47]
  v_cvt_pk_bf16_f32 v137, v70, v71
  v_mfma_f32_16x16x32_bf16 v[92:95], a[152:155], v[248:251], v[92:95]
  v_exp_f32 v74, v74
  v_mfma_f32_16x16x32_bf16 v[92:95], a[148:151], v[244:247], v[92:95]
  v_add_f32 v28, v28, v72
  v_mfma_f32_16x16x32_bf16 v[92:95], a[144:147], v[240:243], v[92:95]
  v_exp_f32 v75, v75
  v_mfma_f32_16x16x32_bf16 v[96:99], a[160:163], v[192:195], v[32:35]
  v_mfma_f32_16x16x32_bf16 v[96:99], a[164:167], v[196:199], v[96:99]
  buffer_load_dwordx4 v15, s[4:7], s24 offen offset:2048 lds
  v_mfma_f32_16x16x32_bf16 v[96:99], a[168:171], v[200:203], v[96:99]
  v_exp_f32 v76, v76
  v_mfma_f32_16x16x32_bf16 v[96:99], a[172:175], v[204:207], v[96:99]
  v_add_f32 v29, v29, v73
  v_mfma_f32_16x16x32_bf16 v[100:103], a[172:175], v[220:223], v[36:39]
  v_exp_f32 v77, v77
  v_mfma_f32_16x16x32_bf16 v[100:103], a[168:171], v[216:219], v[100:103]
  v_cvt_pk_bf16_f32 v144, v72, v73
  v_mfma_f32_16x16x32_bf16 v[100:103], a[164:167], v[212:215], v[100:103]
  v_exp_f32 v78, v78
  v_mfma_f32_16x16x32_bf16 v[100:103], a[160:163], v[208:211], v[100:103]
  v_add_f32 v28, v28, v74
  v_mfma_f32_16x16x32_bf16 v[104:107], a[160:163], v[224:227], v[40:43]
  v_exp_f32 v79, v79
  v_mfma_f32_16x16x32_bf16 v[104:107], a[164:167], v[228:231], v[104:107]
  v_add_f32 v29, v29, v75
  v_cvt_pk_bf16_f32 v145, v74, v75
  v_mfma_f32_16x16x32_bf16 v[104:107], a[168:171], v[232:235], v[104:107]
  v_exp_f32 v80, v80
  v_mfma_f32_16x16x32_bf16 v[104:107], a[172:175], v[236:239], v[104:107]
  v_cvt_pk_bf16_f32 v152, v76, v77
  v_mfma_f32_16x16x32_bf16 v[108:111], a[172:175], v[252:255], v[44:47]
  v_exp_f32 v81, v81
  v_mfma_f32_16x16x32_bf16 v[108:111], a[168:171], v[248:251], v[108:111]
  v_cvt_pk_bf16_f32 v153, v78, v79
  v_mfma_f32_16x16x32_bf16 v[108:111], a[164:167], v[244:247], v[108:111]
  v_exp_f32 v82, v82
  v_mfma_f32_16x16x32_bf16 v[108:111], a[160:163], v[240:243], v[108:111]
  v_cvt_pk_bf16_f32 v130, v80, v81
  v_mfma_f32_16x16x32_bf16 v[112:115], a[176:179], v[192:195], v[32:35]
  v_exp_f32 v83, v83
  v_mfma_f32_16x16x32_bf16 v[112:115], a[180:183], v[196:199], v[112:115]
  buffer_load_dwordx4 v16, s[4:7], s24 offen offset:3072 lds
  v_mfma_f32_16x16x32_bf16 v[112:115], a[184:187], v[200:203], v[112:115]
  s_add_u32 s24, s24, 16384
  v_exp_f32 v84, v84
  v_mfma_f32_16x16x32_bf16 v[112:115], a[188:191], v[204:207], v[112:115]
  v_cvt_pk_bf16_f32 v131, v82, v83
  v_mfma_f32_16x16x32_bf16 v[116:119], a[188:191], v[220:223], v[36:39]
  v_exp_f32 v85, v85
  v_mfma_f32_16x16x32_bf16 v[116:119], a[184:187], v[216:219], v[116:119]
  v_add_f32 v26, v26, v84
  v_mfma_f32_16x16x32_bf16 v[116:119], a[180:183], v[212:215], v[116:119]
  v_exp_f32 v86, v86
  v_mfma_f32_16x16x32_bf16 v[116:119], a[176:179], v[208:211], v[116:119]
  v_add_f32 v27, v27, v85
  v_mfma_f32_16x16x32_bf16 v[120:123], a[176:179], v[224:227], v[40:43]
  v_exp_f32 v87, v87
  v_mfma_f32_16x16x32_bf16 v[120:123], a[180:183], v[228:231], v[120:123]
  v_cvt_pk_bf16_f32 v138, v84, v85
  v_add_f32 v26, v26, v86
  v_mfma_f32_16x16x32_bf16 v[120:123], a[184:187], v[232:235], v[120:123]
  v_exp_f32 v88, v88
  v_mfma_f32_16x16x32_bf16 v[120:123], a[188:191], v[236:239], v[120:123]
  v_add_f32 v27, v27, v87
  v_mfma_f32_16x16x32_bf16 v[124:127], a[188:191], v[252:255], v[44:47]
  v_exp_f32 v89, v89
  v_mfma_f32_16x16x32_bf16 v[124:127], a[184:187], v[248:251], v[124:127]
  v_cvt_pk_bf16_f32 v139, v86, v87
  v_mfma_f32_16x16x32_bf16 v[124:127], a[180:183], v[244:247], v[124:127]
  v_exp_f32 v90, v90
  v_mfma_f32_16x16x32_bf16 v[124:127], a[176:179], v[240:243], v[124:127]
  v_add_f32 v28, v28, v88
  s_add_u32 m0, s26, 98304
  v_exp_f32 v91, v91
  buffer_load_dwordx4 v17, s[8:11], s25 offen offset:0 lds
  v_exp_f32 v92, v92
  v_add_f32 v29, v29, v89
  v_exp_f32 v93, v93
  v_cvt_pk_bf16_f32 v146, v88, v89
  v_exp_f32 v94, v94
  v_add_f32 v28, v28, v90
  v_exp_f32 v95, v95
  v_add_f32 v29, v29, v91
  v_cvt_pk_bf16_f32 v147, v90, v91
  v_exp_f32 v96, v96
  v_cvt_pk_bf16_f32 v154, v92, v93
  v_exp_f32 v97, v97
  v_cvt_pk_bf16_f32 v155, v94, v95
  v_exp_f32 v98, v98
  v_cvt_pk_bf16_f32 v132, v96, v97
  v_exp_f32 v99, v99
  buffer_load_dwordx4 v18, s[8:11], s25 offen offset:1024 lds
  v_exp_f32 v100, v100
  v_cvt_pk_bf16_f32 v133, v98, v99
  v_exp_f32 v101, v101
  v_add_f32 v26, v26, v100
  v_exp_f32 v102, v102
  ds_read_b128 a[128:131], v1 offset:16384
  v_add_f32 v27, v27, v101
  v_exp_f32 v103, v103
  v_cvt_pk_bf16_f32 v140, v100, v101
  v_add_f32 v26, v26, v102
  v_exp_f32 v104, v104
  ds_read_b128 a[132:135], v2 offset:16384
  v_add_f32 v27, v27, v103
  v_exp_f32 v105, v105
  ds_read_b128 a[136:139], v3 offset:16384
  v_cvt_pk_bf16_f32 v141, v102, v103
  v_exp_f32 v106, v106
  ds_read_b128 a[140:143], v4 offset:16384
  v_add_f32 v28, v28, v104
  v_exp_f32 v107, v107
  buffer_load_dwordx4 v17, s[8:11], s25 offen offset:2048 lds
  v_exp_f32 v108, v108
  ds_read_b128 a[144:147], v1 offset:20480
  v_add_f32 v29, v29, v105
  v_exp_f32 v109, v109
  ds_read_b128 a[148:151], v2 offset:20480
  v_cvt_pk_bf16_f32 v148, v104, v105
  v_exp_f32 v110, v110
  ds_read_b128 a[152:155], v3 offset:20480
  v_add_f32 v28, v28, v106
  v_exp_f32 v111, v111
  v_add_f32 v29, v29, v107
  v_cvt_pk_bf16_f32 v149, v106, v107
  v_exp_f32 v112, v112
  ds_read_b128 a[156:159], v4 offset:20480
  v_cvt_pk_bf16_f32 v156, v108, v109
  v_exp_f32 v113, v113
  ds_read_b128 a[160:163], v1 offset:24576
  v_cvt_pk_bf16_f32 v157, v110, v111
  v_exp_f32 v114, v114
  ds_read_b128 a[164:167], v2 offset:24576
  v_cvt_pk_bf16_f32 v134, v112, v113
  v_exp_f32 v115, v115
  buffer_load_dwordx4 v18, s[8:11], s25 offen offset:3072 lds
  s_add_u32 s25, s25, 16384
  v_exp_f32 v116, v116
  ds_read_b128 a[168:171], v3 offset:24576
  v_cvt_pk_bf16_f32 v135, v114, v115
  v_exp_f32 v117, v117
  ds_read_b128 a[172:175], v4 offset:24576
  v_add_f32 v26, v26, v116
  v_exp_f32 v118, v118
  ds_read_b128 a[176:179], v1 offset:28672
  v_add_f32 v27, v27, v117
  v_exp_f32 v119, v119
  v_cvt_pk_bf16_f32 v142, v116, v117
  v_add_f32 v26, v26, v118
  v_exp_f32 v120, v120
  ds_read_b128 a[180:183], v2 offset:28672
  v_add_f32 v27, v27, v119
  v_exp_f32 v121, v121
  ds_read_b128 a[184:187], v3 offset:28672
  v_cvt_pk_bf16_f32 v143, v118, v119
  v_exp_f32 v122, v122
  ds_read_b128 a[188:191], v4 offset:28672
  v_add_f32 v28, v28, v120
  s_add_u32 m0, s26, 0
  v_exp_f32 v123, v123
  s_waitcnt vmcnt(12) lgkmcnt(15)
  s_barrier
  v_mfma_f32_16x16x32_bf16 v[64:67], a[128:131], v[192:195], v[32:35]
  s_waitcnt lgkmcnt(14)
  buffer_load_dwordx4 v13, s[4:7], s24 offen offset:0 lds
  v_mfma_f32_16x16x32_bf16 v[64:67], a[132:135], v[196:199], v[64:67]
  s_waitcnt lgkmcnt(13)
  v_exp_f32 v124, v124
  v_mfma_f32_16x16x32_bf16 v[64:67], a[136:139], v[200:203], v[64:67]
  s_waitcnt lgkmcnt(12)
  ds_read_b64_tr_b16 a[192:193], v5 offset:0
  v_add_f32 v29, v29, v121
  v_mfma_f32_16x16x32_bf16 v[64:67], a[140:143], v[204:207], v[64:67]
  v_exp_f32 v125, v125
  v_mfma_f32_16x16x32_bf16 v[68:71], a[140:143], v[220:223], v[36:39]
  ds_read_b64_tr_b16 a[194:195], v5 offset:4096
  v_cvt_pk_bf16_f32 v150, v120, v121
  v_mfma_f32_16x16x32_bf16 v[68:71], a[136:139], v[216:219], v[68:71]
  v_exp_f32 v126, v126
  v_mfma_f32_16x16x32_bf16 v[68:71], a[132:135], v[212:215], v[68:71]
  ds_read_b64_tr_b16 a[196:197], v5 offset:8192
  v_add_f32 v28, v28, v122
  v_mfma_f32_16x16x32_bf16 v[68:71], a[128:131], v[208:211], v[68:71]
  v_exp_f32 v127, v127
  v_mfma_f32_16x16x32_bf16 v[72:75], a[128:131], v[224:227], v[40:43]
  v_add_f32 v29, v29, v123
  v_cvt_pk_bf16_f32 v151, v122, v123
  v_mfma_f32_16x16x32_bf16 v[72:75], a[132:135], v[228:231], v[72:75]
  v_exp_f32 v64, v64
  v_mfma_f32_16x16x32_bf16 v[72:75], a[136:139], v[232:235], v[72:75]
  ds_read_b64_tr_b16 a[198:199], v5 offset:12288
  v_cvt_pk_bf16_f32 v158, v124, v125
  v_mfma_f32_16x16x32_bf16 v[72:75], a[140:143], v[236:239], v[72:75]
  v_exp_f32 v65, v65
  v_mfma_f32_16x16x32_bf16 v[76:79], a[140:143], v[252:255], v[44:47]
  ds_read_b64_tr_b16 a[200:201], v6 offset:0
  v_cvt_pk_bf16_f32 v159, v126, v127
  v_mfma_f32_16x16x32_bf16 v[76:79], a[136:139], v[248:251], v[76:79]
  v_exp_f32 v66, v66
  v_mfma_f32_16x16x32_bf16 v[76:79], a[132:135], v[244:247], v[76:79]
  ds_read_b64_tr_b16 a[202:203], v6 offset:4096
  v_cvt_pk_bf16_f32 v160, v64, v65
  v_mfma_f32_16x16x32_bf16 v[76:79], a[128:131], v[240:243], v[76:79]
  s_waitcnt lgkmcnt(15)
  v_exp_f32 v67, v67
  v_mfma_f32_16x16x32_bf16 v[80:83], a[144:147], v[192:195], v[32:35]
  buffer_load_dwordx4 v14, s[4:7], s24 offen offset:1024 lds
  v_mfma_f32_16x16x32_bf16 v[80:83], a[148:151], v[196:199], v[80:83]
  v_exp_f32 v68, v68
  v_mfma_f32_16x16x32_bf16 v[80:83], a[152:155], v[200:203], v[80:83]
  s_waitcnt lgkmcnt(14)
  ds_read_b64_tr_b16 a[204:205], v6 offset:8192
  v_cvt_pk_bf16_f32 v161, v66, v67
  v_mfma_f32_16x16x32_bf16 v[80:83], a[156:159], v[204:207], v[80:83]
  v_exp_f32 v69, v69
  v_mfma_f32_16x16x32_bf16 v[84:87], a[156:159], v[220:223], v[36:39]
  s_lshl_b32 s34, s72, 12
  ds_read_b64_tr_b16 a[206:207], v6 offset:12288
  v_add_f32 v26, v26, v68
  v_mfma_f32_16x16x32_bf16 v[84:87], a[152:155], v[216:219], v[84:87]
  s_lshl_b32 s35, s20, 10
  v_exp_f32 v70, v70
  v_mfma_f32_16x16x32_bf16 v[84:87], a[148:151], v[212:215], v[84:87]
  s_add_u32 s34, s34, s35
  ds_read_b64_tr_b16 a[208:209], v7 offset:0
  v_add_f32 v27, v27, v69
  v_mfma_f32_16x16x32_bf16 v[84:87], a[144:147], v[208:211], v[84:87]
  s_add_u32 s34, s34, 29360128
  v_exp_f32 v71, v71
  v_mfma_f32_16x16x32_bf16 v[88:91], a[144:147], v[224:227], v[40:43]
  v_cvt_pk_bf16_f32 v168, v68, v69
  v_add_f32 v26, v26, v70
  v_mfma_f32_16x16x32_bf16 v[88:91], a[148:151], v[228:231], v[88:91]
  v_exp_f32 v72, v72
  v_mfma_f32_16x16x32_bf16 v[88:91], a[152:155], v[232:235], v[88:91]
  ds_read_b64_tr_b16 a[210:211], v7 offset:4096
  v_add_f32 v27, v27, v71
  v_mfma_f32_16x16x32_bf16 v[88:91], a[156:159], v[236:239], v[88:91]
  v_exp_f32 v73, v73
  v_mfma_f32_16x16x32_bf16 v[92:95], a[156:159], v[252:255], v[44:47]
  ds_read_b64_tr_b16 a[212:213], v7 offset:8192
  v_cvt_pk_bf16_f32 v169, v70, v71
  v_mfma_f32_16x16x32_bf16 v[92:95], a[152:155], v[248:251], v[92:95]
  v_exp_f32 v74, v74
  v_mfma_f32_16x16x32_bf16 v[92:95], a[148:151], v[244:247], v[92:95]
  ds_read_b64_tr_b16 a[214:215], v7 offset:12288
  v_add_f32 v28, v28, v72
  v_mfma_f32_16x16x32_bf16 v[92:95], a[144:147], v[240:243], v[92:95]
  s_waitcnt lgkmcnt(15)
  v_exp_f32 v75, v75
  v_mfma_f32_16x16x32_bf16 v[96:99], a[160:163], v[192:195], v[32:35]
  v_lshrrev_b32 v58, 8, v0
  v_lshlrev_b32 v59, 3, v0
  v_mfma_f32_16x16x32_bf16 v[96:99], a[164:167], v[196:199], v[96:99]
  buffer_load_dwordx4 v15, s[4:7], s24 offen offset:2048 lds
  v_mfma_f32_16x16x32_bf16 v[96:99], a[168:171], v[200:203], v[96:99]
  v_exp_f32 v76, v76
  v_mfma_f32_16x16x32_bf16 v[96:99], a[172:175], v[204:207], v[96:99]
  ds_read_b64_tr_b16 a[216:217], v8 offset:0
  v_add_f32 v29, v29, v73
  v_mfma_f32_16x16x32_bf16 v[100:103], a[172:175], v[220:223], v[36:39]
  v_exp_f32 v77, v77
  v_mfma_f32_16x16x32_bf16 v[100:103], a[168:171], v[216:219], v[100:103]
  ds_read_b64_tr_b16 a[218:219], v8 offset:4096
  v_cvt_pk_bf16_f32 v176, v72, v73
  v_mfma_f32_16x16x32_bf16 v[100:103], a[164:167], v[212:215], v[100:103]
  v_exp_f32 v78, v78
  v_mfma_f32_16x16x32_bf16 v[100:103], a[160:163], v[208:211], v[100:103]
  ds_read_b64_tr_b16 a[220:221], v8 offset:8192
  v_add_f32 v28, v28, v74
  v_mfma_f32_16x16x32_bf16 v[104:107], a[160:163], v[224:227], v[40:43]
  v_exp_f32 v79, v79
  v_mfma_f32_16x16x32_bf16 v[104:107], a[164:167], v[228:231], v[104:107]
  v_add_f32 v29, v29, v75
  v_cvt_pk_bf16_f32 v177, v74, v75
  v_mfma_f32_16x16x32_bf16 v[104:107], a[168:171], v[232:235], v[104:107]
  v_exp_f32 v80, v80
  v_mfma_f32_16x16x32_bf16 v[104:107], a[172:175], v[236:239], v[104:107]
  ds_read_b64_tr_b16 a[222:223], v8 offset:12288
  v_cvt_pk_bf16_f32 v184, v76, v77
  v_mfma_f32_16x16x32_bf16 v[108:111], a[172:175], v[252:255], v[44:47]
  v_exp_f32 v81, v81
  v_mfma_f32_16x16x32_bf16 v[108:111], a[168:171], v[248:251], v[108:111]
  ds_read_b64_tr_b16 a[224:225], v9 offset:0
  v_cvt_pk_bf16_f32 v185, v78, v79
  v_mfma_f32_16x16x32_bf16 v[108:111], a[164:167], v[244:247], v[108:111]
  v_exp_f32 v82, v82
  v_mfma_f32_16x16x32_bf16 v[108:111], a[160:163], v[240:243], v[108:111]
  ds_read_b64_tr_b16 a[226:227], v9 offset:4096
  v_cvt_pk_bf16_f32 v162, v80, v81
  v_mfma_f32_16x16x32_bf16 v[112:115], a[176:179], v[192:195], v[32:35]
  s_waitcnt lgkmcnt(15)
  v_exp_f32 v83, v83
  v_mfma_f32_16x16x32_bf16 v[112:115], a[180:183], v[196:199], v[112:115]
  buffer_load_dwordx4 v16, s[4:7], s24 offen offset:3072 lds
  v_mfma_f32_16x16x32_bf16 v[112:115], a[184:187], v[200:203], v[112:115]
  s_add_u32 s24, s24, 16384
  v_exp_f32 v84, v84
  v_mfma_f32_16x16x32_bf16 v[112:115], a[188:191], v[204:207], v[112:115]
  ds_read_b64_tr_b16 a[228:229], v9 offset:8192
  v_cvt_pk_bf16_f32 v163, v82, v83
  v_mfma_f32_16x16x32_bf16 v[116:119], a[188:191], v[220:223], v[36:39]
  v_exp_f32 v85, v85
  v_mfma_f32_16x16x32_bf16 v[116:119], a[184:187], v[216:219], v[116:119]
  ds_read_b64_tr_b16 a[230:231], v9 offset:12288
  v_add_f32 v26, v26, v84
  v_mfma_f32_16x16x32_bf16 v[116:119], a[180:183], v[212:215], v[116:119]
  v_exp_f32 v86, v86
  v_mfma_f32_16x16x32_bf16 v[116:119], a[176:179], v[208:211], v[116:119]
  ds_read_b64_tr_b16 a[232:233], v10 offset:0
  v_add_f32 v27, v27, v85
  v_mfma_f32_16x16x32_bf16 v[120:123], a[176:179], v[224:227], v[40:43]
  v_exp_f32 v87, v87
  v_mfma_f32_16x16x32_bf16 v[120:123], a[180:183], v[228:231], v[120:123]
  v_cvt_pk_bf16_f32 v170, v84, v85
  v_add_f32 v26, v26, v86
  v_mfma_f32_16x16x32_bf16 v[120:123], a[184:187], v[232:235], v[120:123]
  v_exp_f32 v88, v88
  v_mfma_f32_16x16x32_bf16 v[120:123], a[188:191], v[236:239], v[120:123]
  ds_read_b64_tr_b16 a[234:235], v10 offset:4096
  v_add_f32 v27, v27, v87
  v_mfma_f32_16x16x32_bf16 v[124:127], a[188:191], v[252:255], v[44:47]
  v_exp_f32 v89, v89
  v_mfma_f32_16x16x32_bf16 v[124:127], a[184:187], v[248:251], v[124:127]
  ds_read_b64_tr_b16 a[236:237], v10 offset:8192
  v_cvt_pk_bf16_f32 v171, v86, v87
  v_mfma_f32_16x16x32_bf16 v[124:127], a[180:183], v[244:247], v[124:127]
  v_exp_f32 v90, v90
  v_mfma_f32_16x16x32_bf16 v[124:127], a[176:179], v[240:243], v[124:127]
  ds_read_b64_tr_b16 a[238:239], v10 offset:12288
  v_add_f32 v28, v28, v88
  v_mfma_f32_16x16x32_bf16 a[0:3], a[192:195], v[128:131], 0
  s_waitcnt lgkmcnt(15)
  s_add_u32 m0, s26, 114688
  v_exp_f32 v91, v91
  v_mfma_f32_16x16x32_bf16 a[0:3], a[196:199], v[132:135], a[0:3]
  buffer_store_dwordx4 v[52:55], v0, s[16:19], s34 offen sc1
  v_mfma_f32_16x16x32_bf16 a[4:7], a[192:195], v[136:139], 0
  buffer_load_dwordx4 v17, s[8:11], s25 offen offset:0 lds
  v_mfma_f32_16x16x32_bf16 a[4:7], a[196:199], v[140:143], a[4:7]
  v_exp_f32 v92, v92
  v_mfma_f32_16x16x32_bf16 a[8:11], a[192:195], v[144:147], 0
  ds_read_b64_tr_b16 a[240:241], v11 offset:0
  v_add_f32 v29, v29, v89
  v_mfma_f32_16x16x32_bf16 a[8:11], a[196:199], v[148:151], a[8:11]
  v_exp_f32 v93, v93
  v_mfma_f32_16x16x32_bf16 a[12:15], a[192:195], v[152:155], 0
  ds_read_b64_tr_b16 a[242:243], v11 offset:4096
  v_cvt_pk_bf16_f32 v178, v88, v89
  v_mfma_f32_16x16x32_bf16 a[12:15], a[196:199], v[156:159], a[12:15]
  v_exp_f32 v94, v94
  v_mfma_f32_16x16x32_bf16 v[60:63], v[20:23], v[152:155], 0
  ds_read_b64_tr_b16 a[244:245], v11 offset:8192
  v_add_f32 v28, v28, v90
  v_mfma_f32_16x16x32_bf16 v[60:63], v[20:23], v[156:159], v[60:63]
  v_exp_f32 v95, v95
  v_mfma_f32_16x16x32_bf16 a[28:31], a[200:203], v[152:155], 0
  v_add_f32 v29, v29, v91
  v_cvt_pk_bf16_f32 v179, v90, v91
  v_mfma_f32_16x16x32_bf16 a[28:31], a[204:207], v[156:159], a[28:31]
  v_exp_f32 v96, v96
  v_mfma_f32_16x16x32_bf16 a[24:27], a[200:203], v[144:147], 0
  ds_read_b64_tr_b16 a[246:247], v11 offset:12288
  v_cvt_pk_bf16_f32 v186, v92, v93
  v_mfma_f32_16x16x32_bf16 a[24:27], a[204:207], v[148:151], a[24:27]
  v_exp_f32 v97, v97
  v_mfma_f32_16x16x32_bf16 a[20:23], a[200:203], v[136:139], 0
  ds_read_b64_tr_b16 a[248:249], v12 offset:0
  v_cvt_pk_bf16_f32 v187, v94, v95
  v_mfma_f32_16x16x32_bf16 a[20:23], a[204:207], v[140:143], a[20:23]
  v_exp_f32 v98, v98
  v_mfma_f32_16x16x32_bf16 a[16:19], a[200:203], v[128:131], 0
  ds_read_b64_tr_b16 a[250:251], v12 offset:4096
  v_cvt_pk_bf16_f32 v164, v96, v97
  v_mfma_f32_16x16x32_bf16 a[16:19], a[204:207], v[132:135], a[16:19]
  v_exp_f32 v99, v99
  v_mfma_f32_16x16x32_bf16 v[48:51], v[20:23], v[128:131], 0
  buffer_load_dwordx4 v18, s[8:11], s25 offen offset:1024 lds
  v_mfma_f32_16x16x32_bf16 v[48:51], v[20:23], v[132:135], v[48:51]
  s_waitcnt lgkmcnt(15)
  v_exp_f32 v100, v100
  v_mfma_f32_16x16x32_bf16 a[32:35], a[208:211], v[128:131], 0
  ds_read_b64_tr_b16 a[252:253], v12 offset:8192
  v_cvt_pk_bf16_f32 v165, v98, v99
  v_mfma_f32_16x16x32_bf16 a[32:35], a[212:215], v[132:135], a[32:35]
  v_exp_f32 v101, v101
  v_mfma_f32_16x16x32_bf16 a[36:39], a[208:211], v[136:139], 0
  ds_read_b64_tr_b16 a[254:255], v12 offset:12288
  v_add_f32 v26, v26, v100
  v_mfma_f32_16x16x32_bf16 a[36:39], a[212:215], v[140:143], a[36:39]
  v_exp_f32 v102, v102
  v_mfma_f32_16x16x32_bf16 a[40:43], a[208:211], v[144:147], 0
  ds_read_b128 a[128:131], v1 offset:32768
  v_add_f32 v27, v27, v101
  v_mfma_f32_16x16x32_bf16 a[40:43], a[212:215], v[148:151], a[40:43]
  v_exp_f32 v103, v103
  v_mfma_f32_16x16x32_bf16 a[44:47], a[208:211], v[152:155], 0
  v_cvt_pk_bf16_f32 v172, v100, v101
  v_add_f32 v26, v26, v102
  v_mfma_f32_16x16x32_bf16 a[44:47], a[212:215], v[156:159], a[44:47]
  v_exp_f32 v104, v104
  v_mfma_f32_16x16x32_bf16 a[60:63], a[216:219], v[152:155], 0
  s_waitcnt lgkmcnt(15)
  ds_read_b128 a[132:135], v2 offset:32768
  v_add_f32 v27, v27, v103
  v_mfma_f32_16x16x32_bf16 a[60:63], a[220:223], v[156:159], a[60:63]
  v_exp_f32 v105, v105
  v_mfma_f32_16x16x32_bf16 a[56:59], a[216:219], v[144:147], 0
  ds_read_b128 a[136:139], v3 offset:32768
  v_cvt_pk_bf16_f32 v173, v102, v103
  v_mfma_f32_16x16x32_bf16 a[56:59], a[220:223], v[148:151], a[56:59]
  v_exp_f32 v106, v106
  v_mfma_f32_16x16x32_bf16 a[52:55], a[216:219], v[136:139], 0
  ds_read_b128 a[140:143], v4 offset:32768
  v_add_f32 v28, v28, v104
  v_mfma_f32_16x16x32_bf16 a[52:55], a[220:223], v[140:143], a[52:55]
  v_exp_f32 v107, v107
  v_mfma_f32_16x16x32_bf16 a[48:51], a[216:219], v[128:131], 0
  v_lshl_add_u32 v58, v58, 22, v59
  v_mfma_f32_16x16x32_bf16 a[48:51], a[220:223], v[132:135], a[48:51]
  buffer_load_dwordx4 v17, s[8:11], s25 offen offset:2048 lds
  v_mfma_f32_16x16x32_bf16 a[64:67], a[224:227], v[128:131], 0
  s_waitcnt lgkmcnt(15)
  v_exp_f32 v108, v108
  v_mfma_f32_16x16x32_bf16 a[64:67], a[228:231], v[132:135], a[64:67]
  ds_read_b128 a[144:147], v1 offset:36864
  v_add_f32 v29, v29, v105
  v_mfma_f32_16x16x32_bf16 a[68:71], a[224:227], v[136:139], 0
  v_exp_f32 v109, v109
  v_mfma_f32_16x16x32_bf16 a[68:71], a[228:231], v[140:143], a[68:71]
  ds_read_b128 a[148:151], v2 offset:36864
  v_cvt_pk_bf16_f32 v180, v104, v105
  v_mfma_f32_16x16x32_bf16 a[72:75], a[224:227], v[144:147], 0
  v_exp_f32 v110, v110
  v_mfma_f32_16x16x32_bf16 a[72:75], a[228:231], v[148:151], a[72:75]
  ds_read_b128 a[152:155], v3 offset:36864
  v_add_f32 v28, v28, v106
  v_mfma_f32_16x16x32_bf16 a[76:79], a[224:227], v[152:155], 0
  v_exp_f32 v111, v111
  v_mfma_f32_16x16x32_bf16 a[76:79], a[228:231], v[156:159], a[76:79]
  s_waitcnt lgkmcnt(15)
  v_add_f32 v29, v29, v107
  v_cvt_pk_bf16_f32 v181, v106, v107
  v_mfma_f32_16x16x32_bf16 a[92:95], a[232:235], v[152:155], 0
  v_exp_f32 v112, v112
  v_mfma_f32_16x16x32_bf16 a[92:95], a[236:239], v[156:159], a[92:95]
  ds_read_b128 a[156:159], v4 offset:36864
  v_cvt_pk_bf16_f32 v188, v108, v109
  v_mfma_f32_16x16x32_bf16 a[88:91], a[232:235], v[144:147], 0
  v_exp_f32 v113, v113
  v_mfma_f32_16x16x32_bf16 a[88:91], a[236:239], v[148:151], a[88:91]
  ds_read_b128 a[160:163], v1 offset:40960
  v_cvt_pk_bf16_f32 v189, v110, v111
  v_mfma_f32_16x16x32_bf16 a[84:87], a[232:235], v[136:139], 0
  v_exp_f32 v114, v114
  v_mfma_f32_16x16x32_bf16 a[84:87], a[236:239], v[140:143], a[84:87]
  ds_read_b128 a[164:167], v2 offset:40960
  v_cvt_pk_bf16_f32 v166, v112, v113
  v_mfma_f32_16x16x32_bf16 a[80:83], a[232:235], v[128:131], 0
  v_exp_f32 v115, v115
  v_mfma_f32_16x16x32_bf16 a[80:83], a[236:239], v[132:135], a[80:83]
  s_waitcnt lgkmcnt(15)
  buffer_load_dwordx4 v18, s[8:11], s25 offen offset:3072 lds
  v_mfma_f32_16x16x32_bf16 a[96:99], a[240:243], v[128:131], 0
  s_waitcnt lgkmcnt(14)
  s_add_u32 s25, s25, 16384
  v_exp_f32 v116, v116
  v_mfma_f32_16x16x32_bf16 a[96:99], a[244:247], v[132:135], a[96:99]
  ds_read_b128 a[168:171], v3 offset:40960
  v_cvt_pk_bf16_f32 v167, v114, v115
  v_mfma_f32_16x16x32_bf16 a[100:103], a[240:243], v[136:139], 0
  v_exp_f32 v117, v117
  v_mfma_f32_16x16x32_bf16 a[100:103], a[244:247], v[140:143], a[100:103]
  ds_read_b128 a[172:175], v4 offset:40960
  v_add_f32 v26, v26, v116
  v_mfma_f32_16x16x32_bf16 a[104:107], a[240:243], v[144:147], 0
  v_exp_f32 v118, v118
  v_mfma_f32_16x16x32_bf16 a[104:107], a[244:247], v[148:151], a[104:107]
  ds_read_b128 a[176:179], v1 offset:45056
  v_add_f32 v27, v27, v117
  v_mfma_f32_16x16x32_bf16 a[108:111], a[240:243], v[152:155], 0
  v_exp_f32 v119, v119
  v_mfma_f32_16x16x32_bf16 a[108:111], a[244:247], v[156:159], a[108:111]
  s_waitcnt lgkmcnt(15)
  v_cvt_pk_bf16_f32 v174, v116, v117
  v_add_f32 v26, v26, v118
  v_mfma_f32_16x16x32_bf16 a[124:127], a[248:251], v[152:155], 0
  s_waitcnt lgkmcnt(13)
  v_exp_f32 v120, v120
  v_mfma_f32_16x16x32_bf16 a[124:127], a[252:255], v[156:159], a[124:127]
  ds_read_b128 a[180:183], v2 offset:45056
  v_add_f32 v27, v27, v119
  v_mfma_f32_16x16x32_bf16 a[120:123], a[248:251], v[144:147], 0
  v_exp_f32 v121, v121
  v_mfma_f32_16x16x32_bf16 a[120:123], a[252:255], v[148:151], a[120:123]
  ds_read_b128 a[184:187], v3 offset:45056
  v_cvt_pk_bf16_f32 v175, v118, v119
  v_mfma_f32_16x16x32_bf16 a[116:119], a[248:251], v[136:139], 0
  v_exp_f32 v122, v122
  v_mfma_f32_16x16x32_bf16 a[116:119], a[252:255], v[140:143], a[116:119]
  ds_read_b128 a[188:191], v4 offset:45056
  v_add_f32 v28, v28, v120
  v_mfma_f32_16x16x32_bf16 a[112:115], a[248:251], v[128:131], 0
  s_add_u32 m0, s26, 16384
  v_exp_f32 v123, v123
  v_mfma_f32_16x16x32_bf16 a[112:115], a[252:255], v[132:135], a[112:115]
  s_waitcnt vmcnt(13) lgkmcnt(15)
  s_barrier
.p2align 6
L_attn_loop:
  v_mfma_f32_16x16x32_bf16 v[64:67], a[128:131], v[192:195], v[32:35]
  s_waitcnt lgkmcnt(14)
  buffer_load_dwordx4 v13, s[4:7], s24 offen offset:0 lds
  v_mfma_f32_16x16x32_bf16 v[64:67], a[132:135], v[196:199], v[64:67]
  s_waitcnt lgkmcnt(13)
  v_exp_f32 v124, v124
  v_mfma_f32_16x16x32_bf16 v[64:67], a[136:139], v[200:203], v[64:67]
  s_waitcnt lgkmcnt(12)
  ds_read_b64_tr_b16 a[192:193], v5 offset:16384
  v_add_f32 v29, v29, v121
  v_mfma_f32_16x16x32_bf16 v[64:67], a[140:143], v[204:207], v[64:67]
  v_exp_f32 v125, v125
  v_mfma_f32_16x16x32_bf16 v[68:71], a[140:143], v[220:223], v[36:39]
  ds_read_b64_tr_b16 a[194:195], v5 offset:20480
  v_cvt_pk_bf16_f32 v182, v120, v121
  v_mfma_f32_16x16x32_bf16 v[68:71], a[136:139], v[216:219], v[68:71]
  v_exp_f32 v126, v126
  v_mfma_f32_16x16x32_bf16 v[68:71], a[132:135], v[212:215], v[68:71]
  ds_read_b64_tr_b16 a[196:197], v5 offset:24576
  v_add_f32 v28, v28, v122
  v_mfma_f32_16x16x32_bf16 v[68:71], a[128:131], v[208:211], v[68:71]
  v_exp_f32 v127, v127
  v_mfma_f32_16x16x32_bf16 v[72:75], a[128:131], v[224:227], v[40:43]
  v_add_f32 v29, v29, v123
  v_cvt_pk_bf16_f32 v183, v122, v123
  v_mfma_f32_16x16x32_bf16 v[72:75], a[132:135], v[228:231], v[72:75]
  v_exp_f32 v64, v64
  v_mfma_f32_16x16x32_bf16 v[72:75], a[136:139], v[232:235], v[72:75]
  ds_read_b64_tr_b16 a[198:199], v5 offset:28672
  v_cvt_pk_bf16_f32 v190, v124, v125
  v_mfma_f32_16x16x32_bf16 v[72:75], a[140:143], v[236:239], v[72:75]
  v_exp_f32 v65, v65
  v_mfma_f32_16x16x32_bf16 v[76:79], a[140:143], v[252:255], v[44:47]
  ds_read_b64_tr_b16 a[200:201], v6 offset:16384
  v_cvt_pk_bf16_f32 v191, v126, v127
  v_mfma_f32_16x16x32_bf16 v[76:79], a[136:139], v[248:251], v[76:79]
  v_exp_f32 v66, v66
  v_mfma_f32_16x16x32_bf16 v[76:79], a[132:135], v[244:247], v[76:79]
  ds_read_b64_tr_b16 a[202:203], v6 offset:20480
  v_cvt_pk_bf16_f32 v128, v64, v65
  v_mfma_f32_16x16x32_bf16 v[76:79], a[128:131], v[240:243], v[76:79]
  s_waitcnt lgkmcnt(15)
  v_exp_f32 v67, v67
  v_mfma_f32_16x16x32_bf16 v[80:83], a[144:147], v[192:195], v[32:35]
  buffer_load_dwordx4 v14, s[4:7], s24 offen offset:1024 lds
  v_mfma_f32_16x16x32_bf16 v[80:83], a[148:151], v[196:199], v[80:83]
  v_exp_f32 v68, v68
  v_mfma_f32_16x16x32_bf16 v[80:83], a[152:155], v[200:203], v[80:83]
  s_waitcnt lgkmcnt(14)
  ds_read_b64_tr_b16 a[204:205], v6 offset:24576
  v_cvt_pk_bf16_f32 v129, v66, v67
  v_mfma_f32_16x16x32_bf16 v[80:83], a[156:159], v[204:207], v[80:83]
  v_exp_f32 v69, v69
  v_mfma_f32_16x16x32_bf16 v[84:87], a[156:159], v[220:223], v[36:39]
  ds_read_b64_tr_b16 a[206:207], v6 offset:28672
  v_add_f32 v26, v26, v68
  v_mfma_f32_16x16x32_bf16 v[84:87], a[152:155], v[216:219], v[84:87]
  v_exp_f32 v70, v70
  v_mfma_f32_16x16x32_bf16 v[84:87], a[148:151], v[212:215], v[84:87]
  ds_read_b64_tr_b16 a[208:209], v7 offset:16384
  v_add_f32 v27, v27, v69
  v_mfma_f32_16x16x32_bf16 v[84:87], a[144:147], v[208:211], v[84:87]
  v_exp_f32 v71, v71
  v_mfma_f32_16x16x32_bf16 v[88:91], a[144:147], v[224:227], v[40:43]
  v_cvt_pk_bf16_f32 v136, v68, v69
  v_add_f32 v26, v26, v70
  v_mfma_f32_16x16x32_bf16 v[88:91], a[148:151], v[228:231], v[88:91]
  v_exp_f32 v72, v72
  v_mfma_f32_16x16x32_bf16 v[88:91], a[152:155], v[232:235], v[88:91]
  ds_read_b64_tr_b16 a[210:211], v7 offset:20480
  v_add_f32 v27, v27, v71
  v_mfma_f32_16x16x32_bf16 v[88:91], a[156:159], v[236:239], v[88:91]
  v_exp_f32 v73, v73
  v_mfma_f32_16x16x32_bf16 v[92:95], a[156:159], v[252:255], v[44:47]
  ds_read_b64_tr_b16 a[212:213], v7 offset:24576
  v_cvt_pk_bf16_f32 v137, v70, v71
  v_mfma_f32_16x16x32_bf16 v[92:95], a[152:155], v[248:251], v[92:95]
  v_exp_f32 v74, v74
  v_mfma_f32_16x16x32_bf16 v[92:95], a[148:151], v[244:247], v[92:95]
  ds_read_b64_tr_b16 a[214:215], v7 offset:28672
  v_add_f32 v28, v28, v72
  v_mfma_f32_16x16x32_bf16 v[92:95], a[144:147], v[240:243], v[92:95]
  s_waitcnt lgkmcnt(15)
  v_exp_f32 v75, v75
  v_mfma_f32_16x16x32_bf16 v[96:99], a[160:163], v[192:195], v[32:35]
  v_mfma_f32_16x16x32_bf16 v[96:99], a[164:167], v[196:199], v[96:99]
  buffer_load_dwordx4 v15, s[4:7], s24 offen offset:2048 lds
  v_mfma_f32_16x16x32_bf16 v[96:99], a[168:171], v[200:203], v[96:99]
  v_exp_f32 v76, v76
  v_mfma_f32_16x16x32_bf16 v[96:99], a[172:175], v[204:207], v[96:99]
  ds_read_b64_tr_b16 a[216:217], v8 offset:16384
  v_add_f32 v29, v29, v73
  v_mfma_f32_16x16x32_bf16 v[100:103], a[172:175], v[220:223], v[36:39]
  v_exp_f32 v77, v77
  v_mfma_f32_16x16x32_bf16 v[100:103], a[168:171], v[216:219], v[100:103]
  ds_read_b64_tr_b16 a[218:219], v8 offset:20480
  v_cvt_pk_bf16_f32 v144, v72, v73
  v_mfma_f32_16x16x32_bf16 v[100:103], a[164:167], v[212:215], v[100:103]
  v_exp_f32 v78, v78
  v_mfma_f32_16x16x32_bf16 v[100:103], a[160:163], v[208:211], v[100:103]
  ds_read_b64_tr_b16 a[220:221], v8 offset:24576
  v_add_f32 v28, v28, v74
  v_mfma_f32_16x16x32_bf16 v[104:107], a[160:163], v[224:227], v[40:43]
  v_exp_f32 v79, v79
  v_mfma_f32_16x16x32_bf16 v[104:107], a[164:167], v[228:231], v[104:107]
  v_add_f32 v29, v29, v75
  v_cvt_pk_bf16_f32 v145, v74, v75
  v_mfma_f32_16x16x32_bf16 v[104:107], a[168:171], v[232:235], v[104:107]
  v_exp_f32 v80, v80
  v_mfma_f32_16x16x32_bf16 v[104:107], a[172:175], v[236:239], v[104:107]
  ds_read_b64_tr_b16 a[222:223], v8 offset:28672
  v_cvt_pk_bf16_f32 v152, v76, v77
  v_mfma_f32_16x16x32_bf16 v[108:111], a[172:175], v[252:255], v[44:47]
  v_exp_f32 v81, v81
  v_mfma_f32_16x16x32_bf16 v[108:111], a[168:171], v[248:251], v[108:111]
  ds_read_b64_tr_b16 a[224:225], v9 offset:16384
  v_cvt_pk_bf16_f32 v153, v78, v79
  v_mfma_f32_16x16x32_bf16 v[108:111], a[164:167], v[244:247], v[108:111]
  v_exp_f32 v82, v82
  v_mfma_f32_16x16x32_bf16 v[108:111], a[160:163], v[240:243], v[108:111]
  ds_read_b64_tr_b16 a[226:227], v9 offset:20480
  v_cvt_pk_bf16_f32 v130, v80, v81
  v_mfma_f32_16x16x32_bf16 v[112:115], a[176:179], v[192:195], v[32:35]
  s_waitcnt lgkmcnt(15)
  v_exp_f32 v83, v83
  v_mfma_f32_16x16x32_bf16 v[112:115], a[180:183], v[196:199], v[112:115]
  buffer_load_dwordx4 v16, s[4:7], s24 offen offset:3072 lds
  v_mfma_f32_16x16x32_bf16 v[112:115], a[184:187], v[200:203], v[112:115]
  s_add_u32 s24, s24, 16384
  v_exp_f32 v84, v84
  v_mfma_f32_16x16x32_bf16 v[112:115], a[188:191], v[204:207], v[112:115]
  ds_read_b64_tr_b16 a[228:229], v9 offset:24576
  v_cvt_pk_bf16_f32 v131, v82, v83
  v_mfma_f32_16x16x32_bf16 v[116:119], a[188:191], v[220:223], v[36:39]
  v_exp_f32 v85, v85
  v_mfma_f32_16x16x32_bf16 v[116:119], a[184:187], v[216:219], v[116:119]
  ds_read_b64_tr_b16 a[230:231], v9 offset:28672
  v_add_f32 v26, v26, v84
  v_mfma_f32_16x16x32_bf16 v[116:119], a[180:183], v[212:215], v[116:119]
  v_exp_f32 v86, v86
  v_mfma_f32_16x16x32_bf16 v[116:119], a[176:179], v[208:211], v[116:119]
  ds_read_b64_tr_b16 a[232:233], v10 offset:16384
  v_add_f32 v27, v27, v85
  v_mfma_f32_16x16x32_bf16 v[120:123], a[176:179], v[224:227], v[40:43]
  v_exp_f32 v87, v87
  v_mfma_f32_16x16x32_bf16 v[120:123], a[180:183], v[228:231], v[120:123]
  v_cvt_pk_bf16_f32 v138, v84, v85
  v_add_f32 v26, v26, v86
  v_mfma_f32_16x16x32_bf16 v[120:123], a[184:187], v[232:235], v[120:123]
  v_exp_f32 v88, v88
  v_mfma_f32_16x16x32_bf16 v[120:123], a[188:191], v[236:239], v[120:123]
  ds_read_b64_tr_b16 a[234:235], v10 offset:20480
  v_add_f32 v27, v27, v87
  v_mfma_f32_16x16x32_bf16 v[124:127], a[188:191], v[252:255], v[44:47]
  v_exp_f32 v89, v89
  v_mfma_f32_16x16x32_bf16 v[124:127], a[184:187], v[248:251], v[124:127]
  ds_read_b64_tr_b16 a[236:237], v10 offset:24576
  v_cvt_pk_bf16_f32 v139, v86, v87
  v_mfma_f32_16x16x32_bf16 v[124:127], a[180:183], v[244:247], v[124:127]
  v_exp_f32 v90, v90
  v_mfma_f32_16x16x32_bf16 v[124:127], a[176:179], v[240:243], v[124:127]
  s_mov_b32 m0, s62
  ds_read_b64_tr_b16 a[238:239], v10 offset:28672
  v_add_f32 v28, v28, v88
  v_mfma_f32_16x16x32_bf16 a[0:3], a[192:195], v[160:163], a[0:3]
  s_waitcnt lgkmcnt(15)
  v_exp_f32 v91, v91
  v_mfma_f32_16x16x32_bf16 a[0:3], a[196:199], v[164:167], a[0:3]
  s_bitcmp1_b32 s63, 0
  s_cbranch_scc0 L_fw_s0
  buffer_load_dwordx4 v30, s[64:67], s60 offen lds
  s_add_u32 s60, s60, s61
  s_add_u32 s62, s62, 1024
L_fw_s0:
  s_add_u32 m0, s26, 65536
  v_mfma_f32_16x16x32_bf16 a[4:7], a[192:195], v[168:171], a[4:7]
  buffer_load_dwordx4 v17, s[8:11], s25 offen offset:0 lds
  v_mfma_f32_16x16x32_bf16 a[4:7], a[196:199], v[172:175], a[4:7]
  s_lshr_b32 s63, s63, 1
  v_exp_f32 v92, v92
  v_mfma_f32_16x16x32_bf16 a[8:11], a[192:195], v[176:179], a[8:11]
  ds_read_b64_tr_b16 a[240:241], v11 offset:16384
  v_add_f32 v29, v29, v89
  v_mfma_f32_16x16x32_bf16 a[8:11], a[196:199], v[180:183], a[8:11]
  v_exp_f32 v93, v93
  v_mfma_f32_16x16x32_bf16 a[12:15], a[192:195], v[184:187], a[12:15]
  ds_read_b64_tr_b16 a[242:243], v11 offset:20480
  v_cvt_pk_bf16_f32 v146, v88, v89
  v_mfma_f32_16x16x32_bf16 a[12:15], a[196:199], v[188:191], a[12:15]
  v_exp_f32 v94, v94
  v_mfma_f32_16x16x32_bf16 v[60:63], v[20:23], v[184:187], v[60:63]
  ds_read_b64_tr_b16 a[244:245], v11 offset:24576
  v_add_f32 v28, v28, v90
  v_mfma_f32_16x16x32_bf16 v[60:63], v[20:23], v[188:191], v[60:63]
  v_exp_f32 v95, v95
  v_mfma_f32_16x16x32_bf16 a[28:31], a[200:203], v[184:187], a[28:31]
  v_add_f32 v29, v29, v91
  v_cvt_pk_bf16_f32 v147, v90, v91
  v_mfma_f32_16x16x32_bf16 a[28:31], a[204:207], v[188:191], a[28:31]
  v_exp_f32 v96, v96
  v_mfma_f32_16x16x32_bf16 a[24:27], a[200:203], v[176:179], a[24:27]
  ds_read_b64_tr_b16 a[246:247], v11 offset:28672
  v_cvt_pk_bf16_f32 v154, v92, v93
  v_mfma_f32_16x16x32_bf16 a[24:27], a[204:207], v[180:183], a[24:27]
  v_exp_f32 v97, v97
  v_mfma_f32_16x16x32_bf16 a[20:23], a[200:203], v[168:171], a[20:23]
  ds_read_b64_tr_b16 a[248:249], v12 offset:16384
  v_cvt_pk_bf16_f32 v155, v94, v95
  v_mfma_f32_16x16x32_bf16 a[20:23], a[204:207], v[172:175], a[20:23]
  v_exp_f32 v98, v98
  v_mfma_f32_16x16x32_bf16 a[16:19], a[200:203], v[160:163], a[16:19]
  ds_read_b64_tr_b16 a[250:251], v12 offset:20480
  v_cvt_pk_bf16_f32 v132, v96, v97
  v_mfma_f32_16x16x32_bf16 a[16:19], a[204:207], v[164:167], a[16:19]
  v_exp_f32 v99, v99
  v_mfma_f32_16x16x32_bf16 v[48:51], v[20:23], v[160:163], v[48:51]
  buffer_load_dwordx4 v18, s[8:11], s25 offen offset:1024 lds
  v_mfma_f32_16x16x32_bf16 v[48:51], v[20:23], v[164:167], v[48:51]
  s_waitcnt lgkmcnt(15)
  v_exp_f32 v100, v100
  v_mfma_f32_16x16x32_bf16 a[32:35], a[208:211], v[160:163], a[32:35]
  ds_read_b64_tr_b16 a[252:253], v12 offset:24576
  v_cvt_pk_bf16_f32 v133, v98, v99
  v_mfma_f32_16x16x32_bf16 a[32:35], a[212:215], v[164:167], a[32:35]
  v_exp_f32 v101, v101
  v_mfma_f32_16x16x32_bf16 a[36:39], a[208:211], v[168:171], a[36:39]
  ds_read_b64_tr_b16 a[254:255], v12 offset:28672
  v_add_f32 v26, v26, v100
  v_mfma_f32_16x16x32_bf16 a[36:39], a[212:215], v[172:175], a[36:39]
  v_exp_f32 v102, v102
  v_mfma_f32_16x16x32_bf16 a[40:43], a[208:211], v[176:179], a[40:43]
  ds_read_b128 a[128:131], v1 offset:49152
  v_add_f32 v27, v27, v101
  v_mfma_f32_16x16x32_bf16 a[40:43], a[212:215], v[180:183], a[40:43]
  v_exp_f32 v103, v103
  v_mfma_f32_16x16x32_bf16 a[44:47], a[208:211], v[184:187], a[44:47]
  v_cvt_pk_bf16_f32 v140, v100, v101
  v_add_f32 v26, v26, v102
  v_mfma_f32_16x16x32_bf16 a[44:47], a[212:215], v[188:191], a[44:47]
  v_exp_f32 v104, v104
  v_mfma_f32_16x16x32_bf16 a[60:63], a[216:219], v[184:187], a[60:63]
  s_waitcnt lgkmcnt(15)
  ds_read_b128 a[132:135], v2 offset:49152
  v_add_f32 v27, v27, v103
  v_mfma_f32_16x16x32_bf16 a[60:63], a[220:223], v[188:191], a[60:63]
  v_exp_f32 v105, v105
  v_mfma_f32_16x16x32_bf16 a[56:59], a[216:219], v[176:179], a[56:59]
  ds_read_b128 a[136:139], v3 offset:49152
  v_cvt_pk_bf16_f32 v141, v102, v103
  v_mfma_f32_16x16x32_bf16 a[56:59], a[220:223], v[180:183], a[56:59]
  v_exp_f32 v106, v106
  v_mfma_f32_16x16x32_bf16 a[52:55], a[216:219], v[168:171], a[52:55]
  ds_read_b128 a[140:143], v4 offset:49152
  v_add_f32 v28, v28, v104
  v_mfma_f32_16x16x32_bf16 a[52:55], a[220:223], v[172:175], a[52:55]
  v_exp_f32 v107, v107
  v_mfma_f32_16x16x32_bf16 a[48:51], a[216:219], v[160:163], a[48:51]
  v_mfma_f32_16x16x32_bf16 a[48:51], a[220:223], v[164:167], a[48:51]
  buffer_load_dwordx4 v17, s[8:11], s25 offen offset:2048 lds
  v_mfma_f32_16x16x32_bf16 a[64:67], a[224:227], v[160:163], a[64:67]
  s_waitcnt lgkmcnt(15)
  v_exp_f32 v108, v108
  v_mfma_f32_16x16x32_bf16 a[64:67], a[228:231], v[164:167], a[64:67]
  ds_read_b128 a[144:147], v1 offset:53248
  v_add_f32 v29, v29, v105
  v_mfma_f32_16x16x32_bf16 a[68:71], a[224:227], v[168:171], a[68:71]
  v_exp_f32 v109, v109
  v_mfma_f32_16x16x32_bf16 a[68:71], a[228:231], v[172:175], a[68:71]
  ds_read_b128 a[148:151], v2 offset:53248
  v_cvt_pk_bf16_f32 v148, v104, v105
  v_mfma_f32_16x16x32_bf16 a[72:75], a[224:227], v[176:179], a[72:75]
  v_exp_f32 v110, v110
  v_mfma_f32_16x16x32_bf16 a[72:75], a[228:231], v[180:183], a[72:75]
  ds_read_b128 a[152:155], v3 offset:53248
  v_add_f32 v28, v28, v106
  v_mfma_f32_16x16x32_bf16 a[76:79], a[224:227], v[184:187], a[76:79]
  v_exp_f32 v111, v111
  v_mfma_f32_16x16x32_bf16 a[76:79], a[228:231], v[188:191], a[76:79]
  s_waitcnt lgkmcnt(15)
  v_add_f32 v29, v29, v107
  v_cvt_pk_bf16_f32 v149, v106, v107
  v_mfma_f32_16x16x32_bf16 a[92:95], a[232:235], v[184:187], a[92:95]
  v_exp_f32 v112, v112
  v_mfma_f32_16x16x32_bf16 a[92:95], a[236:239], v[188:191], a[92:95]
  ds_read_b128 a[156:159], v4 offset:53248
  v_cvt_pk_bf16_f32 v156, v108, v109
  v_mfma_f32_16x16x32_bf16 a[88:91], a[232:235], v[176:179], a[88:91]
  v_exp_f32 v113, v113
  v_mfma_f32_16x16x32_bf16 a[88:91], a[236:239], v[180:183], a[88:91]
  ds_read_b128 a[160:163], v1 offset:57344
  v_cvt_pk_bf16_f32 v157, v110, v111
  v_mfma_f32_16x16x32_bf16 a[84:87], a[232:235], v[168:171], a[84:87]
  v_exp_f32 v114, v114
  v_mfma_f32_16x16x32_bf16 a[84:87], a[236:239], v[172:175], a[84:87]
  ds_read_b128 a[164:167], v2 offset:57344
  v_cvt_pk_bf16_f32 v134, v112, v113
  v_mfma_f32_16x16x32_bf16 a[80:83], a[232:235], v[160:163], a[80:83]
  v_exp_f32 v115, v115
  v_mfma_f32_16x16x32_bf16 a[80:83], a[236:239], v[164:167], a[80:83]
  s_waitcnt lgkmcnt(15)
  buffer_load_dwordx4 v18, s[8:11], s25 offen offset:3072 lds
  v_mfma_f32_16x16x32_bf16 a[96:99], a[240:243], v[160:163], a[96:99]
  s_waitcnt lgkmcnt(14)
  s_add_u32 s25, s25, 16384
  v_exp_f32 v116, v116
  v_mfma_f32_16x16x32_bf16 a[96:99], a[244:247], v[164:167], a[96:99]
  ds_read_b128 a[168:171], v3 offset:57344
  v_cvt_pk_bf16_f32 v135, v114, v115
  v_mfma_f32_16x16x32_bf16 a[100:103], a[240:243], v[168:171], a[100:103]
  v_exp_f32 v117, v117
  v_mfma_f32_16x16x32_bf16 a[100:103], a[244:247], v[172:175], a[100:103]
  ds_read_b128 a[172:175], v4 offset:57344
  v_add_f32 v26, v26, v116
  v_mfma_f32_16x16x32_bf16 a[104:107], a[240:243], v[176:179], a[104:107]
  v_exp_f32 v118, v118
  v_mfma_f32_16x16x32_bf16 a[104:107], a[244:247], v[180:183], a[104:107]
  ds_read_b128 a[176:179], v1 offset:61440
  v_add_f32 v27, v27, v117
  v_mfma_f32_16x16x32_bf16 a[108:111], a[240:243], v[184:187], a[108:111]
  v_exp_f32 v119, v119
  v_mfma_f32_16x16x32_bf16 a[108:111], a[244:247], v[188:191], a[108:111]
  s_waitcnt lgkmcnt(15)
  v_cvt_pk_bf16_f32 v142, v116, v117
  v_add_f32 v26, v26, v118
  v_mfma_f32_16x16x32_bf16 a[124:127], a[248:251], v[184:187], a[124:127]
  s_waitcnt lgkmcnt(13)
  v_exp_f32 v120, v120
  v_mfma_f32_16x16x32_bf16 a[124:127], a[252:255], v[188:191], a[124:127]
  ds_read_b128 a[180:183], v2 offset:61440
  v_add_f32 v27, v27, v119
  v_mfma_f32_16x16x32_bf16 a[120:123], a[248:251], v[176:179], a[120:123]
  v_exp_f32 v121, v121
  v_mfma_f32_16x16x32_bf16 a[120:123], a[252:255], v[180:183], a[120:123]
  ds_read_b128 a[184:187], v3 offset:61440
  v_cvt_pk_bf16_f32 v143, v118, v119
  v_mfma_f32_16x16x32_bf16 a[116:119], a[248:251], v[168:171], a[116:119]
  v_exp_f32 v122, v122
  v_mfma_f32_16x16x32_bf16 a[116:119], a[252:255], v[172:175], a[116:119]
  ds_read_b128 a[188:191], v4 offset:61440
  v_add_f32 v28, v28, v120
  v_mfma_f32_16x16x32_bf16 a[112:115], a[248:251], v[160:163], a[112:115]
  s_add_u32 m0, s26, 32768
  v_exp_f32 v123, v123
  v_mfma_f32_16x16x32_bf16 a[112:115], a[252:255], v[164:167], a[112:115]
  s_waitcnt vmcnt(12) lgkmcnt(15)
  s_barrier
  v_mfma_f32_16x16x32_bf16 v[64:67], a[128:131], v[192:195], v[32:35]
  s_waitcnt lgkmcnt(14)
  buffer_load_dwordx4 v13, s[4:7], s24 offen offset:0 lds
  v_mfma_f32_16x16x32_bf16 v[64:67], a[132:135], v[196:199], v[64:67]
  s_waitcnt lgkmcnt(13)
  v_exp_f32 v124, v124
  v_mfma_f32_16x16x32_bf16 v[64:67], a[136:139], v[200:203], v[64:67]
  s_waitcnt lgkmcnt(12)
  ds_read_b64_tr_b16 a[192:193], v5 offset:32768
  v_add_f32 v29, v29, v121
  v_mfma_f32_16x16x32_bf16 v[64:67], a[140:143], v[204:207], v[64:67]
  v_exp_f32 v125, v125
  v_mfma_f32_16x16x32_bf16 v[68:71], a[140:143], v[220:223], v[36:39]
  ds_read_b64_tr_b16 a[194:195], v5 offset:36864
  v_cvt_pk_bf16_f32 v150, v120, v121
  v_mfma_f32_16x16x32_bf16 v[68:71], a[136:139], v[216:219], v[68:71]
  v_exp_f32 v126, v126
  v_mfma_f32_16x16x32_bf16 v[68:71], a[132:135], v[212:215], v[68:71]
  ds_read_b64_tr_b16 a[196:197], v5 offset:40960
  v_add_f32 v28, v28, v122
  v_mfma_f32_16x16x32_bf16 v[68:71], a[128:131], v[208:211], v[68:71]
  v_exp_f32 v127, v127
  v_mfma_f32_16x16x32_bf16 v[72:75], a[128:131], v[224:227], v[40:43]
  v_add_f32 v29, v29, v123
  v_cvt_pk_bf16_f32 v151, v122, v123
  v_mfma_f32_16x16x32_bf16 v[72:75], a[132:135], v[228:231], v[72:75]
  v_exp_f32 v64, v64
  v_mfma_f32_16x16x32_bf16 v[72:75], a[136:139], v[232:235], v[72:75]
  ds_read_b64_tr_b16 a[198:199], v5 offset:45056
  v_cvt_pk_bf16_f32 v158, v124, v125
  v_mfma_f32_16x16x32_bf16 v[72:75], a[140:143], v[236:239], v[72:75]
  v_exp_f32 v65, v65
  v_mfma_f32_16x16x32_bf16 v[76:79], a[140:143], v[252:255], v[44:47]
  ds_read_b64_tr_b16 a[200:201], v6 offset:32768
  v_cvt_pk_bf16_f32 v159, v126, v127
  v_mfma_f32_16x16x32_bf16 v[76:79], a[136:139], v[248:251], v[76:79]
  v_exp_f32 v66, v66
  v_mfma_f32_16x16x32_bf16 v[76:79], a[132:135], v[244:247], v[76:79]
  ds_read_b64_tr_b16 a[202:203], v6 offset:36864
  v_cvt_pk_bf16_f32 v160, v64, v65
  v_mfma_f32_16x16x32_bf16 v[76:79], a[128:131], v[240:243], v[76:79]
  s_waitcnt lgkmcnt(15)
  v_exp_f32 v67, v67
  v_mfma_f32_16x16x32_bf16 v[80:83], a[144:147], v[192:195], v[32:35]
  buffer_load_dwordx4 v14, s[4:7], s24 offen offset:1024 lds
  v_mfma_f32_16x16x32_bf16 v[80:83], a[148:151], v[196:199], v[80:83]
  v_exp_f32 v68, v68
  v_mfma_f32_16x16x32_bf16 v[80:83], a[152:155], v[200:203], v[80:83]
  s_waitcnt lgkmcnt(14)
  ds_read_b64_tr_b16 a[204:205], v6 offset:40960
  v_cvt_pk_bf16_f32 v161, v66, v67
  v_mfma_f32_16x16x32_bf16 v[80:83], a[156:159], v[204:207], v[80:83]
  v_exp_f32 v69, v69
  v_mfma_f32_16x16x32_bf16 v[84:87], a[156:159], v[220:223], v[36:39]
  ds_read_b64_tr_b16 a[206:207], v6 offset:45056
  v_add_f32 v26, v26, v68
  v_mfma_f32_16x16x32_bf16 v[84:87], a[152:155], v[216:219], v[84:87]
  v_exp_f32 v70, v70
  v_mfma_f32_16x16x32_bf16 v[84:87], a[148:151], v[212:215], v[84:87]
  ds_read_b64_tr_b16 a[208:209], v7 offset:32768
  v_add_f32 v27, v27, v69
  v_mfma_f32_16x16x32_bf16 v[84:87], a[144:147], v[208:211], v[84:87]
  v_exp_f32 v71, v71
  v_mfma_f32_16x16x32_bf16 v[88:91], a[144:147], v[224:227], v[40:43]
  v_cvt_pk_bf16_f32 v168, v68, v69
  v_add_f32 v26, v26, v70
  v_mfma_f32_16x16x32_bf16 v[88:91], a[148:151], v[228:231], v[88:91]
  v_exp_f32 v72, v72
  v_mfma_f32_16x16x32_bf16 v[88:91], a[152:155], v[232:235], v[88:91]
  ds_read_b64_tr_b16 a[210:211], v7 offset:36864
  v_add_f32 v27, v27, v71
  v_mfma_f32_16x16x32_bf16 v[88:91], a[156:159], v[236:239], v[88:91]
  v_exp_f32 v73, v73
  v_mfma_f32_16x16x32_bf16 v[92:95], a[156:159], v[252:255], v[44:47]
  ds_read_b64_tr_b16 a[212:213], v7 offset:40960
  v_cvt_pk_bf16_f32 v169, v70, v71
  v_mfma_f32_16x16x32_bf16 v[92:95], a[152:155], v[248:251], v[92:95]
  v_exp_f32 v74, v74
  v_mfma_f32_16x16x32_bf16 v[92:95], a[148:151], v[244:247], v[92:95]
  ds_read_b64_tr_b16 a[214:215], v7 offset:45056
  v_add_f32 v28, v28, v72
  v_mfma_f32_16x16x32_bf16 v[92:95], a[144:147], v[240:243], v[92:95]
  s_waitcnt lgkmcnt(15)
  v_exp_f32 v75, v75
  v_mfma_f32_16x16x32_bf16 v[96:99], a[160:163], v[192:195], v[32:35]
  v_mfma_f32_16x16x32_bf16 v[96:99], a[164:167], v[196:199], v[96:99]
  buffer_load_dwordx4 v15, s[4:7], s24 offen offset:2048 lds
  v_mfma_f32_16x16x32_bf16 v[96:99], a[168:171], v[200:203], v[96:99]
  v_exp_f32 v76, v76
  v_mfma_f32_16x16x32_bf16 v[96:99], a[172:175], v[204:207], v[96:99]
  ds_read_b64_tr_b16 a[216:217], v8 offset:32768
  v_add_f32 v29, v29, v73
  v_mfma_f32_16x16x32_bf16 v[100:103], a[172:175], v[220:223], v[36:39]
  v_exp_f32 v77, v77
  v_mfma_f32_16x16x32_bf16 v[100:103], a[168:171], v[216:219], v[100:103]
  ds_read_b64_tr_b16 a[218:219], v8 offset:36864
  v_cvt_pk_bf16_f32 v176, v72, v73
  v_mfma_f32_16x16x32_bf16 v[100:103], a[164:167], v[212:215], v[100:103]
  v_exp_f32 v78, v78
  v_mfma_f32_16x16x32_bf16 v[100:103], a[160:163], v[208:211], v[100:103]
  ds_read_b64_tr_b16 a[220:221], v8 offset:40960
  v_add_f32 v28, v28, v74
  v_mfma_f32_16x16x32_bf16 v[104:107], a[160:163], v[224:227], v[40:43]
  v_exp_f32 v79, v79
  v_mfma_f32_16x16x32_bf16 v[104:107], a[164:167], v[228:231], v[104:107]
  v_add_f32 v29, v29, v75
  v_cvt_pk_bf16_f32 v177, v74, v75
  v_mfma_f32_16x16x32_bf16 v[104:107], a[168:171], v[232:235], v[104:107]
  v_exp_f32 v80, v80
  v_mfma_f32_16x16x32_bf16 v[104:107], a[172:175], v[236:239], v[104:107]
  ds_read_b64_tr_b16 a[222:223], v8 offset:45056
  v_cvt_pk_bf16_f32 v184, v76, v77
  v_mfma_f32_16x16x32_bf16 v[108:111], a[172:175], v[252:255], v[44:47]
  v_exp_f32 v81, v81
  v_mfma_f32_16x16x32_bf16 v[108:111], a[168:171], v[248:251], v[108:111]
  ds_read_b64_tr_b16 a[224:225], v9 offset:32768
  v_cvt_pk_bf16_f32 v185, v78, v79
  v_mfma_f32_16x16x32_bf16 v[108:111], a[164:167], v[244:247], v[108:111]
  v_exp_f32 v82, v82
  v_mfma_f32_16x16x32_bf16 v[108:111], a[160:163], v[240:243], v[108:111]
  ds_read_b64_tr_b16 a[226:227], v9 offset:36864
  v_cvt_pk_bf16_f32 v162, v80, v81
  v_mfma_f32_16x16x32_bf16 v[112:115], a[176:179], v[192:195], v[32:35]
  s_waitcnt lgkmcnt(15)
  v_exp_f32 v83, v83
  v_mfma_f32_16x16x32_bf16 v[112:115], a[180:183], v[196:199], v[112:115]
  buffer_load_dwordx4 v16, s[4:7], s24 offen offset:3072 lds
  v_mfma_f32_16x16x32_bf16 v[112:115], a[184:187], v[200:203], v[112:115]
  s_add_u32 s24, s24, 16384
  v_exp_f32 v84, v84
  v_mfma_f32_16x16x32_bf16 v[112:115], a[188:191], v[204:207], v[112:115]
  ds_read_b64_tr_b16 a[228:229], v9 offset:40960
  v_cvt_pk_bf16_f32 v163, v82, v83
  v_mfma_f32_16x16x32_bf16 v[116:119], a[188:191], v[220:223], v[36:39]
  v_exp_f32 v85, v85
  v_mfma_f32_16x16x32_bf16 v[116:119], a[184:187], v[216:219], v[116:119]
  ds_read_b64_tr_b16 a[230:231], v9 offset:45056
  v_add_f32 v26, v26, v84
  v_mfma_f32_16x16x32_bf16 v[116:119], a[180:183], v[212:215], v[116:119]
  v_exp_f32 v86, v86
  v_mfma_f32_16x16x32_bf16 v[116:119], a[176:179], v[208:211], v[116:119]
  ds_read_b64_tr_b16 a[232:233], v10 offset:32768
  v_add_f32 v27, v27, v85
  v_mfma_f32_16x16x32_bf16 v[120:123], a[176:179], v[224:227], v[40:43]
  v_exp_f32 v87, v87
  v_mfma_f32_16x16x32_bf16 v[120:123], a[180:183], v[228:231], v[120:123]
  v_cvt_pk_bf16_f32 v170, v84, v85
  v_add_f32 v26, v26, v86
  v_mfma_f32_16x16x32_bf16 v[120:123], a[184:187], v[232:235], v[120:123]
  v_exp_f32 v88, v88
  v_mfma_f32_16x16x32_bf16 v[120:123], a[188:191], v[236:239], v[120:123]
  ds_read_b64_tr_b16 a[234:235], v10 offset:36864
  v_add_f32 v27, v27, v87
  v_mfma_f32_16x16x32_bf16 v[124:127], a[188:191], v[252:255], v[44:47]
  v_exp_f32 v89, v89
  v_mfma_f32_16x16x32_bf16 v[124:127], a[184:187], v[248:251], v[124:127]
  ds_read_b64_tr_b16 a[236:237], v10 offset:40960
  v_cvt_pk_bf16_f32 v171, v86, v87
  v_mfma_f32_16x16x32_bf16 v[124:127], a[180:183], v[244:247], v[124:127]
  v_exp_f32 v90, v90
  v_mfma_f32_16x16x32_bf16 v[124:127], a[176:179], v[240:243], v[124:127]
  s_mov_b32 m0, s62
  ds_read_b64_tr_b16 a[238:239], v10 offset:45056
  v_add_f32 v28, v28, v88
  v_mfma_f32_16x16x32_bf16 a[0:3], a[192:195], v[128:131], a[0:3]
  s_waitcnt lgkmcnt(15)
  v_exp_f32 v91, v91
  v_mfma_f32_16x16x32_bf16 a[0:3], a[196:199], v[132:135], a[0:3]
  s_bitcmp1_b32 s63, 0
  s_cbranch_scc0 L_fw_s1
  buffer_load_dwordx4 v30, s[64:67], s60 offen lds
  s_add_u32 s60, s60, s61
  s_add_u32 s62, s62, 1024
L_fw_s1:
  s_add_u32 m0, s26, 81920
  v_mfma_f32_16x16x32_bf16 a[4:7], a[192:195], v[136:139], a[4:7]
  buffer_load_dwordx4 v17, s[8:11], s25 offen offset:0 lds
  v_mfma_f32_16x16x32_bf16 a[4:7], a[196:199], v[140:143], a[4:7]
  s_lshr_b32 s63, s63, 1
  v_exp_f32 v92, v92
  v_mfma_f32_16x16x32_bf16 a[8:11], a[192:195], v[144:147], a[8:11]
  ds_read_b64_tr_b16 a[240:241], v11 offset:32768
  v_add_f32 v29, v29, v89
  v_mfma_f32_16x16x32_bf16 a[8:11], a[196:199], v[148:151], a[8:11]
  v_exp_f32 v93, v93
  v_mfma_f32_16x16x32_bf16 a[12:15], a[192:195], v[152:155], a[12:15]
  ds_read_b64_tr_b16 a[242:243], v11 offset:36864
  v_cvt_pk_bf16_f32 v178, v88, v89
  v_mfma_f32_16x16x32_bf16 a[12:15], a[196:199], v[156:159], a[12:15]
  v_exp_f32 v94, v94
  v_mfma_f32_16x16x32_bf16 v[60:63], v[20:23], v[152:155], v[60:63]
  ds_read_b64_tr_b16 a[244:245], v11 offset:40960
  v_add_f32 v28, v28, v90
  v_mfma_f32_16x16x32_bf16 v[60:63], v[20:23], v[156:159], v[60:63]
  v_exp_f32 v95, v95
  v_mfma_f32_16x16x32_bf16 a[28:31], a[200:203], v[152:155], a[28:31]
  v_add_f32 v29, v29, v91
  v_cvt_pk_bf16_f32 v179, v90, v91
  v_mfma_f32_16x16x32_bf16 a[28:31], a[204:207], v[156:159], a[28:31]
  v_exp_f32 v96, v96
  v_mfma_f32_16x16x32_bf16 a[24:27], a[200:203], v[144:147], a[24:27]
  ds_read_b64_tr_b16 a[246:247], v11 offset:45056
  v_cvt_pk_bf16_f32 v186, v92, v93
  v_mfma_f32_16x16x32_bf16 a[24:27], a[204:207], v[148:151], a[24:27]
  v_exp_f32 v97, v97
  v_mfma_f32_16x16x32_bf16 a[20:23], a[200:203], v[136:139], a[20:23]
  ds_read_b64_tr_b16 a[248:249], v12 offset:32768
  v_cvt_pk_bf16_f32 v187, v94, v95
  v_mfma_f32_16x16x32_bf16 a[20:23], a[204:207], v[140:143], a[20:23]
  v_exp_f32 v98, v98
  v_mfma_f32_16x16x32_bf16 a[16:19], a[200:203], v[128:131], a[16:19]
  ds_read_b64_tr_b16 a[250:251], v12 offset:36864
  v_cvt_pk_bf16_f32 v164, v96, v97
  v_mfma_f32_16x16x32_bf16 a[16:19], a[204:207], v[132:135], a[16:19]
  v_exp_f32 v99, v99
  v_mfma_f32_16x16x32_bf16 v[48:51], v[20:23], v[128:131], v[48:51]
  buffer_load_dwordx4 v18, s[8:11], s25 offen offset:1024 lds
  v_mfma_f32_16x16x32_bf16 v[48:51], v[20:23], v[132:135], v[48:51]
  s_waitcnt lgkmcnt(15)
  v_exp_f32 v100, v100
  v_mfma_f32_16x16x32_bf16 a[32:35], a[208:211], v[128:131], a[32:35]
  ds_read_b64_tr_b16 a[252:253], v12 offset:40960
  v_cvt_pk_bf16_f32 v165, v98, v99
  v_mfma_f32_16x16x32_bf16 a[32:35], a[212:215], v[132:135], a[32:35]
  v_exp_f32 v101, v101
  v_mfma_f32_16x16x32_bf16 a[36:39], a[208:211], v[136:139], a[36:39]
  ds_read_b64_tr_b16 a[254:255], v12 offset:45056
  v_add_f32 v26, v26, v100
  v_mfma_f32_16x16x32_bf16 a[36:39], a[212:215], v[140:143], a[36:39]
  v_exp_f32 v102, v102
  v_mfma_f32_16x16x32_bf16 a[40:43], a[208:211], v[144:147], a[40:43]
  ds_read_b128 a[128:131], v1 offset:0
  v_add_f32 v27, v27, v101
  v_mfma_f32_16x16x32_bf16 a[40:43], a[212:215], v[148:151], a[40:43]
  v_exp_f32 v103, v103
  v_mfma_f32_16x16x32_bf16 a[44:47], a[208:211], v[152:155], a[44:47]
  v_cvt_pk_bf16_f32 v172, v100, v101
  v_add_f32 v26, v26, v102
  v_mfma_f32_16x16x32_bf16 a[44:47], a[212:215], v[156:159], a[44:47]
  v_exp_f32 v104, v104
  v_mfma_f32_16x16x32_bf16 a[60:63], a[216:219], v[152:155], a[60:63]
  s_waitcnt lgkmcnt(15)
  ds_read_b128 a[132:135], v2 offset:0
  v_add_f32 v27, v27, v103
  v_mfma_f32_16x16x32_bf16 a[60:63], a[220:223], v[156:159], a[60:63]
  v_exp_f32 v105, v105
  v_mfma_f32_16x16x32_bf16 a[56:59], a[216:219], v[144:147], a[56:59]
  ds_read_b128 a[136:139], v3 offset:0
  v_cvt_pk_bf16_f32 v173, v102, v103
  v_mfma_f32_16x16x32_bf16 a[56:59], a[220:223], v[148:151], a[56:59]
  v_exp_f32 v106, v106
  v_mfma_f32_16x16x32_bf16 a[52:55], a[216:219], v[136:139], a[52:55]
  ds_read_b128 a[140:143], v4 offset:0
  v_add_f32 v28, v28, v104
  v_mfma_f32_16x16x32_bf16 a[52:55], a[220:223], v[140:143], a[52:55]
  v_exp_f32 v107, v107
  v_mfma_f32_16x16x32_bf16 a[48:51], a[216:219], v[128:131], a[48:51]
  v_mfma_f32_16x16x32_bf16 a[48:51], a[220:223], v[132:135], a[48:51]
  buffer_load_dwordx4 v17, s[8:11], s25 offen offset:2048 lds
  v_mfma_f32_16x16x32_bf16 a[64:67], a[224:227], v[128:131], a[64:67]
  s_waitcnt lgkmcnt(15)
  v_exp_f32 v108, v108
  v_mfma_f32_16x16x32_bf16 a[64:67], a[228:231], v[132:135], a[64:67]
  ds_read_b128 a[144:147], v1 offset:4096
  v_add_f32 v29, v29, v105
  v_mfma_f32_16x16x32_bf16 a[68:71], a[224:227], v[136:139], a[68:71]
  v_exp_f32 v109, v109
  v_mfma_f32_16x16x32_bf16 a[68:71], a[228:231], v[140:143], a[68:71]
  ds_read_b128 a[148:151], v2 offset:4096
  v_cvt_pk_bf16_f32 v180, v104, v105
  v_mfma_f32_16x16x32_bf16 a[72:75], a[224:227], v[144:147], a[72:75]
  v_exp_f32 v110, v110
  v_mfma_f32_16x16x32_bf16 a[72:75], a[228:231], v[148:151], a[72:75]
  ds_read_b128 a[152:155], v3 offset:4096
  v_add_f32 v28, v28, v106
  v_mfma_f32_16x16x32_bf16 a[76:79], a[224:227], v[152:155], a[76:79]
  v_exp_f32 v111, v111
  v_mfma_f32_16x16x32_bf16 a[76:79], a[228:231], v[156:159], a[76:79]
  s_waitcnt lgkmcnt(15)
  v_add_f32 v29, v29, v107
  v_cvt_pk_bf16_f32 v181, v106, v107
  v_mfma_f32_16x16x32_bf16 a[92:95], a[232:235], v[152:155], a[92:95]
  v_exp_f32 v112, v112
  v_mfma_f32_16x16x32_bf16 a[92:95], a[236:239], v[156:159], a[92:95]
  ds_read_b128 a[156:159], v4 offset:4096
  v_cvt_pk_bf16_f32 v188, v108, v109
  v_mfma_f32_16x16x32_bf16 a[88:91], a[232:235], v[144:147], a[88:91]
  v_exp_f32 v113, v113
  v_mfma_f32_16x16x32_bf16 a[88:91], a[236:239], v[148:151], a[88:91]
  ds_read_b128 a[160:163], v1 offset:8192
  v_cvt_pk_bf16_f32 v189, v110, v111
  v_mfma_f32_16x16x32_bf16 a[84:87], a[232:235], v[136:139], a[84:87]
  v_exp_f32 v114, v114
  v_mfma_f32_16x16x32_bf16 a[84:87], a[236:239], v[140:143], a[84:87]
  ds_read_b128 a[164:167], v2 offset:8192
  v_cvt_pk_bf16_f32 v166, v112, v113
  v_mfma_f32_16x16x32_bf16 a[80:83], a[232:235], v[128:131], a[80:83]
  v_exp_f32 v115, v115
  v_mfma_f32_16x16x32_bf16 a[80:83], a[236:239], v[132:135], a[80:83]
  s_waitcnt lgkmcnt(15)
  buffer_load_dwordx4 v18, s[8:11], s25 offen offset:3072 lds
  v_mfma_f32_16x16x32_bf16 a[96:99], a[240:243], v[128:131], a[96:99]
  s_waitcnt lgkmcnt(14)
  s_add_u32 s25, s25, 16384
  v_exp_f32 v116, v116
  v_mfma_f32_16x16x32_bf16 a[96:99], a[244:247], v[132:135], a[96:99]
  ds_read_b128 a[168:171], v3 offset:8192
  v_cvt_pk_bf16_f32 v167, v114, v115
  v_mfma_f32_16x16x32_bf16 a[100:103], a[240:243], v[136:139], a[100:103]
  v_exp_f32 v117, v117
  v_mfma_f32_16x16x32_bf16 a[100:103], a[244:247], v[140:143], a[100:103]
  ds_read_b128 a[172:175], v4 offset:8192
  v_add_f32 v26, v26, v116
  v_mfma_f32_16x16x32_bf16 a[104:107], a[240:243], v[144:147], a[104:107]
  v_exp_f32 v118, v118
  v_mfma_f32_16x16x32_bf16 a[104:107], a[244:247], v[148:151], a[104:107]
  ds_read_b128 a[176:179], v1 offset:12288
  v_add_f32 v27, v27, v117
  v_mfma_f32_16x16x32_bf16 a[108:111], a[240:243], v[152:155], a[108:111]
  v_exp_f32 v119, v119
  v_mfma_f32_16x16x32_bf16 a[108:111], a[244:247], v[156:159], a[108:111]
  s_waitcnt lgkmcnt(15)
  v_cvt_pk_bf16_f32 v174, v116, v117
  v_add_f32 v26, v26, v118
  v_mfma_f32_16x16x32_bf16 a[124:127], a[248:251], v[152:155], a[124:127]
  s_waitcnt lgkmcnt(13)
  v_exp_f32 v120, v120
  v_mfma_f32_16x16x32_bf16 a[124:127], a[252:255], v[156:159], a[124:127]
  ds_read_b128 a[180:183], v2 offset:12288
  v_add_f32 v27, v27, v119
  v_mfma_f32_16x16x32_bf16 a[120:123], a[248:251], v[144:147], a[120:123]
  v_exp_f32 v121, v121
  v_mfma_f32_16x16x32_bf16 a[120:123], a[252:255], v[148:151], a[120:123]
  ds_read_b128 a[184:187], v3 offset:12288
  v_cvt_pk_bf16_f32 v175, v118, v119
  v_mfma_f32_16x16x32_bf16 a[116:119], a[248:251], v[136:139], a[116:119]
  v_exp_f32 v122, v122
  v_mfma_f32_16x16x32_bf16 a[116:119], a[252:255], v[140:143], a[116:119]
  ds_read_b128 a[188:191], v4 offset:12288
  v_add_f32 v28, v28, v120
  v_mfma_f32_16x16x32_bf16 a[112:115], a[248:251], v[128:131], a[112:115]
  s_add_u32 m0, s26, 49152
  v_exp_f32 v123, v123
  v_mfma_f32_16x16x32_bf16 a[112:115], a[252:255], v[132:135], a[112:115]
  s_waitcnt vmcnt(12) lgkmcnt(15)
  s_barrier
  v_mfma_f32_16x16x32_bf16 v[64:67], a[128:131], v[192:195], v[32:35]
  s_waitcnt lgkmcnt(14)
  buffer_load_dwordx4 v13, s[4:7], s24 offen offset:0 lds
  v_mfma_f32_16x16x32_bf16 v[64:67], a[132:135], v[196:199], v[64:67]
  s_waitcnt lgkmcnt(13)
  v_exp_f32 v124, v124
  v_mfma_f32_16x16x32_bf16 v[64:67], a[136:139], v[200:203], v[64:67]
  s_waitcnt lgkmcnt(12)
  ds_read_b64_tr_b16 a[192:193], v5 offset:49152
  v_add_f32 v29, v29, v121
  v_mfma_f32_16x16x32_bf16 v[64:67], a[140:143], v[204:207], v[64:67]
  v_exp_f32 v125, v125
  v_mfma_f32_16x16x32_bf16 v[68:71], a[140:143], v[220:223], v[36:39]
  ds_read_b64_tr_b16 a[194:195], v5 offset:53248
  v_cvt_pk_bf16_f32 v182, v120, v121
  v_mfma_f32_16x16x32_bf16 v[68:71], a[136:139], v[216:219], v[68:71]
  v_exp_f32 v126, v126
  v_mfma_f32_16x16x32_bf16 v[68:71], a[132:135], v[212:215], v[68:71]
  ds_read_b64_tr_b16 a[196:197], v5 offset:57344
  v_add_f32 v28, v28, v122
  v_mfma_f32_16x16x32_bf16 v[68:71], a[128:131], v[208:211], v[68:71]
  v_exp_f32 v127, v127
  v_mfma_f32_16x16x32_bf16 v[72:75], a[128:131], v[224:227], v[40:43]
  v_add_f32 v29, v29, v123
  v_cvt_pk_bf16_f32 v183, v122, v123
  v_mfma_f32_16x16x32_bf16 v[72:75], a[132:135], v[228:231], v[72:75]
  v_exp_f32 v64, v64
  v_mfma_f32_16x16x32_bf16 v[72:75], a[136:139], v[232:235], v[72:75]
  ds_read_b64_tr_b16 a[198:199], v5 offset:61440
  v_cvt_pk_bf16_f32 v190, v124, v125
  v_mfma_f32_16x16x32_bf16 v[72:75], a[140:143], v[236:239], v[72:75]
  v_exp_f32 v65, v65
  v_mfma_f32_16x16x32_bf16 v[76:79], a[140:143], v[252:255], v[44:47]
  ds_read_b64_tr_b16 a[200:201], v6 offset:49152
  v_cvt_pk_bf16_f32 v191, v126, v127
  v_mfma_f32_16x16x32_bf16 v[76:79], a[136:139], v[248:251], v[76:79]
  v_exp_f32 v66, v66
  v_mfma_f32_16x16x32_bf16 v[76:79], a[132:135], v[244:247], v[76:79]
  ds_read_b64_tr_b16 a[202:203], v6 offset:53248
  v_cvt_pk_bf16_f32 v128, v64, v65
  v_mfma_f32_16x16x32_bf16 v[76:79], a[128:131], v[240:243], v[76:79]
  s_waitcnt lgkmcnt(15)
  v_exp_f32 v67, v67
  v_mfma_f32_16x16x32_bf16 v[80:83], a[144:147], v[192:195], v[32:35]
  buffer_load_dwordx4 v14, s[4:7], s24 offen offset:1024 lds
  v_mfma_f32_16x16x32_bf16 v[80:83], a[148:151], v[196:199], v[80:83]
  v_exp_f32 v68, v68
  v_mfma_f32_16x16x32_bf16 v[80:83], a[152:155], v[200:203], v[80:83]
  s_waitcnt lgkmcnt(14)
  ds_read_b64_tr_b16 a[204:205], v6 offset:57344
  v_cvt_pk_bf16_f32 v129, v66, v67
  v_mfma_f32_16x16x32_bf16 v[80:83], a[156:159], v[204:207], v[80:83]
  v_exp_f32 v69, v69
  v_mfma_f32_16x16x32_bf16 v[84:87], a[156:159], v[220:223], v[36:39]
  ds_read_b64_tr_b16 a[206:207], v6 offset:61440
  v_add_f32 v26, v26, v68
  v_mfma_f32_16x16x32_bf16 v[84:87], a[152:155], v[216:219], v[84:87]
  v_exp_f32 v70, v70
  v_mfma_f32_16x16x32_bf16 v[84:87], a[148:151], v[212:215], v[84:87]
  ds_read_b64_tr_b16 a[208:209], v7 offset:49152
  v_add_f32 v27, v27, v69
  v_mfma_f32_16x16x32_bf16 v[84:87], a[144:147], v[208:211], v[84:87]
  v_exp_f32 v71, v71
  v_mfma_f32_16x16x32_bf16 v[88:91], a[144:147], v[224:227], v[40:43]
  v_cvt_pk_bf16_f32 v136, v68, v69
  v_add_f32 v26, v26, v70
  v_mfma_f32_16x16x32_bf16 v[88:91], a[148:151], v[228:231], v[88:91]
  v_exp_f32 v72, v72
  v_mfma_f32_16x16x32_bf16 v[88:91], a[152:155], v[232:235], v[88:91]
  ds_read_b64_tr_b16 a[210:211], v7 offset:53248
  v_add_f32 v27, v27, v71
  v_mfma_f32_16x16x32_bf16 v[88:91], a[156:159], v[236:239], v[88:91]
  v_exp_f32 v73, v73
  v_mfma_f32_16x16x32_bf16 v[92:95], a[156:159], v[252:255], v[44:47]
  ds_read_b64_tr_b16 a[212:213], v7 offset:57344
  v_cvt_pk_bf16_f32 v137, v70, v71
  v_mfma_f32_16x16x32_bf16 v[92:95], a[152:155], v[248:251], v[92:95]
  v_exp_f32 v74, v74
  v_mfma_f32_16x16x32_bf16 v[92:95], a[148:151], v[244:247], v[92:95]
  ds_read_b64_tr_b16 a[214:215], v7 offset:61440
  v_add_f32 v28, v28, v72
  v_mfma_f32_16x16x32_bf16 v[92:95], a[144:147], v[240:243], v[92:95]
  s_waitcnt lgkmcnt(15)
  v_exp_f32 v75, v75
  v_mfma_f32_16x16x32_bf16 v[96:99], a[160:163], v[192:195], v[32:35]
  v_mfma_f32_16x16x32_bf16 v[96:99], a[164:167], v[196:199], v[96:99]
  buffer_load_dwordx4 v15, s[4:7], s24 offen offset:2048 lds
  v_mfma_f32_16x16x32_bf16 v[96:99], a[168:171], v[200:203], v[96:99]
  v_exp_f32 v76, v76
  v_mfma_f32_16x16x32_bf16 v[96:99], a[172:175], v[204:207], v[96:99]
  ds_read_b64_tr_b16 a[216:217], v8 offset:49152
  v_add_f32 v29, v29, v73
  v_mfma_f32_16x16x32_bf16 v[100:103], a[172:175], v[220:223], v[36:39]
  v_exp_f32 v77, v77
  v_mfma_f32_16x16x32_bf16 v[100:103], a[168:171], v[216:219], v[100:103]
  ds_read_b64_tr_b16 a[218:219], v8 offset:53248
  v_cvt_pk_bf16_f32 v144, v72, v73
  v_mfma_f32_16x16x32_bf16 v[100:103], a[164:167], v[212:215], v[100:103]
  v_exp_f32 v78, v78
  v_mfma_f32_16x16x32_bf16 v[100:103], a[160:163], v[208:211], v[100:103]
  ds_read_b64_tr_b16 a[220:221], v8 offset:57344
  v_add_f32 v28, v28, v74
  v_mfma_f32_16x16x32_bf16 v[104:107], a[160:163], v[224:227], v[40:43]
  v_exp_f32 v79, v79
  v_mfma_f32_16x16x32_bf16 v[104:107], a[164:167], v[228:231], v[104:107]
  v_add_f32 v29, v29, v75
  v_cvt_pk_bf16_f32 v145, v74, v75
  v_mfma_f32_16x16x32_bf16 v[104:107], a[168:171], v[232:235], v[104:107]
  v_exp_f32 v80, v80
  v_mfma_f32_16x16x32_bf16 v[104:107], a[172:175], v[236:239], v[104:107]
  ds_read_b64_tr_b16 a[222:223], v8 offset:61440
  v_cvt_pk_bf16_f32 v152, v76, v77
  v_mfma_f32_16x16x32_bf16 v[108:111], a[172:175], v[252:255], v[44:47]
  v_exp_f32 v81, v81
  v_mfma_f32_16x16x32_bf16 v[108:111], a[168:171], v[248:251], v[108:111]
  ds_read_b64_tr_b16 a[224:225], v9 offset:49152
  v_cvt_pk_bf16_f32 v153, v78, v79
  v_mfma_f32_16x16x32_bf16 v[108:111], a[164:167], v[244:247], v[108:111]
  v_exp_f32 v82, v82
  v_mfma_f32_16x16x32_bf16 v[108:111], a[160:163], v[240:243], v[108:111]
  ds_read_b64_tr_b16 a[226:227], v9 offset:53248
  v_cvt_pk_bf16_f32 v130, v80, v81
  v_mfma_f32_16x16x32_bf16 v[112:115], a[176:179], v[192:195], v[32:35]
  s_waitcnt lgkmcnt(15)
  v_exp_f32 v83, v83
  v_mfma_f32_16x16x32_bf16 v[112:115], a[180:183], v[196:199], v[112:115]
  buffer_load_dwordx4 v16, s[4:7], s24 offen offset:3072 lds
  v_mfma_f32_16x16x32_bf16 v[112:115], a[184:187], v[200:203], v[112:115]
  s_add_u32 s24, s24, 16384
  v_exp_f32 v84, v84
  v_mfma_f32_16x16x32_bf16 v[112:115], a[188:191], v[204:207], v[112:115]
  ds_read_b64_tr_b16 a[228:229], v9 offset:57344
  v_cvt_pk_bf16_f32 v131, v82, v83
  v_mfma_f32_16x16x32_bf16 v[116:119], a[188:191], v[220:223], v[36:39]
  v_exp_f32 v85, v85
  v_mfma_f32_16x16x32_bf16 v[116:119], a[184:187], v[216:219], v[116:119]
  ds_read_b64_tr_b16 a[230:231], v9 offset:61440
  v_add_f32 v26, v26, v84
  v_mfma_f32_16x16x32_bf16 v[116:119], a[180:183], v[212:215], v[116:119]
  v_exp_f32 v86, v86
  v_mfma_f32_16x16x32_bf16 v[116:119], a[176:179], v[208:211], v[116:119]
  ds_read_b64_tr_b16 a[232:233], v10 offset:49152
  v_add_f32 v27, v27, v85
  v_mfma_f32_16x16x32_bf16 v[120:123], a[176:179], v[224:227], v[40:43]
  v_exp_f32 v87, v87
  v_mfma_f32_16x16x32_bf16 v[120:123], a[180:183], v[228:231], v[120:123]
  v_cvt_pk_bf16_f32 v138, v84, v85
  v_add_f32 v26, v26, v86
  v_mfma_f32_16x16x32_bf16 v[120:123], a[184:187], v[232:235], v[120:123]
  v_exp_f32 v88, v88
  v_mfma_f32_16x16x32_bf16 v[120:123], a[188:191], v[236:239], v[120:123]
  ds_read_b64_tr_b16 a[234:235], v10 offset:53248
  v_add_f32 v27, v27, v87
  v_mfma_f32_16x16x32_bf16 v[124:127], a[188:191], v[252:255], v[44:47]
  v_exp_f32 v89, v89
  v_mfma_f32_16x16x32_bf16 v[124:127], a[184:187], v[248:251], v[124:127]
  ds_read_b64_tr_b16 a[236:237], v10 offset:57344
  v_cvt_pk_bf16_f32 v139, v86, v87
  v_mfma_f32_16x16x32_bf16 v[124:127], a[180:183], v[244:247], v[124:127]
  v_exp_f32 v90, v90
  v_mfma_f32_16x16x32_bf16 v[124:127], a[176:179], v[240:243], v[124:127]
  s_mov_b32 m0, s62
  ds_read_b64_tr_b16 a[238:239], v10 offset:61440
  v_add_f32 v28, v28, v88
  v_mfma_f32_16x16x32_bf16 a[0:3], a[192:195], v[160:163], a[0:3]
  s_waitcnt lgkmcnt(15)
  v_exp_f32 v91, v91
  v_mfma_f32_16x16x32_bf16 a[0:3], a[196:199], v[164:167], a[0:3]
  s_bitcmp1_b32 s63, 0
  s_cbranch_scc0 L_fw_s2
  buffer_load_dwordx4 v30, s[64:67], s60 offen lds
  s_add_u32 s60, s60, s61
  s_add_u32 s62, s62, 1024
L_fw_s2:
  s_add_u32 m0, s26, 98304
  v_mfma_f32_16x16x32_bf16 a[4:7], a[192:195], v[168:171], a[4:7]
  buffer_load_dwordx4 v17, s[8:11], s25 offen offset:0 lds
  v_mfma_f32_16x16x32_bf16 a[4:7], a[196:199], v[172:175], a[4:7]
  s_lshr_b32 s63, s63, 1
  v_exp_f32 v92, v92
  v_mfma_f32_16x16x32_bf16 a[8:11], a[192:195], v[176:179], a[8:11]
  ds_read_b64_tr_b16 a[240:241], v11 offset:49152
  v_add_f32 v29, v29, v89
  v_mfma_f32_16x16x32_bf16 a[8:11], a[196:199], v[180:183], a[8:11]
  v_exp_f32 v93, v93
  v_mfma_f32_16x16x32_bf16 a[12:15], a[192:195], v[184:187], a[12:15]
  ds_read_b64_tr_b16 a[242:243], v11 offset:53248
  v_cvt_pk_bf16_f32 v146, v88, v89
  v_mfma_f32_16x16x32_bf16 a[12:15], a[196:199], v[188:191], a[12:15]
  v_exp_f32 v94, v94
  v_mfma_f32_16x16x32_bf16 v[60:63], v[20:23], v[184:187], v[60:63]
  ds_read_b64_tr_b16 a[244:245], v11 offset:57344
  v_add_f32 v28, v28, v90
  v_mfma_f32_16x16x32_bf16 v[60:63], v[20:23], v[188:191], v[60:63]
  v_exp_f32 v95, v95
  v_mfma_f32_16x16x32_bf16 a[28:31], a[200:203], v[184:187], a[28:31]
  v_add_f32 v29, v29, v91
  v_cvt_pk_bf16_f32 v147, v90, v91
  v_mfma_f32_16x16x32_bf16 a[28:31], a[204:207], v[188:191], a[28:31]
  v_exp_f32 v96, v96
  v_mfma_f32_16x16x32_bf16 a[24:27], a[200:203], v[176:179], a[24:27]
  ds_read_b64_tr_b16 a[246:247], v11 offset:61440
  v_cvt_pk_bf16_f32 v154, v92, v93
  v_mfma_f32_16x16x32_bf16 a[24:27], a[204:207], v[180:183], a[24:27]
  v_exp_f32 v97, v97
  v_mfma_f32_16x16x32_bf16 a[20:23], a[200:203], v[168:171], a[20:23]
  ds_read_b64_tr_b16 a[248:249], v12 offset:49152
  v_cvt_pk_bf16_f32 v155, v94, v95
  v_mfma_f32_16x16x32_bf16 a[20:23], a[204:207], v[172:175], a[20:23]
  v_exp_f32 v98, v98
  v_mfma_f32_16x16x32_bf16 a[16:19], a[200:203], v[160:163], a[16:19]
  ds_read_b64_tr_b16 a[250:251], v12 offset:53248
  v_cvt_pk_bf16_f32 v132, v96, v97
  v_mfma_f32_16x16x32_bf16 a[16:19], a[204:207], v[164:167], a[16:19]
  v_exp_f32 v99, v99
  v_mfma_f32_16x16x32_bf16 v[48:51], v[20:23], v[160:163], v[48:51]
  buffer_load_dwordx4 v18, s[8:11], s25 offen offset:1024 lds
  v_mfma_f32_16x16x32_bf16 v[48:51], v[20:23], v[164:167], v[48:51]
  s_waitcnt lgkmcnt(15)
  v_exp_f32 v100, v100
  v_mfma_f32_16x16x32_bf16 a[32:35], a[208:211], v[160:163], a[32:35]
  ds_read_b64_tr_b16 a[252:253], v12 offset:57344
  v_cvt_pk_bf16_f32 v133, v98, v99
  v_mfma_f32_16x16x32_bf16 a[32:35], a[212:215], v[164:167], a[32:35]
  v_exp_f32 v101, v101
  v_mfma_f32_16x16x32_bf16 a[36:39], a[208:211], v[168:171], a[36:39]
  ds_read_b64_tr_b16 a[254:255], v12 offset:61440
  v_add_f32 v26, v26, v100
  v_mfma_f32_16x16x32_bf16 a[36:39], a[212:215], v[172:175], a[36:39]
  v_exp_f32 v102, v102
  v_mfma_f32_16x16x32_bf16 a[40:43], a[208:211], v[176:179], a[40:43]
  ds_read_b128 a[128:131], v1 offset:16384
  v_add_f32 v27, v27, v101
  v_mfma_f32_16x16x32_bf16 a[40:43], a[212:215], v[180:183], a[40:43]
  v_exp_f32 v103, v103
  v_mfma_f32_16x16x32_bf16 a[44:47], a[208:211], v[184:187], a[44:47]
  v_cvt_pk_bf16_f32 v140, v100, v101
  v_add_f32 v26, v26, v102
  v_mfma_f32_16x16x32_bf16 a[44:47], a[212:215], v[188:191], a[44:47]
  v_exp_f32 v104, v104
  v_mfma_f32_16x16x32_bf16 a[60:63], a[216:219], v[184:187], a[60:63]
  s_waitcnt lgkmcnt(15)
  ds_read_b128 a[132:135], v2 offset:16384
  v_add_f32 v27, v27, v103
  v_mfma_f32_16x16x32_bf16 a[60:63], a[220:223], v[188:191], a[60:63]
  v_exp_f32 v105, v105
  v_mfma_f32_16x16x32_bf16 a[56:59], a[216:219], v[176:179], a[56:59]
  ds_read_b128 a[136:139], v3 offset:16384
  v_cvt_pk_bf16_f32 v141, v102, v103
  v_mfma_f32_16x16x32_bf16 a[56:59], a[220:223], v[180:183], a[56:59]
  v_exp_f32 v106, v106
  v_mfma_f32_16x16x32_bf16 a[52:55], a[216:219], v[168:171], a[52:55]
  ds_read_b128 a[140:143], v4 offset:16384
  v_add_f32 v28, v28, v104
  v_mfma_f32_16x16x32_bf16 a[52:55], a[220:223], v[172:175], a[52:55]
  v_exp_f32 v107, v107
  v_mfma_f32_16x16x32_bf16 a[48:51], a[216:219], v[160:163], a[48:51]
  v_mfma_f32_16x16x32_bf16 a[48:51], a[220:223], v[164:167], a[48:51]
  buffer_load_dwordx4 v17, s[8:11], s25 offen offset:2048 lds
  v_mfma_f32_16x16x32_bf16 a[64:67], a[224:227], v[160:163], a[64:67]
  s_waitcnt lgkmcnt(15)
  v_exp_f32 v108, v108
  v_mfma_f32_16x16x32_bf16 a[64:67], a[228:231], v[164:167], a[64:67]
  ds_read_b128 a[144:147], v1 offset:20480
  v_add_f32 v29, v29, v105
  v_mfma_f32_16x16x32_bf16 a[68:71], a[224:227], v[168:171], a[68:71]
  v_exp_f32 v109, v109
  v_mfma_f32_16x16x32_bf16 a[68:71], a[228:231], v[172:175], a[68:71]
  ds_read_b128 a[148:151], v2 offset:20480
  v_cvt_pk_bf16_f32 v148, v104, v105
  v_mfma_f32_16x16x32_bf16 a[72:75], a[224:227], v[176:179], a[72:75]
  v_exp_f32 v110, v110
  v_mfma_f32_16x16x32_bf16 a[72:75], a[228:231], v[180:183], a[72:75]
  ds_read_b128 a[152:155], v3 offset:20480
  v_add_f32 v28, v28, v106
  v_mfma_f32_16x16x32_bf16 a[76:79], a[224:227], v[184:187], a[76:79]
  v_exp_f32 v111, v111
  v_mfma_f32_16x16x32_bf16 a[76:79], a[228:231], v[188:191], a[76:79]
  s_waitcnt lgkmcnt(15)
  v_add_f32 v29, v29, v107
  v_cvt_pk_bf16_f32 v149, v106, v107
  v_mfma_f32_16x16x32_bf16 a[92:95], a[232:235], v[184:187], a[92:95]
  v_exp_f32 v112, v112
  v_mfma_f32_16x16x32_bf16 a[92:95], a[236:239], v[188:191], a[92:95]
  ds_read_b128 a[156:159], v4 offset:20480
  v_cvt_pk_bf16_f32 v156, v108, v109
  v_mfma_f32_16x16x32_bf16 a[88:91], a[232:235], v[176:179], a[88:91]
  v_exp_f32 v113, v113
  v_mfma_f32_16x16x32_bf16 a[88:91], a[236:239], v[180:183], a[88:91]
  ds_read_b128 a[160:163], v1 offset:24576
  v_cvt_pk_bf16_f32 v157, v110, v111
  v_mfma_f32_16x16x32_bf16 a[84:87], a[232:235], v[168:171], a[84:87]
  v_exp_f32 v114, v114
  v_mfma_f32_16x16x32_bf16 a[84:87], a[236:239], v[172:175], a[84:87]
  ds_read_b128 a[164:167], v2 offset:24576
  v_cvt_pk_bf16_f32 v134, v112, v113
  v_mfma_f32_16x16x32_bf16 a[80:83], a[232:235], v[160:163], a[80:83]
  v_exp_f32 v115, v115
  v_mfma_f32_16x16x32_bf16 a[80:83], a[236:239], v[164:167], a[80:83]
  s_waitcnt lgkmcnt(15)
  buffer_load_dwordx4 v18, s[8:11], s25 offen offset:3072 lds
  v_mfma_f32_16x16x32_bf16 a[96:99], a[240:243], v[160:163], a[96:99]
  s_waitcnt lgkmcnt(14)
  s_add_u32 s25, s25, 16384
  v_exp_f32 v116, v116
  v_mfma_f32_16x16x32_bf16 a[96:99], a[244:247], v[164:167], a[96:99]
  ds_read_b128 a[168:171], v3 offset:24576
  v_cvt_pk_bf16_f32 v135, v114, v115
  v_mfma_f32_16x16x32_bf16 a[100:103], a[240:243], v[168:171], a[100:103]
  v_exp_f32 v117, v117
  v_mfma_f32_16x16x32_bf16 a[100:103], a[244:247], v[172:175], a[100:103]
  ds_read_b128 a[172:175], v4 offset:24576
  v_add_f32 v26, v26, v116
  v_mfma_f32_16x16x32_bf16 a[104:107], a[240:243], v[176:179], a[104:107]
  v_exp_f32 v118, v118
  v_mfma_f32_16x16x32_bf16 a[104:107], a[244:247], v[180:183], a[104:107]
  ds_read_b128 a[176:179], v1 offset:28672
  v_add_f32 v27, v27, v117
  v_mfma_f32_16x16x32_bf16 a[108:111], a[240:243], v[184:187], a[108:111]
  v_exp_f32 v119, v119
  v_mfma_f32_16x16x32_bf16 a[108:111], a[244:247], v[188:191], a[108:111]
  s_waitcnt lgkmcnt(15)
  v_cvt_pk_bf16_f32 v142, v116, v117
  v_add_f32 v26, v26, v118
  v_mfma_f32_16x16x32_bf16 a[124:127], a[248:251], v[184:187], a[124:127]
  s_waitcnt lgkmcnt(13)
  v_exp_f32 v120, v120
  v_mfma_f32_16x16x32_bf16 a[124:127], a[252:255], v[188:191], a[124:127]
  ds_read_b128 a[180:183], v2 offset:28672
  v_add_f32 v27, v27, v119
  v_mfma_f32_16x16x32_bf16 a[120:123], a[248:251], v[176:179], a[120:123]
  v_exp_f32 v121, v121
  v_mfma_f32_16x16x32_bf16 a[120:123], a[252:255], v[180:183], a[120:123]
  ds_read_b128 a[184:187], v3 offset:28672
  v_cvt_pk_bf16_f32 v143, v118, v119
  v_mfma_f32_16x16x32_bf16 a[116:119], a[248:251], v[168:171], a[116:119]
  v_exp_f32 v122, v122
  v_mfma_f32_16x16x32_bf16 a[116:119], a[252:255], v[172:175], a[116:119]
  ds_read_b128 a[188:191], v4 offset:28672
  v_add_f32 v28, v28, v120
  v_mfma_f32_16x16x32_bf16 a[112:115], a[248:251], v[160:163], a[112:115]
  s_add_u32 m0, s26, 0
  v_exp_f32 v123, v123
  v_mfma_f32_16x16x32_bf16 a[112:115], a[252:255], v[164:167], a[112:115]
  s_waitcnt vmcnt(12) lgkmcnt(15)
  s_barrier
  v_mfma_f32_16x16x32_bf16 v[64:67], a[128:131], v[192:195], v[32:35]
  s_waitcnt lgkmcnt(14)
  buffer_load_dwordx4 v13, s[4:7], s24 offen offset:0 lds
  v_mfma_f32_16x16x32_bf16 v[64:67], a[132:135], v[196:199], v[64:67]
  s_waitcnt lgkmcnt(13)
  v_exp_f32 v124, v124
  v_mfma_f32_16x16x32_bf16 v[64:67], a[136:139], v[200:203], v[64:67]
  s_waitcnt lgkmcnt(12)
  ds_read_b64_tr_b16 a[192:193], v5 offset:0
  v_add_f32 v29, v29, v121
  v_mfma_f32_16x16x32_bf16 v[64:67], a[140:143], v[204:207], v[64:67]
  v_exp_f32 v125, v125
  v_mfma_f32_16x16x32_bf16 v[68:71], a[140:143], v[220:223], v[36:39]
  ds_read_b64_tr_b16 a[194:195], v5 offset:4096
  v_cvt_pk_bf16_f32 v150, v120, v121
  v_mfma_f32_16x16x32_bf16 v[68:71], a[136:139], v[216:219], v[68:71]
  v_exp_f32 v126, v126
  v_mfma_f32_16x16x32_bf16 v[68:71], a[132:135], v[212:215], v[68:71]
  ds_read_b64_tr_b16 a[196:197], v5 offset:8192
  v_add_f32 v28, v28, v122
  v_mfma_f32_16x16x32_bf16 v[68:71], a[128:131], v[208:211], v[68:71]
  v_exp_f32 v127, v127
  v_mfma_f32_16x16x32_bf16 v[72:75], a[128:131], v[224:227], v[40:43]
  v_add_f32 v29, v29, v123
  v_cvt_pk_bf16_f32 v151, v122, v123
  v_mfma_f32_16x16x32_bf16 v[72:75], a[132:135], v[228:231], v[72:75]
  v_exp_f32 v64, v64
  v_mfma_f32_16x16x32_bf16 v[72:75], a[136:139], v[232:235], v[72:75]
  ds_read_b64_tr_b16 a[198:199], v5 offset:12288
  v_cvt_pk_bf16_f32 v158, v124, v125
  v_mfma_f32_16x16x32_bf16 v[72:75], a[140:143], v[236:239], v[72:75]
  v_exp_f32 v65, v65
  v_mfma_f32_16x16x32_bf16 v[76:79], a[140:143], v[252:255], v[44:47]
  ds_read_b64_tr_b16 a[200:201], v6 offset:0
  v_cvt_pk_bf16_f32 v159, v126, v127
  v_mfma_f32_16x16x32_bf16 v[76:79], a[136:139], v[248:251], v[76:79]
  v_exp_f32 v66, v66
  v_mfma_f32_16x16x32_bf16 v[76:79], a[132:135], v[244:247], v[76:79]
  ds_read_b64_tr_b16 a[202:203], v6 offset:4096
  v_cvt_pk_bf16_f32 v160, v64, v65
  v_mfma_f32_16x16x32_bf16 v[76:79], a[128:131], v[240:243], v[76:79]
  s_waitcnt lgkmcnt(15)
  v_exp_f32 v67, v67
  v_mfma_f32_16x16x32_bf16 v[80:83], a[144:147], v[192:195], v[32:35]
  buffer_load_dwordx4 v14, s[4:7], s24 offen offset:1024 lds
  v_mfma_f32_16x16x32_bf16 v[80:83], a[148:151], v[196:199], v[80:83]
  v_exp_f32 v68, v68
  v_mfma_f32_16x16x32_bf16 v[80:83], a[152:155], v[200:203], v[80:83]
  s_waitcnt lgkmcnt(14)
  ds_read_b64_tr_b16 a[204:205], v6 offset:8192
  v_cvt_pk_bf16_f32 v161, v66, v67
  v_mfma_f32_16x16x32_bf16 v[80:83], a[156:159], v[204:207], v[80:83]
  v_exp_f32 v69, v69
  v_mfma_f32_16x16x32_bf16 v[84:87], a[156:159], v[220:223], v[36:39]
  ds_read_b64_tr_b16 a[206:207], v6 offset:12288
  v_add_f32 v26, v26, v68
  v_mfma_f32_16x16x32_bf16 v[84:87], a[152:155], v[216:219], v[84:87]
  v_exp_f32 v70, v70
  v_mfma_f32_16x16x32_bf16 v[84:87], a[148:151], v[212:215], v[84:87]
  ds_read_b64_tr_b16 a[208:209], v7 offset:0
  v_add_f32 v27, v27, v69
  v_mfma_f32_16x16x32_bf16 v[84:87], a[144:147], v[208:211], v[84:87]
  v_exp_f32 v71, v71
  v_mfma_f32_16x16x32_bf16 v[88:91], a[144:147], v[224:227], v[40:43]
  v_cvt_pk_bf16_f32 v168, v68, v69
  v_add_f32 v26, v26, v70
  v_mfma_f32_16x16x32_bf16 v[88:91], a[148:151], v[228:231], v[88:91]
  v_exp_f32 v72, v72
  v_mfma_f32_16x16x32_bf16 v[88:91], a[152:155], v[232:235], v[88:91]
  ds_read_b64_tr_b16 a[210:211], v7 offset:4096
  v_add_f32 v27, v27, v71
  v_mfma_f32_16x16x32_bf16 v[88:91], a[156:159], v[236:239], v[88:91]
  v_exp_f32 v73, v73
  v_mfma_f32_16x16x32_bf16 v[92:95], a[156:159], v[252:255], v[44:47]
  ds_read_b64_tr_b16 a[212:213], v7 offset:8192
  v_cvt_pk_bf16_f32 v169, v70, v71
  v_mfma_f32_16x16x32_bf16 v[92:95], a[152:155], v[248:251], v[92:95]
  v_exp_f32 v74, v74
  v_mfma_f32_16x16x32_bf16 v[92:95], a[148:151], v[244:247], v[92:95]
  ds_read_b64_tr_b16 a[214:215], v7 offset:12288
  v_add_f32 v28, v28, v72
  v_mfma_f32_16x16x32_bf16 v[92:95], a[144:147], v[240:243], v[92:95]
  s_waitcnt lgkmcnt(15)
  v_exp_f32 v75, v75
  v_mfma_f32_16x16x32_bf16 v[96:99], a[160:163], v[192:195], v[32:35]
  v_mfma_f32_16x16x32_bf16 v[96:99], a[164:167], v[196:199], v[96:99]
  buffer_load_dwordx4 v15, s[4:7], s24 offen offset:2048 lds
  v_mfma_f32_16x16x32_bf16 v[96:99], a[168:171], v[200:203], v[96:99]
  v_exp_f32 v76, v76
  v_mfma_f32_16x16x32_bf16 v[96:99], a[172:175], v[204:207], v[96:99]
  ds_read_b64_tr_b16 a[216:217], v8 offset:0
  v_add_f32 v29, v29, v73
  v_mfma_f32_16x16x32_bf16 v[100:103], a[172:175], v[220:223], v[36:39]
  v_exp_f32 v77, v77
  v_mfma_f32_16x16x32_bf16 v[100:103], a[168:171], v[216:219], v[100:103]
  ds_read_b64_tr_b16 a[218:219], v8 offset:4096
  v_cvt_pk_bf16_f32 v176, v72, v73
  v_mfma_f32_16x16x32_bf16 v[100:103], a[164:167], v[212:215], v[100:103]
  v_exp_f32 v78, v78
  v_mfma_f32_16x16x32_bf16 v[100:103], a[160:163], v[208:211], v[100:103]
  ds_read_b64_tr_b16 a[220:221], v8 offset:8192
  v_add_f32 v28, v28, v74
  v_mfma_f32_16x16x32_bf16 v[104:107], a[160:163], v[224:227], v[40:43]
  v_exp_f32 v79, v79
  v_mfma_f32_16x16x32_bf16 v[104:107], a[164:167], v[228:231], v[104:107]
  v_add_f32 v29, v29, v75
  v_cvt_pk_bf16_f32 v177, v74, v75
  v_mfma_f32_16x16x32_bf16 v[104:107], a[168:171], v[232:235], v[104:107]
  v_exp_f32 v80, v80
  v_mfma_f32_16x16x32_bf16 v[104:107], a[172:175], v[236:239], v[104:107]
  ds_read_b64_tr_b16 a[222:223], v8 offset:12288
  v_cvt_pk_bf16_f32 v184, v76, v77
  v_mfma_f32_16x16x32_bf16 v[108:111], a[172:175], v[252:255], v[44:47]
  v_exp_f32 v81, v81
  v_mfma_f32_16x16x32_bf16 v[108:111], a[168:171], v[248:251], v[108:111]
  ds_read_b64_tr_b16 a[224:225], v9 offset:0
  v_cvt_pk_bf16_f32 v185, v78, v79
  v_mfma_f32_16x16x32_bf16 v[108:111], a[164:167], v[244:247], v[108:111]
  v_exp_f32 v82, v82
  v_mfma_f32_16x16x32_bf16 v[108:111], a[160:163], v[240:243], v[108:111]
  ds_read_b64_tr_b16 a[226:227], v9 offset:4096
  v_cvt_pk_bf16_f32 v162, v80, v81
  v_mfma_f32_16x16x32_bf16 v[112:115], a[176:179], v[192:195], v[32:35]
  s_waitcnt lgkmcnt(15)
  v_exp_f32 v83, v83
  v_mfma_f32_16x16x32_bf16 v[112:115], a[180:183], v[196:199], v[112:115]
  buffer_load_dwordx4 v16, s[4:7], s24 offen offset:3072 lds
  v_mfma_f32_16x16x32_bf16 v[112:115], a[184:187], v[200:203], v[112:115]
  s_add_u32 s24, s24, 16384
  v_exp_f32 v84, v84
  v_mfma_f32_16x16x32_bf16 v[112:115], a[188:191], v[204:207], v[112:115]
  ds_read_b64_tr_b16 a[228:229], v9 offset:8192
  v_cvt_pk_bf16_f32 v163, v82, v83
  v_mfma_f32_16x16x32_bf16 v[116:119], a[188:191], v[220:223], v[36:39]
  v_exp_f32 v85, v85
  v_mfma_f32_16x16x32_bf16 v[116:119], a[184:187], v[216:219], v[116:119]
  ds_read_b64_tr_b16 a[230:231], v9 offset:12288
  v_add_f32 v26, v26, v84
  v_mfma_f32_16x16x32_bf16 v[116:119], a[180:183], v[212:215], v[116:119]
  v_exp_f32 v86, v86
  v_mfma_f32_16x16x32_bf16 v[116:119], a[176:179], v[208:211], v[116:119]
  ds_read_b64_tr_b16 a[232:233], v10 offset:0
  v_add_f32 v27, v27, v85
  v_mfma_f32_16x16x32_bf16 v[120:123], a[176:179], v[224:227], v[40:43]
  v_exp_f32 v87, v87
  v_mfma_f32_16x16x32_bf16 v[120:123], a[180:183], v[228:231], v[120:123]
  v_cvt_pk_bf16_f32 v170, v84, v85
  v_add_f32 v26, v26, v86
  v_mfma_f32_16x16x32_bf16 v[120:123], a[184:187], v[232:235], v[120:123]
  v_exp_f32 v88, v88
  v_mfma_f32_16x16x32_bf16 v[120:123], a[188:191], v[236:239], v[120:123]
  ds_read_b64_tr_b16 a[234:235], v10 offset:4096
  v_add_f32 v27, v27, v87
  v_mfma_f32_16x16x32_bf16 v[124:127], a[188:191], v[252:255], v[44:47]
  v_exp_f32 v89, v89
  v_mfma_f32_16x16x32_bf16 v[124:127], a[184:187], v[248:251], v[124:127]
  ds_read_b64_tr_b16 a[236:237], v10 offset:8192
  v_cvt_pk_bf16_f32 v171, v86, v87
  v_mfma_f32_16x16x32_bf16 v[124:127], a[180:183], v[244:247], v[124:127]
  v_exp_f32 v90, v90
  v_mfma_f32_16x16x32_bf16 v[124:127], a[176:179], v[240:243], v[124:127]
  s_mov_b32 m0, s62
  ds_read_b64_tr_b16 a[238:239], v10 offset:12288
  v_add_f32 v28, v28, v88
  v_mfma_f32_16x16x32_bf16 a[0:3], a[192:195], v[128:131], a[0:3]
  s_waitcnt lgkmcnt(15)
  v_exp_f32 v91, v91
  v_mfma_f32_16x16x32_bf16 a[0:3], a[196:199], v[132:135], a[0:3]
  s_bitcmp1_b32 s63, 0
  s_cbranch_scc0 L_fw_s3
  buffer_load_dwordx4 v30, s[64:67], s60 offen lds
  s_add_u32 s60, s60, s61
  s_add_u32 s62, s62, 1024
L_fw_s3:
  s_add_u32 m0, s26, 114688
  v_mfma_f32_16x16x32_bf16 a[4:7], a[192:195], v[136:139], a[4:7]
  buffer_load_dwordx4 v17, s[8:11], s25 offen offset:0 lds
  v_mfma_f32_16x16x32_bf16 a[4:7], a[196:199], v[140:143], a[4:7]
  s_lshr_b32 s63, s63, 1
  v_exp_f32 v92, v92
  v_mfma_f32_16x16x32_bf16 a[8:11], a[192:195], v[144:147], a[8:11]
  ds_read_b64_tr_b16 a[240:241], v11 offset:0
  v_add_f32 v29, v29, v89
  v_mfma_f32_16x16x32_bf16 a[8:11], a[196:199], v[148:151], a[8:11]
  v_exp_f32 v93, v93
  v_mfma_f32_16x16x32_bf16 a[12:15], a[192:195], v[152:155], a[12:15]
  ds_read_b64_tr_b16 a[242:243], v11 offset:4096
  v_cvt_pk_bf16_f32 v178, v88, v89
  v_mfma_f32_16x16x32_bf16 a[12:15], a[196:199], v[156:159], a[12:15]
  v_exp_f32 v94, v94
  v_mfma_f32_16x16x32_bf16 v[60:63], v[20:23], v[152:155], v[60:63]
  ds_read_b64_tr_b16 a[244:245], v11 offset:8192
  v_add_f32 v28, v28, v90
  v_mfma_f32_16x16x32_bf16 v[60:63], v[20:23], v[156:159], v[60:63]
  v_exp_f32 v95, v95
  v_mfma_f32_16x16x32_bf16 a[28:31], a[200:203], v[152:155], a[28:31]
  v_add_f32 v29, v29, v91
  v_cvt_pk_bf16_f32 v179, v90, v91
  v_mfma_f32_16x16x32_bf16 a[28:31], a[204:207], v[156:159], a[28:31]
  v_exp_f32 v96, v96
  v_mfma_f32_16x16x32_bf16 a[24:27], a[200:203], v[144:147], a[24:27]
  ds_read_b64_tr_b16 a[246:247], v11 offset:12288
  v_cvt_pk_bf16_f32 v186, v92, v93
  v_mfma_f32_16x16x32_bf16 a[24:27], a[204:207], v[148:151], a[24:27]
  v_exp_f32 v97, v97
  v_mfma_f32_16x16x32_bf16 a[20:23], a[200:203], v[136:139], a[20:23]
  ds_read_b64_tr_b16 a[248:249], v12 offset:0
  v_cvt_pk_bf16_f32 v187, v94, v95
  v_mfma_f32_16x16x32_bf16 a[20:23], a[204:207], v[140:143], a[20:23]
  v_exp_f32 v98, v98
  v_mfma_f32_16x16x32_bf16 a[16:19], a[200:203], v[128:131], a[16:19]
  ds_read_b64_tr_b16 a[250:251], v12 offset:4096
  v_cvt_pk_bf16_f32 v164, v96, v97
  v_mfma_f32_16x16x32_bf16 a[16:19], a[204:207], v[132:135], a[16:19]
  v_exp_f32 v99, v99
  v_mfma_f32_16x16x32_bf16 v[48:51], v[20:23], v[128:131], v[48:51]
  buffer_load_dwordx4 v18, s[8:11], s25 offen offset:1024 lds
  v_mfma_f32_16x16x32_bf16 v[48:51], v[20:23], v[132:135], v[48:51]
  s_waitcnt lgkmcnt(15)
  v_exp_f32 v100, v100
  v_mfma_f32_16x16x32_bf16 a[32:35], a[208:211], v[128:131], a[32:35]
  ds_read_b64_tr_b16 a[252:253], v12 offset:8192
  v_cvt_pk_bf16_f32 v165, v98, v99
  v_mfma_f32_16x16x32_bf16 a[32:35], a[212:215], v[132:135], a[32:35]
  v_exp_f32 v101, v101
  v_mfma_f32_16x16x32_bf16 a[36:39], a[208:211], v[136:139], a[36:39]
  ds_read_b64_tr_b16 a[254:255], v12 offset:12288
  v_add_f32 v26, v26, v100
  v_mfma_f32_16x16x32_bf16 a[36:39], a[212:215], v[140:143], a[36:39]
  v_exp_f32 v102, v102
  v_mfma_f32_16x16x32_bf16 a[40:43], a[208:211], v[144:147], a[40:43]
  ds_read_b128 a[128:131], v1 offset:32768
  v_add_f32 v27, v27, v101
  v_mfma_f32_16x16x32_bf16 a[40:43], a[212:215], v[148:151], a[40:43]
  v_exp_f32 v103, v103
  v_mfma_f32_16x16x32_bf16 a[44:47], a[208:211], v[152:155], a[44:47]
  v_cvt_pk_bf16_f32 v172, v100, v101
  v_add_f32 v26, v26, v102
  v_mfma_f32_16x16x32_bf16 a[44:47], a[212:215], v[156:159], a[44:47]
  v_exp_f32 v104, v104
  v_mfma_f32_16x16x32_bf16 a[60:63], a[216:219], v[152:155], a[60:63]
  s_waitcnt lgkmcnt(15)
  ds_read_b128 a[132:135], v2 offset:32768
  v_add_f32 v27, v27, v103
  v_mfma_f32_16x16x32_bf16 a[60:63], a[220:223], v[156:159], a[60:63]
  v_exp_f32 v105, v105
  v_mfma_f32_16x16x32_bf16 a[56:59], a[216:219], v[144:147], a[56:59]
  ds_read_b128 a[136:139], v3 offset:32768
  v_cvt_pk_bf16_f32 v173, v102, v103
  v_mfma_f32_16x16x32_bf16 a[56:59], a[220:223], v[148:151], a[56:59]
  v_exp_f32 v106, v106
  v_mfma_f32_16x16x32_bf16 a[52:55], a[216:219], v[136:139], a[52:55]
  ds_read_b128 a[140:143], v4 offset:32768
  v_add_f32 v28, v28, v104
  v_mfma_f32_16x16x32_bf16 a[52:55], a[220:223], v[140:143], a[52:55]
  v_exp_f32 v107, v107
  v_mfma_f32_16x16x32_bf16 a[48:51], a[216:219], v[128:131], a[48:51]
  v_mfma_f32_16x16x32_bf16 a[48:51], a[220:223], v[132:135], a[48:51]
  buffer_load_dwordx4 v17, s[8:11], s25 offen offset:2048 lds
  v_mfma_f32_16x16x32_bf16 a[64:67], a[224:227], v[128:131], a[64:67]
  s_waitcnt lgkmcnt(15)
  v_exp_f32 v108, v108
  v_mfma_f32_16x16x32_bf16 a[64:67], a[228:231], v[132:135], a[64:67]
  ds_read_b128 a[144:147], v1 offset:36864
  v_add_f32 v29, v29, v105
  v_mfma_f32_16x16x32_bf16 a[68:71], a[224:227], v[136:139], a[68:71]
  v_exp_f32 v109, v109
  v_mfma_f32_16x16x32_bf16 a[68:71], a[228:231], v[140:143], a[68:71]
  ds_read_b128 a[148:151], v2 offset:36864
  v_cvt_pk_bf16_f32 v180, v104, v105
  v_mfma_f32_16x16x32_bf16 a[72:75], a[224:227], v[144:147], a[72:75]
  v_exp_f32 v110, v110
  v_mfma_f32_16x16x32_bf16 a[72:75], a[228:231], v[148:151], a[72:75]
  ds_read_b128 a[152:155], v3 offset:36864
  v_add_f32 v28, v28, v106
  v_mfma_f32_16x16x32_bf16 a[76:79], a[224:227], v[152:155], a[76:79]
  v_exp_f32 v111, v111
  v_mfma_f32_16x16x32_bf16 a[76:79], a[228:231], v[156:159], a[76:79]
  s_waitcnt lgkmcnt(15)
  v_add_f32 v29, v29, v107
  v_cvt_pk_bf16_f32 v181, v106, v107
  v_mfma_f32_16x16x32_bf16 a[92:95], a[232:235], v[152:155], a[92:95]
  v_exp_f32 v112, v112
  v_mfma_f32_16x16x32_bf16 a[92:95], a[236:239], v[156:159], a[92:95]
  ds_read_b128 a[156:159], v4 offset:36864
  v_cvt_pk_bf16_f32 v188, v108, v109
  v_mfma_f32_16x16x32_bf16 a[88:91], a[232:235], v[144:147], a[88:91]
  v_exp_f32 v113, v113
  v_mfma_f32_16x16x32_bf16 a[88:91], a[236:239], v[148:151], a[88:91]
  ds_read_b128 a[160:163], v1 offset:40960
  v_cvt_pk_bf16_f32 v189, v110, v111
  v_mfma_f32_16x16x32_bf16 a[84:87], a[232:235], v[136:139], a[84:87]
  v_exp_f32 v114, v114
  v_mfma_f32_16x16x32_bf16 a[84:87], a[236:239], v[140:143], a[84:87]
  ds_read_b128 a[164:167], v2 offset:40960
  v_cvt_pk_bf16_f32 v166, v112, v113
  v_mfma_f32_16x16x32_bf16 a[80:83], a[232:235], v[128:131], a[80:83]
  v_exp_f32 v115, v115
  v_mfma_f32_16x16x32_bf16 a[80:83], a[236:239], v[132:135], a[80:83]
  s_waitcnt lgkmcnt(15)
  buffer_load_dwordx4 v18, s[8:11], s25 offen offset:3072 lds
  v_mfma_f32_16x16x32_bf16 a[96:99], a[240:243], v[128:131], a[96:99]
  s_waitcnt lgkmcnt(14)
  s_add_u32 s25, s25, 16384
  v_exp_f32 v116, v116
  v_mfma_f32_16x16x32_bf16 a[96:99], a[244:247], v[132:135], a[96:99]
  ds_read_b128 a[168:171], v3 offset:40960
  v_cvt_pk_bf16_f32 v167, v114, v115
  v_mfma_f32_16x16x32_bf16 a[100:103], a[240:243], v[136:139], a[100:103]
  v_exp_f32 v117, v117
  v_mfma_f32_16x16x32_bf16 a[100:103], a[244:247], v[140:143], a[100:103]
  ds_read_b128 a[172:175], v4 offset:40960
  v_add_f32 v26, v26, v116
  v_mfma_f32_16x16x32_bf16 a[104:107], a[240:243], v[144:147], a[104:107]
  v_exp_f32 v118, v118
  v_mfma_f32_16x16x32_bf16 a[104:107], a[244:247], v[148:151], a[104:107]
  ds_read_b128 a[176:179], v1 offset:45056
  v_add_f32 v27, v27, v117
  v_mfma_f32_16x16x32_bf16 a[108:111], a[240:243], v[152:155], a[108:111]
  v_exp_f32 v119, v119
  v_mfma_f32_16x16x32_bf16 a[108:111], a[244:247], v[156:159], a[108:111]
  s_waitcnt lgkmcnt(15)
  v_cvt_pk_bf16_f32 v174, v116, v117
  v_add_f32 v26, v26, v118
  v_mfma_f32_16x16x32_bf16 a[124:127], a[248:251], v[152:155], a[124:127]
  s_waitcnt lgkmcnt(13)
  v_exp_f32 v120, v120
  v_mfma_f32_16x16x32_bf16 a[124:127], a[252:255], v[156:159], a[124:127]
  ds_read_b128 a[180:183], v2 offset:45056
  v_add_f32 v27, v27, v119
  v_mfma_f32_16x16x32_bf16 a[120:123], a[248:251], v[144:147], a[120:123]
  v_exp_f32 v121, v121
  v_mfma_f32_16x16x32_bf16 a[120:123], a[252:255], v[148:151], a[120:123]
  ds_read_b128 a[184:187], v3 offset:45056
  v_cvt_pk_bf16_f32 v175, v118, v119
  v_mfma_f32_16x16x32_bf16 a[116:119], a[248:251], v[136:139], a[116:119]
  v_exp_f32 v122, v122
  v_mfma_f32_16x16x32_bf16 a[116:119], a[252:255], v[140:143], a[116:119]
  ds_read_b128 a[188:191], v4 offset:45056
  v_add_f32 v28, v28, v120
  v_mfma_f32_16x16x32_bf16 a[112:115], a[248:251], v[128:131], a[112:115]
  s_add_u32 m0, s26, 16384
  v_exp_f32 v123, v123
  v_mfma_f32_16x16x32_bf16 a[112:115], a[252:255], v[132:135], a[112:115]
  s_waitcnt vmcnt(12) lgkmcnt(15)
  s_sub_u32 s23, s23, 1
  s_cmp_lg_u32 s23, 0
  s_barrier
  s_cbranch_scc1 L_attn_loop
  v_mfma_f32_16x16x32_bf16 v[64:67], a[128:131], v[192:195], v[32:35]
  s_waitcnt lgkmcnt(14)
  buffer_load_dwordx4 v13, s[4:7], s24 offen offset:0 lds
  v_mfma_f32_16x16x32_bf16 v[64:67], a[132:135], v[196:199], v[64:67]
  s_waitcnt lgkmcnt(13)
  v_exp_f32 v124, v124
  v_mfma_f32_16x16x32_bf16 v[64:67], a[136:139], v[200:203], v[64:67]
  s_waitcnt lgkmcnt(12)
  s_lshr_b32 s27, s2, 3
  ds_read_b64_tr_b16 a[192:193], v5 offset:16384
  v_add_f32 v29, v29, v121
  v_mfma_f32_16x16x32_bf16 v[64:67], a[140:143], v[204:207], v[64:67]
  s_lshl_b32 s27, s27, 2
  v_exp_f32 v125, v125
  v_mfma_f32_16x16x32_bf16 v[68:71], a[140:143], v[220:223], v[36:39]
  s_add_u32 s27, s27, s20
  ds_read_b64_tr_b16 a[194:195], v5 offset:20480
  v_cvt_pk_bf16_f32 v182, v120, v121
  v_mfma_f32_16x16x32_bf16 v[68:71], a[136:139], v[216:219], v[68:71]
  s_lshl_b32 s27, s27, 7
  v_exp_f32 v126, v126
  v_mfma_f32_16x16x32_bf16 v[68:71], a[132:135], v[212:215], v[68:71]
  ds_read_b64_tr_b16 a[196:197], v5 offset:24576
  v_add_f32 v28, v28, v122
  v_mfma_f32_16x16x32_bf16 v[68:71], a[128:131], v[208:211], v[68:71]
  v_exp_f32 v127, v127
  v_mfma_f32_16x16x32_bf16 v[72:75], a[128:131], v[224:227], v[40:43]
  v_add_f32 v29, v29, v123
  v_cvt_pk_bf16_f32 v183, v122, v123
  v_mfma_f32_16x16x32_bf16 v[72:75], a[132:135], v[228:231], v[72:75]
  v_exp_f32 v64, v64
  v_mfma_f32_16x16x32_bf16 v[72:75], a[136:139], v[232:235], v[72:75]
  ds_read_b64_tr_b16 a[198:199], v5 offset:28672
  v_cvt_pk_bf16_f32 v190, v124, v125
  v_mfma_f32_16x16x32_bf16 v[72:75], a[140:143], v[236:239], v[72:75]
  v_exp_f32 v65, v65
  v_mfma_f32_16x16x32_bf16 v[76:79], a[140:143], v[252:255], v[44:47]
  ds_read_b64_tr_b16 a[200:201], v6 offset:16384
  v_cvt_pk_bf16_f32 v191, v126, v127
  v_mfma_f32_16x16x32_bf16 v[76:79], a[136:139], v[248:251], v[76:79]
  v_exp_f32 v66, v66
  v_mfma_f32_16x16x32_bf16 v[76:79], a[132:135], v[244:247], v[76:79]
  ds_read_b64_tr_b16 a[202:203], v6 offset:20480
  v_cvt_pk_bf16_f32 v128, v64, v65
  v_mfma_f32_16x16x32_bf16 v[76:79], a[128:131], v[240:243], v[76:79]
  s_waitcnt lgkmcnt(15)
  v_exp_f32 v67, v67
  v_mfma_f32_16x16x32_bf16 v[80:83], a[144:147], v[192:195], v[32:35]
  buffer_load_dwordx4 v14, s[4:7], s24 offen offset:1024 lds
  v_mfma_f32_16x16x32_bf16 v[80:83], a[148:151], v[196:199], v[80:83]
  v_exp_f32 v68, v68
  v_mfma_f32_16x16x32_bf16 v[80:83], a[152:155], v[200:203], v[80:83]
  s_waitcnt lgkmcnt(14)
  ds_read_b64_tr_b16 a[204:205], v6 offset:24576
  v_cvt_pk_bf16_f32 v129, v66, v67
  v_mfma_f32_16x16x32_bf16 v[80:83], a[156:159], v[204:207], v[80:83]
  v_exp_f32 v69, v69
  v_mfma_f32_16x16x32_bf16 v[84:87], a[156:159], v[220:223], v[36:39]
  ds_read_b64_tr_b16 a[206:207], v6 offset:28672
  v_add_f32 v26, v26, v68
  v_mfma_f32_16x16x32_bf16 v[84:87], a[152:155], v[216:219], v[84:87]
  v_exp_f32 v70, v70
  v_mfma_f32_16x16x32_bf16 v[84:87], a[148:151], v[212:215], v[84:87]
  ds_read_b64_tr_b16 a[208:209], v7 offset:16384
  v_add_f32 v27, v27, v69
  v_mfma_f32_16x16x32_bf16 v[84:87], a[144:147], v[208:211], v[84:87]
  v_exp_f32 v71, v71
  v_mfma_f32_16x16x32_bf16 v[88:91], a[144:147], v[224:227], v[40:43]
  v_cvt_pk_bf16_f32 v136, v68, v69
  v_add_f32 v26, v26, v70
  v_mfma_f32_16x16x32_bf16 v[88:91], a[148:151], v[228:231], v[88:91]
  v_exp_f32 v72, v72
  v_mfma_f32_16x16x32_bf16 v[88:91], a[152:155], v[232:235], v[88:91]
  ds_read_b64_tr_b16 a[210:211], v7 offset:20480
  v_add_f32 v27, v27, v71
  v_mfma_f32_16x16x32_bf16 v[88:91], a[156:159], v[236:239], v[88:91]
  v_exp_f32 v73, v73
  v_mfma_f32_16x16x32_bf16 v[92:95], a[156:159], v[252:255], v[44:47]
  ds_read_b64_tr_b16 a[212:213], v7 offset:24576
  v_cvt_pk_bf16_f32 v137, v70, v71
  v_mfma_f32_16x16x32_bf16 v[92:95], a[152:155], v[248:251], v[92:95]
  v_exp_f32 v74, v74
  v_mfma_f32_16x16x32_bf16 v[92:95], a[148:151], v[244:247], v[92:95]
  ds_read_b64_tr_b16 a[214:215], v7 offset:28672
  v_add_f32 v28, v28, v72
  v_mfma_f32_16x16x32_bf16 v[92:95], a[144:147], v[240:243], v[92:95]
  s_waitcnt lgkmcnt(15)
  v_exp_f32 v75, v75
  v_mfma_f32_16x16x32_bf16 v[96:99], a[160:163], v[192:195], v[32:35]
  buffer_load_dword v56, v57, s[12:15], s27 offen
  v_mfma_f32_16x16x32_bf16 v[96:99], a[164:167], v[196:199], v[96:99]
  buffer_load_dwordx4 v15, s[4:7], s24 offen offset:2048 lds
  v_mfma_f32_16x16x32_bf16 v[96:99], a[168:171], v[200:203], v[96:99]
  s_mov_b32 s12, s38
  v_exp_f32 v76, v76
  v_mfma_f32_16x16x32_bf16 v[96:99], a[172:175], v[204:207], v[96:99]
  s_mov_b32 s13, s39
  ds_read_b64_tr_b16 a[216:217], v8 offset:16384
  v_add_f32 v29, v29, v73
  v_mfma_f32_16x16x32_bf16 v[100:103], a[172:175], v[220:223], v[36:39]
  s_mov_b32 s14, 4194304
  v_exp_f32 v77, v77
  v_mfma_f32_16x16x32_bf16 v[100:103], a[168:171], v[216:219], v[100:103]
  s_lshl_b32 s27, s27, 6
  ds_read_b64_tr_b16 a[218:219], v8 offset:20480
  v_cvt_pk_bf16_f32 v144, v72, v73
  v_mfma_f32_16x16x32_bf16 v[100:103], a[164:167], v[212:215], v[100:103]
  s_lshr_b32 s34, s21, 3
  v_exp_f32 v78, v78
  v_mfma_f32_16x16x32_bf16 v[100:103], a[160:163], v[208:211], v[100:103]
  s_lshl_b32 s34, s34, 20
  ds_read_b64_tr_b16 a[220:221], v8 offset:24576
  v_add_f32 v28, v28, v74
  v_mfma_f32_16x16x32_bf16 v[104:107], a[160:163], v[224:227], v[40:43]
  s_add_u32 s27, s27, s34
  v_exp_f32 v79, v79
  v_mfma_f32_16x16x32_bf16 v[104:107], a[164:167], v[228:231], v[104:107]
  v_add_f32 v29, v29, v75
  v_cvt_pk_bf16_f32 v145, v74, v75
  v_mfma_f32_16x16x32_bf16 v[104:107], a[168:171], v[232:235], v[104:107]
  v_exp_f32 v80, v80
  v_mfma_f32_16x16x32_bf16 v[104:107], a[172:175], v[236:239], v[104:107]
  ds_read_b64_tr_b16 a[222:223], v8 offset:28672
  v_cvt_pk_bf16_f32 v152, v76, v77
  v_mfma_f32_16x16x32_bf16 v[108:111], a[172:175], v[252:255], v[44:47]
  v_exp_f32 v81, v81
  v_mfma_f32_16x16x32_bf16 v[108:111], a[168:171], v[248:251], v[108:111]
  ds_read_b64_tr_b16 a[224:225], v9 offset:16384
  v_cvt_pk_bf16_f32 v153, v78, v79
  v_mfma_f32_16x16x32_bf16 v[108:111], a[164:167], v[244:247], v[108:111]
  v_exp_f32 v82, v82
  v_mfma_f32_16x16x32_bf16 v[108:111], a[160:163], v[240:243], v[108:111]
  ds_read_b64_tr_b16 a[226:227], v9 offset:20480
  v_cvt_pk_bf16_f32 v130, v80, v81
  v_mfma_f32_16x16x32_bf16 v[112:115], a[176:179], v[192:195], v[32:35]
  s_waitcnt lgkmcnt(15)
  v_exp_f32 v83, v83
  v_mfma_f32_16x16x32_bf16 v[112:115], a[180:183], v[196:199], v[112:115]
  buffer_load_dwordx4 v16, s[4:7], s24 offen offset:3072 lds
  v_mfma_f32_16x16x32_bf16 v[112:115], a[184:187], v[200:203], v[112:115]
  s_add_u32 s24, s24, 16384
  v_exp_f32 v84, v84
  v_mfma_f32_16x16x32_bf16 v[112:115], a[188:191], v[204:207], v[112:115]
  ds_read_b64_tr_b16 a[228:229], v9 offset:24576
  v_cvt_pk_bf16_f32 v131, v82, v83
  v_mfma_f32_16x16x32_bf16 v[116:119], a[188:191], v[220:223], v[36:39]
  v_exp_f32 v85, v85
  v_mfma_f32_16x16x32_bf16 v[116:119], a[184:187], v[216:219], v[116:119]
  ds_read_b64_tr_b16 a[230:231], v9 offset:28672
  v_add_f32 v26, v26, v84
  v_mfma_f32_16x16x32_bf16 v[116:119], a[180:183], v[212:215], v[116:119]
  v_exp_f32 v86, v86
  v_mfma_f32_16x16x32_bf16 v[116:119], a[176:179], v[208:211], v[116:119]
  ds_read_b64_tr_b16 a[232:233], v10 offset:16384
  v_add_f32 v27, v27, v85
  v_mfma_f32_16x16x32_bf16 v[120:123], a[176:179], v[224:227], v[40:43]
  v_exp_f32 v87, v87
  v_mfma_f32_16x16x32_bf16 v[120:123], a[180:183], v[228:231], v[120:123]
  v_cvt_pk_bf16_f32 v138, v84, v85
  v_add_f32 v26, v26, v86
  v_mfma_f32_16x16x32_bf16 v[120:123], a[184:187], v[232:235], v[120:123]
  v_exp_f32 v88, v88
  v_mfma_f32_16x16x32_bf16 v[120:123], a[188:191], v[236:239], v[120:123]
  ds_read_b64_tr_b16 a[234:235], v10 offset:20480
  v_add_f32 v27, v27, v87
  v_mfma_f32_16x16x32_bf16 v[124:127], a[188:191], v[252:255], v[44:47]
  v_exp_f32 v89, v89
  v_mfma_f32_16x16x32_bf16 v[124:127], a[184:187], v[248:251], v[124:127]
  ds_read_b64_tr_b16 a[236:237], v10 offset:24576
  v_cvt_pk_bf16_f32 v139, v86, v87
  v_mfma_f32_16x16x32_bf16 v[124:127], a[180:183], v[244:247], v[124:127]
  v_exp_f32 v90, v90
  v_mfma_f32_16x16x32_bf16 v[124:127], a[176:179], v[240:243], v[124:127]
  ds_read_b64_tr_b16 a[238:239], v10 offset:28672
  v_add_f32 v28, v28, v88
  v_mfma_f32_16x16x32_bf16 a[0:3], a[192:195], v[160:163], a[0:3]
  s_waitcnt lgkmcnt(15)
  s_add_u32 m0, s26, 65536
  v_exp_f32 v91, v91
  v_mfma_f32_16x16x32_bf16 a[0:3], a[196:199], v[164:167], a[0:3]
  buffer_load_dword v56, v58, s[12:15], s27 offen offset:0
  v_mfma_f32_16x16x32_bf16 a[4:7], a[192:195], v[168:171], a[4:7]
  buffer_load_dwordx4 v17, s[8:11], s25 offen offset:0 lds
  v_mfma_f32_16x16x32_bf16 a[4:7], a[196:199], v[172:175], a[4:7]
  v_exp_f32 v92, v92
  v_mfma_f32_16x16x32_bf16 a[8:11], a[192:195], v[176:179], a[8:11]
  ds_read_b64_tr_b16 a[240:241], v11 offset:16384
  v_add_f32 v29, v29, v89
  v_mfma_f32_16x16x32_bf16 a[8:11], a[196:199], v[180:183], a[8:11]
  v_exp_f32 v93, v93
  v_mfma_f32_16x16x32_bf16 a[12:15], a[192:195], v[184:187], a[12:15]
  ds_read_b64_tr_b16 a[242:243], v11 offset:20480
  v_cvt_pk_bf16_f32 v146, v88, v89
  v_mfma_f32_16x16x32_bf16 a[12:15], a[196:199], v[188:191], a[12:15]
  v_exp_f32 v94, v94
  v_mfma_f32_16x16x32_bf16 v[60:63], v[20:23], v[184:187], v[60:63]
  ds_read_b64_tr_b16 a[244:245], v11 offset:24576
  v_add_f32 v28, v28, v90
  v_mfma_f32_16x16x32_bf16 v[60:63], v[20:23], v[188:191], v[60:63]
  v_exp_f32 v95, v95
  v_mfma_f32_16x16x32_bf16 a[28:31], a[200:203], v[184:187], a[28:31]
  v_add_f32 v29, v29, v91
  v_cvt_pk_bf16_f32 v147, v90, v91
  v_mfma_f32_16x16x32_bf16 a[28:31], a[204:207], v[188:191], a[28:31]
  v_exp_f32 v96, v96
  v_mfma_f32_16x16x32_bf16 a[24:27], a[200:203], v[176:179], a[24:27]
  ds_read_b64_tr_b16 a[246:247], v11 offset:28672
  v_cvt_pk_bf16_f32 v154, v92, v93
  v_mfma_f32_16x16x32_bf16 a[24:27], a[204:207], v[180:183], a[24:27]
  v_exp_f32 v97, v97
  v_mfma_f32_16x16x32_bf16 a[20:23], a[200:203], v[168:171], a[20:23]
  ds_read_b64_tr_b16 a[248:249], v12 offset:16384
  v_cvt_pk_bf16_f32 v155, v94, v95
  v_mfma_f32_16x16x32_bf16 a[20:23], a[204:207], v[172:175], a[20:23]
  v_exp_f32 v98, v98
  v_mfma_f32_16x16x32_bf16 a[16:19], a[200:203], v[160:163], a[16:19]
  ds_read_b64_tr_b16 a[250:251], v12 offset:20480
  v_cvt_pk_bf16_f32 v132, v96, v97
  v_mfma_f32_16x16x32_bf16 a[16:19], a[204:207], v[164:167], a[16:19]
  v_exp_f32 v99, v99
  v_mfma_f32_16x16x32_bf16 v[48:51], v[20:23], v[160:163], v[48:51]
  buffer_load_dwordx4 v18, s[8:11], s25 offen offset:1024 lds
  v_mfma_f32_16x16x32_bf16 v[48:51], v[20:23], v[164:167], v[48:51]
  s_waitcnt lgkmcnt(15)
  v_exp_f32 v100, v100
  v_mfma_f32_16x16x32_bf16 a[32:35], a[208:211], v[160:163], a[32:35]
  ds_read_b64_tr_b16 a[252:253], v12 offset:24576
  v_cvt_pk_bf16_f32 v133, v98, v99
  v_mfma_f32_16x16x32_bf16 a[32:35], a[212:215], v[164:167], a[32:35]
  v_exp_f32 v101, v101
  v_mfma_f32_16x16x32_bf16 a[36:39], a[208:211], v[168:171], a[36:39]
  ds_read_b64_tr_b16 a[254:255], v12 offset:28672
  v_add_f32 v26, v26, v100
  v_mfma_f32_16x16x32_bf16 a[36:39], a[212:215], v[172:175], a[36:39]
  v_exp_f32 v102, v102
  v_mfma_f32_16x16x32_bf16 a[40:43], a[208:211], v[176:179], a[40:43]
  ds_read_b128 a[128:131], v1 offset:49152
  v_add_f32 v27, v27, v101
  v_mfma_f32_16x16x32_bf16 a[40:43], a[212:215], v[180:183], a[40:43]
  v_exp_f32 v103, v103
  v_mfma_f32_16x16x32_bf16 a[44:47], a[208:211], v[184:187], a[44:47]
  v_cvt_pk_bf16_f32 v140, v100, v101
  v_add_f32 v26, v26, v102
  v_mfma_f32_16x16x32_bf16 a[44:47], a[212:215], v[188:191], a[44:47]
  v_exp_f32 v104, v104
  v_mfma_f32_16x16x32_bf16 a[60:63], a[216:219], v[184:187], a[60:63]
  s_waitcnt lgkmcnt(15)
  ds_read_b128 a[132:135], v2 offset:49152
  v_add_f32 v27, v27, v103
  v_mfma_f32_16x16x32_bf16 a[60:63], a[220:223], v[188:191], a[60:63]
  v_exp_f32 v105, v105
  v_mfma_f32_16x16x32_bf16 a[56:59], a[216:219], v[176:179], a[56:59]
  ds_read_b128 a[136:139], v3 offset:49152
  v_cvt_pk_bf16_f32 v141, v102, v103
  v_mfma_f32_16x16x32_bf16 a[56:59], a[220:223], v[180:183], a[56:59]
  v_exp_f32 v106, v106
  v_mfma_f32_16x16x32_bf16 a[52:55], a[216:219], v[168:171], a[52:55]
  ds_read_b128 a[140:143], v4 offset:49152
  v_add_f32 v28, v28, v104
  v_mfma_f32_16x16x32_bf16 a[52:55], a[220:223], v[172:175], a[52:55]
  v_exp_f32 v107, v107
  v_mfma_f32_16x16x32_bf16 a[48:51], a[216:219], v[160:163], a[48:51]
  buffer_load_dword v56, v58, s[12:15], s27 offen offset:2048
  v_mfma_f32_16x16x32_bf16 a[48:51], a[220:223], v[164:167], a[48:51]
  buffer_load_dwordx4 v17, s[8:11], s25 offen offset:2048 lds
  v_mfma_f32_16x16x32_bf16 a[64:67], a[224:227], v[160:163], a[64:67]
  s_waitcnt lgkmcnt(15)
  s_add_u32 s27, s27, 4096
  v_exp_f32 v108, v108
  v_mfma_f32_16x16x32_bf16 a[64:67], a[228:231], v[164:167], a[64:67]
  ds_read_b128 a[144:147], v1 offset:53248
  v_add_f32 v29, v29, v105
  v_mfma_f32_16x16x32_bf16 a[68:71], a[224:227], v[168:171], a[68:71]
  v_exp_f32 v109, v109
  v_mfma_f32_16x16x32_bf16 a[68:71], a[228:231], v[172:175], a[68:71]
  ds_read_b128 a[148:151], v2 offset:53248
  v_cvt_pk_bf16_f32 v148, v104, v105
  v_mfma_f32_16x16x32_bf16 a[72:75], a[224:227], v[176:179], a[72:75]
  v_exp_f32 v110, v110
  v_mfma_f32_16x16x32_bf16 a[72:75], a[228:231], v[180:183], a[72:75]
  ds_read_b128 a[152:155], v3 offset:53248
  v_add_f32 v28, v28, v106
  v_mfma_f32_16x16x32_bf16 a[76:79], a[224:227], v[184:187], a[76:79]
  v_exp_f32 v111, v111
  v_mfma_f32_16x16x32_bf16 a[76:79], a[228:231], v[188:191], a[76:79]
  s_waitcnt lgkmcnt(15)
  v_add_f32 v29, v29, v107
  v_cvt_pk_bf16_f32 v149, v106, v107
  v_mfma_f32_16x16x32_bf16 a[92:95], a[232:235], v[184:187], a[92:95]
  v_exp_f32 v112, v112
  v_mfma_f32_16x16x32_bf16 a[92:95], a[236:239], v[188:191], a[92:95]
  ds_read_b128 a[156:159], v4 offset:53248
  v_cvt_pk_bf16_f32 v156, v108, v109
  v_mfma_f32_16x16x32_bf16 a[88:91], a[232:235], v[176:179], a[88:91]
  v_exp_f32 v113, v113
  v_mfma_f32_16x16x32_bf16 a[88:91], a[236:239], v[180:183], a[88:91]
  ds_read_b128 a[160:163], v1 offset:57344
  v_cvt_pk_bf16_f32 v157, v110, v111
  v_mfma_f32_16x16x32_bf16 a[84:87], a[232:235], v[168:171], a[84:87]
  v_exp_f32 v114, v114
  v_mfma_f32_16x16x32_bf16 a[84:87], a[236:239], v[172:175], a[84:87]
  ds_read_b128 a[164:167], v2 offset:57344
  v_cvt_pk_bf16_f32 v134, v112, v113
  v_mfma_f32_16x16x32_bf16 a[80:83], a[232:235], v[160:163], a[80:83]
  v_exp_f32 v115, v115
  v_mfma_f32_16x16x32_bf16 a[80:83], a[236:239], v[164:167], a[80:83]
  s_waitcnt lgkmcnt(15)
  buffer_load_dwordx4 v18, s[8:11], s25 offen offset:3072 lds
  v_mfma_f32_16x16x32_bf16 a[96:99], a[240:243], v[160:163], a[96:99]
  s_waitcnt lgkmcnt(14)
  s_add_u32 s25, s25, 16384
  v_exp_f32 v116, v116
  v_mfma_f32_16x16x32_bf16 a[96:99], a[244:247], v[164:167], a[96:99]
  ds_read_b128 a[168:171], v3 offset:57344
  v_cvt_pk_bf16_f32 v135, v114, v115
  v_mfma_f32_16x16x32_bf16 a[100:103], a[240:243], v[168:171], a[100:103]
  v_exp_f32 v117, v117
  v_mfma_f32_16x16x32_bf16 a[100:103], a[244:247], v[172:175], a[100:103]
  ds_read_b128 a[172:175], v4 offset:57344
  v_add_f32 v26, v26, v116
  v_mfma_f32_16x16x32_bf16 a[104:107], a[240:243], v[176:179], a[104:107]
  v_exp_f32 v118, v118
  v_mfma_f32_16x16x32_bf16 a[104:107], a[244:247], v[180:183], a[104:107]
  ds_read_b128 a[176:179], v1 offset:61440
  v_add_f32 v27, v27, v117
  v_mfma_f32_16x16x32_bf16 a[108:111], a[240:243], v[184:187], a[108:111]
  v_exp_f32 v119, v119
  v_mfma_f32_16x16x32_bf16 a[108:111], a[244:247], v[188:191], a[108:111]
  s_waitcnt lgkmcnt(15)
  v_cvt_pk_bf16_f32 v142, v116, v117
  v_add_f32 v26, v26, v118
  v_mfma_f32_16x16x32_bf16 a[124:127], a[248:251], v[184:187], a[124:127]
  s_waitcnt lgkmcnt(13)
  v_exp_f32 v120, v120
  v_mfma_f32_16x16x32_bf16 a[124:127], a[252:255], v[188:191], a[124:127]
  ds_read_b128 a[180:183], v2 offset:61440
  v_add_f32 v27, v27, v119
  v_mfma_f32_16x16x32_bf16 a[120:123], a[248:251], v[176:179], a[120:123]
  v_exp_f32 v121, v121
  v_mfma_f32_16x16x32_bf16 a[120:123], a[252:255], v[180:183], a[120:123]
  ds_read_b128 a[184:187], v3 offset:61440
  v_cvt_pk_bf16_f32 v143, v118, v119
  v_mfma_f32_16x16x32_bf16 a[116:119], a[248:251], v[168:171], a[116:119]
  v_exp_f32 v122, v122
  v_mfma_f32_16x16x32_bf16 a[116:119], a[252:255], v[172:175], a[116:119]
  ds_read_b128 a[188:191], v4 offset:61440
  v_add_f32 v28, v28, v120
  v_mfma_f32_16x16x32_bf16 a[112:115], a[248:251], v[160:163], a[112:115]
  s_add_u32 m0, s26, 32768
  v_exp_f32 v123, v123
  v_mfma_f32_16x16x32_bf16 a[112:115], a[252:255], v[164:167], a[112:115]
  s_waitcnt vmcnt(15) lgkmcnt(15)
  s_barrier
  v_mfma_f32_16x16x32_bf16 v[64:67], a[128:131], v[192:195], v[32:35]
  s_waitcnt lgkmcnt(14)
  buffer_load_dwordx4 v13, s[4:7], s24 offen offset:0 lds
  v_mfma_f32_16x16x32_bf16 v[64:67], a[132:135], v[196:199], v[64:67]
  s_waitcnt lgkmcnt(13)
  v_exp_f32 v124, v124
  v_mfma_f32_16x16x32_bf16 v[64:67], a[136:139], v[200:203], v[64:67]
  s_waitcnt lgkmcnt(12)
  ds_read_b64_tr_b16 a[192:193], v5 offset:32768
  v_add_f32 v29, v29, v121
  v_mfma_f32_16x16x32_bf16 v[64:67], a[140:143], v[204:207], v[64:67]
  v_exp_f32 v125, v125
  v_mfma_f32_16x16x32_bf16 v[68:71], a[140:143], v[220:223], v[36:39]
  ds_read_b64_tr_b16 a[194:195], v5 offset:36864
  v_cvt_pk_bf16_f32 v150, v120, v121
  v_mfma_f32_16x16x32_bf16 v[68:71], a[136:139], v[216:219], v[68:71]
  v_exp_f32 v126, v126
  v_mfma_f32_16x16x32_bf16 v[68:71], a[132:135], v[212:215], v[68:71]
  ds_read_b64_tr_b16 a[196:197], v5 offset:40960
  v_add_f32 v28, v28, v122
  v_mfma_f32_16x16x32_bf16 v[68:71], a[128:131], v[208:211], v[68:71]
  v_exp_f32 v127, v127
  v_mfma_f32_16x16x32_bf16 v[72:75], a[128:131], v[224:227], v[40:43]
  v_add_f32 v29, v29, v123
  v_cvt_pk_bf16_f32 v151, v122, v123
  v_mfma_f32_16x16x32_bf16 v[72:75], a[132:135], v[228:231], v[72:75]
  v_exp_f32 v64, v64
  v_mfma_f32_16x16x32_bf16 v[72:75], a[136:139], v[232:235], v[72:75]
  ds_read_b64_tr_b16 a[198:199], v5 offset:45056
  v_cvt_pk_bf16_f32 v158, v124, v125
  v_mfma_f32_16x16x32_bf16 v[72:75], a[140:143], v[236:239], v[72:75]
  v_exp_f32 v65, v65
  v_mfma_f32_16x16x32_bf16 v[76:79], a[140:143], v[252:255], v[44:47]
  ds_read_b64_tr_b16 a[200:201], v6 offset:32768
  v_cvt_pk_bf16_f32 v159, v126, v127
  v_mfma_f32_16x16x32_bf16 v[76:79], a[136:139], v[248:251], v[76:79]
  v_exp_f32 v66, v66
  v_mfma_f32_16x16x32_bf16 v[76:79], a[132:135], v[244:247], v[76:79]
  ds_read_b64_tr_b16 a[202:203], v6 offset:36864
  v_cvt_pk_bf16_f32 v160, v64, v65
  v_mfma_f32_16x16x32_bf16 v[76:79], a[128:131], v[240:243], v[76:79]
  s_waitcnt lgkmcnt(15)
  v_exp_f32 v67, v67
  v_mfma_f32_16x16x32_bf16 v[80:83], a[144:147], v[192:195], v[32:35]
  buffer_load_dwordx4 v14, s[4:7], s24 offen offset:1024 lds
  v_mfma_f32_16x16x32_bf16 v[80:83], a[148:151], v[196:199], v[80:83]
  v_exp_f32 v68, v68
  v_mfma_f32_16x16x32_bf16 v[80:83], a[152:155], v[200:203], v[80:83]
  s_waitcnt lgkmcnt(14)
  ds_read_b64_tr_b16 a[204:205], v6 offset:40960
  v_cvt_pk_bf16_f32 v161, v66, v67
  v_mfma_f32_16x16x32_bf16 v[80:83], a[156:159], v[204:207], v[80:83]
  v_exp_f32 v69, v69
  v_mfma_f32_16x16x32_bf16 v[84:87], a[156:159], v[220:223], v[36:39]
  ds_read_b64_tr_b16 a[206:207], v6 offset:45056
  v_add_f32 v26, v26, v68
  v_mfma_f32_16x16x32_bf16 v[84:87], a[152:155], v[216:219], v[84:87]
  v_exp_f32 v70, v70
  v_mfma_f32_16x16x32_bf16 v[84:87], a[148:151], v[212:215], v[84:87]
  ds_read_b64_tr_b16 a[208:209], v7 offset:32768
  v_add_f32 v27, v27, v69
  v_mfma_f32_16x16x32_bf16 v[84:87], a[144:147], v[208:211], v[84:87]
  v_exp_f32 v71, v71
  v_mfma_f32_16x16x32_bf16 v[88:91], a[144:147], v[224:227], v[40:43]
  v_cvt_pk_bf16_f32 v168, v68, v69
  v_add_f32 v26, v26, v70
  v_mfma_f32_16x16x32_bf16 v[88:91], a[148:151], v[228:231], v[88:91]
  v_exp_f32 v72, v72
  v_mfma_f32_16x16x32_bf16 v[88:91], a[152:155], v[232:235], v[88:91]
  ds_read_b64_tr_b16 a[210:211], v7 offset:36864
  v_add_f32 v27, v27, v71
  v_mfma_f32_16x16x32_bf16 v[88:91], a[156:159], v[236:239], v[88:91]
  v_exp_f32 v73, v73
  v_mfma_f32_16x16x32_bf16 v[92:95], a[156:159], v[252:255], v[44:47]
  ds_read_b64_tr_b16 a[212:213], v7 offset:40960
  v_cvt_pk_bf16_f32 v169, v70, v71
  v_mfma_f32_16x16x32_bf16 v[92:95], a[152:155], v[248:251], v[92:95]
  v_exp_f32 v74, v74
  v_mfma_f32_16x16x32_bf16 v[92:95], a[148:151], v[244:247], v[92:95]
  ds_read_b64_tr_b16 a[214:215], v7 offset:45056
  v_add_f32 v28, v28, v72
  v_mfma_f32_16x16x32_bf16 v[92:95], a[144:147], v[240:243], v[92:95]
  s_waitcnt lgkmcnt(15)
  v_exp_f32 v75, v75
  v_mfma_f32_16x16x32_bf16 v[96:99], a[160:163], v[192:195], v[32:35]
  buffer_load_dword v56, v58, s[12:15], s27 offen offset:0
  v_mfma_f32_16x16x32_bf16 v[96:99], a[164:167], v[196:199], v[96:99]
  buffer_load_dwordx4 v15, s[4:7], s24 offen offset:2048 lds
  v_mfma_f32_16x16x32_bf16 v[96:99], a[168:171], v[200:203], v[96:99]
  v_exp_f32 v76, v76
  v_mfma_f32_16x16x32_bf16 v[96:99], a[172:175], v[204:207], v[96:99]
  ds_read_b64_tr_b16 a[216:217], v8 offset:32768
  v_add_f32 v29, v29, v73
  v_mfma_f32_16x16x32_bf16 v[100:103], a[172:175], v[220:223], v[36:39]
  v_exp_f32 v77, v77
  v_mfma_f32_16x16x32_bf16 v[100:103], a[168:171], v[216:219], v[100:103]
  ds_read_b64_tr_b16 a[218:219], v8 offset:36864
  v_cvt_pk_bf16_f32 v176, v72, v73
  v_mfma_f32_16x16x32_bf16 v[100:103], a[164:167], v[212:215], v[100:103]
  v_exp_f32 v78, v78
  v_mfma_f32_16x16x32_bf16 v[100:103], a[160:163], v[208:211], v[100:103]
  ds_read_b64_tr_b16 a[220:221], v8 offset:40960
  v_add_f32 v28, v28, v74
  v_mfma_f32_16x16x32_bf16 v[104:107], a[160:163], v[224:227], v[40:43]
  v_exp_f32 v79, v79
  v_mfma_f32_16x16x32_bf16 v[104:107], a[164:167], v[228:231], v[104:107]
  v_add_f32 v29, v29, v75
  v_cvt_pk_bf16_f32 v177, v74, v75
  v_mfma_f32_16x16x32_bf16 v[104:107], a[168:171], v[232:235], v[104:107]
  v_exp_f32 v80, v80
  v_mfma_f32_16x16x32_bf16 v[104:107], a[172:175], v[236:239], v[104:107]
  ds_read_b64_tr_b16 a[222:223], v8 offset:45056
  v_cvt_pk_bf16_f32 v184, v76, v77
  v_mfma_f32_16x16x32_bf16 v[108:111], a[172:175], v[252:255], v[44:47]
  v_exp_f32 v81, v81
  v_mfma_f32_16x16x32_bf16 v[108:111], a[168:171], v[248:251], v[108:111]
  ds_read_b64_tr_b16 a[224:225], v9 offset:32768
  v_cvt_pk_bf16_f32 v185, v78, v79
  v_mfma_f32_16x16x32_bf16 v[108:111], a[164:167], v[244:247], v[108:111]
  v_exp_f32 v82, v82
  v_mfma_f32_16x16x32_bf16 v[108:111], a[160:163], v[240:243], v[108:111]
  ds_read_b64_tr_b16 a[226:227], v9 offset:36864
  v_cvt_pk_bf16_f32 v162, v80, v81
  v_mfma_f32_16x16x32_bf16 v[112:115], a[176:179], v[192:195], v[32:35]
  s_waitcnt lgkmcnt(15)
  v_exp_f32 v83, v83
  v_mfma_f32_16x16x32_bf16 v[112:115], a[180:183], v[196:199], v[112:115]
  buffer_load_dwordx4 v16, s[4:7], s24 offen offset:3072 lds
  v_mfma_f32_16x16x32_bf16 v[112:115], a[184:187], v[200:203], v[112:115]
  s_add_u32 s24, s24, 16384
  v_exp_f32 v84, v84
  v_mfma_f32_16x16x32_bf16 v[112:115], a[188:191], v[204:207], v[112:115]
  ds_read_b64_tr_b16 a[228:229], v9 offset:40960
  v_cvt_pk_bf16_f32 v163, v82, v83
  v_mfma_f32_16x16x32_bf16 v[116:119], a[188:191], v[220:223], v[36:39]
  v_exp_f32 v85, v85
  v_mfma_f32_16x16x32_bf16 v[116:119], a[184:187], v[216:219], v[116:119]
  ds_read_b64_tr_b16 a[230:231], v9 offset:45056
  v_add_f32 v26, v26, v84
  v_mfma_f32_16x16x32_bf16 v[116:119], a[180:183], v[212:215], v[116:119]
  v_exp_f32 v86, v86
  v_mfma_f32_16x16x32_bf16 v[116:119], a[176:179], v[208:211], v[116:119]
  ds_read_b64_tr_b16 a[232:233], v10 offset:32768
  v_add_f32 v27, v27, v85
  v_mfma_f32_16x16x32_bf16 v[120:123], a[176:179], v[224:227], v[40:43]
  v_exp_f32 v87, v87
  v_mfma_f32_16x16x32_bf16 v[120:123], a[180:183], v[228:231], v[120:123]
  v_cvt_pk_bf16_f32 v170, v84, v85
  v_add_f32 v26, v26, v86
  v_mfma_f32_16x16x32_bf16 v[120:123], a[184:187], v[232:235], v[120:123]
  v_exp_f32 v88, v88
  v_mfma_f32_16x16x32_bf16 v[120:123], a[188:191], v[236:239], v[120:123]
  ds_read_b64_tr_b16 a[234:235], v10 offset:36864
  v_add_f32 v27, v27, v87
  v_mfma_f32_16x16x32_bf16 v[124:127], a[188:191], v[252:255], v[44:47]
  v_exp_f32 v89, v89
  v_mfma_f32_16x16x32_bf16 v[124:127], a[184:187], v[248:251], v[124:127]
  ds_read_b64_tr_b16 a[236:237], v10 offset:40960
  v_cvt_pk_bf16_f32 v171, v86, v87
  v_mfma_f32_16x16x32_bf16 v[124:127], a[180:183], v[244:247], v[124:127]
  v_exp_f32 v90, v90
  v_mfma_f32_16x16x32_bf16 v[124:127], a[176:179], v[240:243], v[124:127]
  ds_read_b64_tr_b16 a[238:239], v10 offset:45056
  v_add_f32 v28, v28, v88
  v_mfma_f32_16x16x32_bf16 a[0:3], a[192:195], v[128:131], a[0:3]
  s_waitcnt lgkmcnt(15)
  s_add_u32 m0, s26, 81920
  v_exp_f32 v91, v91
  v_mfma_f32_16x16x32_bf16 a[0:3], a[196:199], v[132:135], a[0:3]
  buffer_load_dword v56, v58, s[12:15], s27 offen offset:2048
  v_mfma_f32_16x16x32_bf16 a[4:7], a[192:195], v[136:139], a[4:7]
  buffer_load_dwordx4 v17, s[8:11], s25 offen offset:0 lds
  v_mfma_f32_16x16x32_bf16 a[4:7], a[196:199], v[140:143], a[4:7]
  v_exp_f32 v92, v92
  v_mfma_f32_16x16x32_bf16 a[8:11], a[192:195], v[144:147], a[8:11]
  ds_read_b64_tr_b16 a[240:241], v11 offset:32768
  v_add_f32 v29, v29, v89
  v_mfma_f32_16x16x32_bf16 a[8:11], a[196:199], v[148:151], a[8:11]
  v_exp_f32 v93, v93
  v_mfma_f32_16x16x32_bf16 a[12:15], a[192:195], v[152:155], a[12:15]
  ds_read_b64_tr_b16 a[242:243], v11 offset:36864
  v_cvt_pk_bf16_f32 v178, v88, v89
  v_mfma_f32_16x16x32_bf16 a[12:15], a[196:199], v[156:159], a[12:15]
  v_exp_f32 v94, v94
  v_mfma_f32_16x16x32_bf16 v[60:63], v[20:23], v[152:155], v[60:63]
  ds_read_b64_tr_b16 a[244:245], v11 offset:40960
  v_add_f32 v28, v28, v90
  v_mfma_f32_16x16x32_bf16 v[60:63], v[20:23], v[156:159], v[60:63]
  v_exp_f32 v95, v95
  v_mfma_f32_16x16x32_bf16 a[28:31], a[200:203], v[152:155], a[28:31]
  v_add_f32 v29, v29, v91
  v_cvt_pk_bf16_f32 v179, v90, v91
  v_mfma_f32_16x16x32_bf16 a[28:31], a[204:207], v[156:159], a[28:31]
  v_exp_f32 v96, v96
  v_mfma_f32_16x16x32_bf16 a[24:27], a[200:203], v[144:147], a[24:27]
  ds_read_b64_tr_b16 a[246:247], v11 offset:45056
  v_cvt_pk_bf16_f32 v186, v92, v93
  v_mfma_f32_16x16x32_bf16 a[24:27], a[204:207], v[148:151], a[24:27]
  v_exp_f32 v97, v97
  v_mfma_f32_16x16x32_bf16 a[20:23], a[200:203], v[136:139], a[20:23]
  ds_read_b64_tr_b16 a[248:249], v12 offset:32768
  v_cvt_pk_bf16_f32 v187, v94, v95
  v_mfma_f32_16x16x32_bf16 a[20:23], a[204:207], v[140:143], a[20:23]
  v_exp_f32 v98, v98
  v_mfma_f32_16x16x32_bf16 a[16:19], a[200:203], v[128:131], a[16:19]
  ds_read_b64_tr_b16 a[250:251], v12 offset:36864
  v_cvt_pk_bf16_f32 v164, v96, v97
  v_mfma_f32_16x16x32_bf16 a[16:19], a[204:207], v[132:135], a[16:19]
  v_exp_f32 v99, v99
  v_mfma_f32_16x16x32_bf16 v[48:51], v[20:23], v[128:131], v[48:51]
  buffer_load_dwordx4 v18, s[8:11], s25 offen offset:1024 lds
  v_mfma_f32_16x16x32_bf16 v[48:51], v[20:23], v[132:135], v[48:51]
  s_waitcnt lgkmcnt(15)
  v_exp_f32 v100, v100
  v_mfma_f32_16x16x32_bf16 a[32:35], a[208:211], v[128:131], a[32:35]
  ds_read_b64_tr_b16 a[252:253], v12 offset:40960
  v_cvt_pk_bf16_f32 v165, v98, v99
  v_mfma_f32_16x16x32_bf16 a[32:35], a[212:215], v[132:135], a[32:35]
  v_exp_f32 v101, v101
  v_mfma_f32_16x16x32_bf16 a[36:39], a[208:211], v[136:139], a[36:39]
  ds_read_b64_tr_b16 a[254:255], v12 offset:45056
  v_add_f32 v26, v26, v100
  v_mfma_f32_16x16x32_bf16 a[36:39], a[212:215], v[140:143], a[36:39]
  v_exp_f32 v102, v102
  v_mfma_f32_16x16x32_bf16 a[40:43], a[208:211], v[144:147], a[40:43]
  ds_read_b128 a[128:131], v1 offset:0
  v_add_f32 v27, v27, v101
  v_mfma_f32_16x16x32_bf16 a[40:43], a[212:215], v[148:151], a[40:43]
  v_exp_f32 v103, v103
  v_mfma_f32_16x16x32_bf16 a[44:47], a[208:211], v[152:155], a[44:47]
  v_cvt_pk_bf16_f32 v172, v100, v101
  v_add_f32 v26, v26, v102
  v_mfma_f32_16x16x32_bf16 a[44:47], a[212:215], v[156:159], a[44:47]
  v_exp_f32 v104, v104
  v_mfma_f32_16x16x32_bf16 a[60:63], a[216:219], v[152:155], a[60:63]
  s_waitcnt lgkmcnt(15)
  ds_read_b128 a[132:135], v2 offset:0
  v_add_f32 v27, v27, v103
  v_mfma_f32_16x16x32_bf16 a[60:63], a[220:223], v[156:159], a[60:63]
  v_exp_f32 v105, v105
  v_mfma_f32_16x16x32_bf16 a[56:59], a[216:219], v[144:147], a[56:59]
  ds_read_b128 a[136:139], v3 offset:0
  v_cvt_pk_bf16_f32 v173, v102, v103
  v_mfma_f32_16x16x32_bf16 a[56:59], a[220:223], v[148:151], a[56:59]
  v_exp_f32 v106, v106
  v_mfma_f32_16x16x32_bf16 a[52:55], a[216:219], v[136:139], a[52:55]
  ds_read_b128 a[140:143], v4 offset:0
  v_add_f32 v28, v28, v104
  v_mfma_f32_16x16x32_bf16 a[52:55], a[220:223], v[140:143], a[52:55]
  v_exp_f32 v107, v107
  v_mfma_f32_16x16x32_bf16 a[48:51], a[216:219], v[128:131], a[48:51]
  v_and_b32 v52, 0x300, v0
  v_and_b32 v53, 0xff, v17
  v_mfma_f32_16x16x32_bf16 a[48:51], a[220:223], v[132:135], a[48:51]
  buffer_load_dwordx4 v17, s[8:11], s25 offen offset:2048 lds
  v_mfma_f32_16x16x32_bf16 a[64:67], a[224:227], v[128:131], a[64:67]
  s_waitcnt lgkmcnt(15)
  v_exp_f32 v108, v108
  v_mfma_f32_16x16x32_bf16 a[64:67], a[228:231], v[132:135], a[64:67]
  ds_read_b128 a[144:147], v1 offset:4096
  v_add_f32 v29, v29, v105
  v_mfma_f32_16x16x32_bf16 a[68:71], a[224:227], v[136:139], a[68:71]
  v_exp_f32 v109, v109
  v_mfma_f32_16x16x32_bf16 a[68:71], a[228:231], v[140:143], a[68:71]
  ds_read_b128 a[148:151], v2 offset:4096
  v_cvt_pk_bf16_f32 v180, v104, v105
  v_mfma_f32_16x16x32_bf16 a[72:75], a[224:227], v[144:147], a[72:75]
  v_exp_f32 v110, v110
  v_mfma_f32_16x16x32_bf16 a[72:75], a[228:231], v[148:151], a[72:75]
  ds_read_b128 a[152:155], v3 offset:4096
  v_add_f32 v28, v28, v106
  v_mfma_f32_16x16x32_bf16 a[76:79], a[224:227], v[152:155], a[76:79]
  v_exp_f32 v111, v111
  v_mfma_f32_16x16x32_bf16 a[76:79], a[228:231], v[156:159], a[76:79]
  s_waitcnt lgkmcnt(15)
  v_add_f32 v29, v29, v107
  v_cvt_pk_bf16_f32 v181, v106, v107
  v_mfma_f32_16x16x32_bf16 a[92:95], a[232:235], v[152:155], a[92:95]
  v_exp_f32 v112, v112
  v_mfma_f32_16x16x32_bf16 a[92:95], a[236:239], v[156:159], a[92:95]
  ds_read_b128 a[156:159], v4 offset:4096
  v_cvt_pk_bf16_f32 v188, v108, v109
  v_mfma_f32_16x16x32_bf16 a[88:91], a[232:235], v[144:147], a[88:91]
  v_exp_f32 v113, v113
  v_mfma_f32_16x16x32_bf16 a[88:91], a[236:239], v[148:151], a[88:91]
  ds_read_b128 a[160:163], v1 offset:8192
  v_cvt_pk_bf16_f32 v189, v110, v111
  v_mfma_f32_16x16x32_bf16 a[84:87], a[232:235], v[136:139], a[84:87]
  v_exp_f32 v114, v114
  v_mfma_f32_16x16x32_bf16 a[84:87], a[236:239], v[140:143], a[84:87]
  ds_read_b128 a[164:167], v2 offset:8192
  v_cvt_pk_bf16_f32 v166, v112, v113
  v_mfma_f32_16x16x32_bf16 a[80:83], a[232:235], v[128:131], a[80:83]
  v_exp_f32 v115, v115
  v_mfma_f32_16x16x32_bf16 a[80:83], a[236:239], v[132:135], a[80:83]
  s_waitcnt lgkmcnt(15)
  buffer_load_dwordx4 v18, s[8:11], s25 offen offset:3072 lds
  v_mfma_f32_16x16x32_bf16 a[96:99], a[240:243], v[128:131], a[96:99]
  s_waitcnt lgkmcnt(14)
  s_add_u32 s25, s25, 16384
  v_exp_f32 v116, v116
  v_mfma_f32_16x16x32_bf16 a[96:99], a[244:247], v[132:135], a[96:99]
  ds_read_b128 a[168:171], v3 offset:8192
  v_cvt_pk_bf16_f32 v167, v114, v115
  v_mfma_f32_16x16x32_bf16 a[100:103], a[240:243], v[136:139], a[100:103]
  v_exp_f32 v117, v117
  v_mfma_f32_16x16x32_bf16 a[100:103], a[244:247], v[140:143], a[100:103]
  ds_read_b128 a[172:175], v4 offset:8192
  v_add_f32 v26, v26, v116
  v_mfma_f32_16x16x32_bf16 a[104:107], a[240:243], v[144:147], a[104:107]
  v_exp_f32 v118, v118
  v_mfma_f32_16x16x32_bf16 a[104:107], a[244:247], v[148:151], a[104:107]
  ds_read_b128 a[176:179], v1 offset:12288
  v_add_f32 v27, v27, v117
  v_mfma_f32_16x16x32_bf16 a[108:111], a[240:243], v[152:155], a[108:111]
  v_exp_f32 v119, v119
  v_mfma_f32_16x16x32_bf16 a[108:111], a[244:247], v[156:159], a[108:111]
  s_waitcnt lgkmcnt(15)
  v_cvt_pk_bf16_f32 v174, v116, v117
  v_add_f32 v26, v26, v118
  v_mfma_f32_16x16x32_bf16 a[124:127], a[248:251], v[152:155], a[124:127]
  s_waitcnt lgkmcnt(13)
  v_exp_f32 v120, v120
  v_mfma_f32_16x16x32_bf16 a[124:127], a[252:255], v[156:159], a[124:127]
  ds_read_b128 a[180:183], v2 offset:12288
  v_add_f32 v27, v27, v119
  v_mfma_f32_16x16x32_bf16 a[120:123], a[248:251], v[144:147], a[120:123]
  v_exp_f32 v121, v121
  v_mfma_f32_16x16x32_bf16 a[120:123], a[252:255], v[148:151], a[120:123]
  ds_read_b128 a[184:187], v3 offset:12288
  v_cvt_pk_bf16_f32 v175, v118, v119
  v_mfma_f32_16x16x32_bf16 a[116:119], a[248:251], v[136:139], a[116:119]
  v_exp_f32 v122, v122
  v_mfma_f32_16x16x32_bf16 a[116:119], a[252:255], v[140:143], a[116:119]
  ds_read_b128 a[188:191], v4 offset:12288
  v_add_f32 v28, v28, v120
  v_mfma_f32_16x16x32_bf16 a[112:115], a[248:251], v[128:131], a[112:115]
  s_add_u32 m0, s26, 49152
  v_exp_f32 v123, v123
  v_mfma_f32_16x16x32_bf16 a[112:115], a[252:255], v[132:135], a[112:115]
  s_waitcnt vmcnt(16) lgkmcnt(15)
  s_barrier
L_attn_tailcode:
  v_mfma_f32_16x16x32_bf16 v[64:67], a[128:131], v[192:195], v[32:35]
  s_waitcnt lgkmcnt(14)
  buffer_load_dwordx4 v13, s[4:7], s24 offen offset:0 lds
  v_mfma_f32_16x16x32_bf16 v[64:67], a[132:135], v[196:199], v[64:67]
  s_waitcnt lgkmcnt(13)
  v_exp_f32 v124, v124
  v_mfma_f32_16x16x32_bf16 v[64:67], a[136:139], v[200:203], v[64:67]
  s_waitcnt lgkmcnt(12)
  s_and_b32 s27, s21, 3
  ds_read_b64_tr_b16 a[192:193], v5 offset:49152
  v_add_f32 v29, v29, v121
  v_mfma_f32_16x16x32_bf16 v[64:67], a[140:143], v[204:207], v[64:67]
  s_lshl_b32 s27, s27, 8
  v_exp_f32 v125, v125
  v_mfma_f32_16x16x32_bf16 v[68:71], a[140:143], v[220:223], v[36:39]
  s_add_u32 s27, s27, s34
  ds_read_b64_tr_b16 a[194:195], v5 offset:53248
  v_cvt_pk_bf16_f32 v182, v120, v121
  v_mfma_f32_16x16x32_bf16 v[68:71], a[136:139], v[216:219], v[68:71]
  s_lshr_b32 s34, s20, 1
  v_exp_f32 v126, v126
  v_mfma_f32_16x16x32_bf16 v[68:71], a[132:135], v[212:215], v[68:71]
  s_lshl_b32 s34, s34, 17
  ds_read_b64_tr_b16 a[196:197], v5 offset:57344
  v_add_f32 v28, v28, v122
  v_mfma_f32_16x16x32_bf16 v[68:71], a[128:131], v[208:211], v[68:71]
  s_add_u32 s27, s27, s34
  v_exp_f32 v127, v127
  v_mfma_f32_16x16x32_bf16 v[72:75], a[128:131], v[224:227], v[40:43]
  s_and_b32 s34, s20, 1
  v_add_f32 v29, v29, v123
  v_cvt_pk_bf16_f32 v183, v122, v123
  v_mfma_f32_16x16x32_bf16 v[72:75], a[132:135], v[228:231], v[72:75]
  s_lshl_b32 s34, s34, 14
  v_exp_f32 v64, v64
  v_mfma_f32_16x16x32_bf16 v[72:75], a[136:139], v[232:235], v[72:75]
  s_add_u32 s27, s27, s34
  ds_read_b64_tr_b16 a[198:199], v5 offset:61440
  v_cvt_pk_bf16_f32 v190, v124, v125
  v_mfma_f32_16x16x32_bf16 v[72:75], a[140:143], v[236:239], v[72:75]
  v_exp_f32 v65, v65
  v_mfma_f32_16x16x32_bf16 v[76:79], a[140:143], v[252:255], v[44:47]
  ds_read_b64_tr_b16 a[200:201], v6 offset:49152
  v_cvt_pk_bf16_f32 v191, v126, v127
  v_mfma_f32_16x16x32_bf16 v[76:79], a[136:139], v[248:251], v[76:79]
  v_exp_f32 v66, v66
  v_mfma_f32_16x16x32_bf16 v[76:79], a[132:135], v[244:247], v[76:79]
  ds_read_b64_tr_b16 a[202:203], v6 offset:53248
  v_cvt_pk_bf16_f32 v128, v64, v65
  v_mfma_f32_16x16x32_bf16 v[76:79], a[128:131], v[240:243], v[76:79]
  s_waitcnt lgkmcnt(15)
  v_exp_f32 v67, v67
  v_mfma_f32_16x16x32_bf16 v[80:83], a[144:147], v[192:195], v[32:35]
  buffer_load_dwordx4 v14, s[4:7], s24 offen offset:1024 lds
  v_mfma_f32_16x16x32_bf16 v[80:83], a[148:151], v[196:199], v[80:83]
  v_exp_f32 v68, v68
  v_mfma_f32_16x16x32_bf16 v[80:83], a[152:155], v[200:203], v[80:83]
  s_waitcnt lgkmcnt(14)
  ds_read_b64_tr_b16 a[204:205], v6 offset:57344
  v_cvt_pk_bf16_f32 v129, v66, v67
  v_mfma_f32_16x16x32_bf16 v[80:83], a[156:159], v[204:207], v[80:83]
  v_exp_f32 v69, v69
  v_mfma_f32_16x16x32_bf16 v[84:87], a[156:159], v[220:223], v[36:39]
  ds_read_b64_tr_b16 a[206:207], v6 offset:61440
  v_add_f32 v26, v26, v68
  v_mfma_f32_16x16x32_bf16 v[84:87], a[152:155], v[216:219], v[84:87]
  v_exp_f32 v70, v70
  v_mfma_f32_16x16x32_bf16 v[84:87], a[148:151], v[212:215], v[84:87]
  ds_read_b64_tr_b16 a[208:209], v7 offset:49152
  v_add_f32 v27, v27, v69
  v_mfma_f32_16x16x32_bf16 v[84:87], a[144:147], v[208:211], v[84:87]
  v_exp_f32 v71, v71
  v_mfma_f32_16x16x32_bf16 v[88:91], a[144:147], v[224:227], v[40:43]
  v_cvt_pk_bf16_f32 v136, v68, v69
  v_add_f32 v26, v26, v70
  v_mfma_f32_16x16x32_bf16 v[88:91], a[148:151], v[228:231], v[88:91]
  v_exp_f32 v72, v72
  v_mfma_f32_16x16x32_bf16 v[88:91], a[152:155], v[232:235], v[88:91]
  ds_read_b64_tr_b16 a[210:211], v7 offset:53248
  v_add_f32 v27, v27, v71
  v_mfma_f32_16x16x32_bf16 v[88:91], a[156:159], v[236:239], v[88:91]
  v_exp_f32 v73, v73
  v_mfma_f32_16x16x32_bf16 v[92:95], a[156:159], v[252:255], v[44:47]
  ds_read_b64_tr_b16 a[212:213], v7 offset:57344
  v_cvt_pk_bf16_f32 v137, v70, v71
  v_mfma_f32_16x16x32_bf16 v[92:95], a[152:155], v[248:251], v[92:95]
  v_exp_f32 v74, v74
  v_mfma_f32_16x16x32_bf16 v[92:95], a[148:151], v[244:247], v[92:95]
  ds_read_b64_tr_b16 a[214:215], v7 offset:61440
  v_add_f32 v28, v28, v72
  v_mfma_f32_16x16x32_bf16 v[92:95], a[144:147], v[240:243], v[92:95]
  s_waitcnt lgkmcnt(15)
  v_exp_f32 v75, v75
  v_mfma_f32_16x16x32_bf16 v[96:99], a[160:163], v[192:195], v[32:35]
  v_lshl_add_u32 v53, v52, 2, v53
  v_xor_b32 v54, 0x80, v53
  v_mfma_f32_16x16x32_bf16 v[96:99], a[164:167], v[196:199], v[96:99]
  buffer_load_dwordx4 v15, s[4:7], s24 offen offset:2048 lds
  v_mfma_f32_16x16x32_bf16 v[96:99], a[168:171], v[200:203], v[96:99]
  v_exp_f32 v76, v76
  v_mfma_f32_16x16x32_bf16 v[96:99], a[172:175], v[204:207], v[96:99]
  ds_read_b64_tr_b16 a[216:217], v8 offset:49152
  v_add_f32 v29, v29, v73
  v_mfma_f32_16x16x32_bf16 v[100:103], a[172:175], v[220:223], v[36:39]
  v_exp_f32 v77, v77
  v_mfma_f32_16x16x32_bf16 v[100:103], a[168:171], v[216:219], v[100:103]
  ds_read_b64_tr_b16 a[218:219], v8 offset:53248
  v_cvt_pk_bf16_f32 v144, v72, v73
  v_mfma_f32_16x16x32_bf16 v[100:103], a[164:167], v[212:215], v[100:103]
  v_exp_f32 v78, v78
  v_mfma_f32_16x16x32_bf16 v[100:103], a[160:163], v[208:211], v[100:103]
  ds_read_b64_tr_b16 a[220:221], v8 offset:57344
  v_add_f32 v28, v28, v74
  v_mfma_f32_16x16x32_bf16 v[104:107], a[160:163], v[224:227], v[40:43]
  v_exp_f32 v79, v79
  v_mfma_f32_16x16x32_bf16 v[104:107], a[164:167], v[228:231], v[104:107]
  v_add_f32 v29, v29, v75
  v_cvt_pk_bf16_f32 v145, v74, v75
  v_mfma_f32_16x16x32_bf16 v[104:107], a[168:171], v[232:235], v[104:107]
  v_exp_f32 v80, v80
  v_mfma_f32_16x16x32_bf16 v[104:107], a[172:175], v[236:239], v[104:107]
  ds_read_b64_tr_b16 a[222:223], v8 offset:61440
  v_cvt_pk_bf16_f32 v152, v76, v77
  v_mfma_f32_16x16x32_bf16 v[108:111], a[172:175], v[252:255], v[44:47]
  v_exp_f32 v81, v81
  v_mfma_f32_16x16x32_bf16 v[108:111], a[168:171], v[248:251], v[108:111]
  ds_read_b64_tr_b16 a[224:225], v9 offset:49152
  v_cvt_pk_bf16_f32 v153, v78, v79
  v_mfma_f32_16x16x32_bf16 v[108:111], a[164:167], v[244:247], v[108:111]
  v_exp_f32 v82, v82
  v_mfma_f32_16x16x32_bf16 v[108:111], a[160:163], v[240:243], v[108:111]
  ds_read_b64_tr_b16 a[226:227], v9 offset:53248
  v_cvt_pk_bf16_f32 v130, v80, v81
  v_mfma_f32_16x16x32_bf16 v[112:115], a[176:179], v[192:195], v[32:35]
  s_waitcnt lgkmcnt(15)
  v_exp_f32 v83, v83
  v_mfma_f32_16x16x32_bf16 v[112:115], a[180:183], v[196:199], v[112:115]
  buffer_load_dwordx4 v16, s[4:7], s24 offen offset:3072 lds
  v_mfma_f32_16x16x32_bf16 v[112:115], a[184:187], v[200:203], v[112:115]
  s_add_u32 s24, s24, 16384
  v_exp_f32 v84, v84
  v_mfma_f32_16x16x32_bf16 v[112:115], a[188:191], v[204:207], v[112:115]
  ds_read_b64_tr_b16 a[228:229], v9 offset:57344
  v_cvt_pk_bf16_f32 v131, v82, v83
  v_mfma_f32_16x16x32_bf16 v[116:119], a[188:191], v[220:223], v[36:39]
  v_exp_f32 v85, v85
  v_mfma_f32_16x16x32_bf16 v[116:119], a[184:187], v[216:219], v[116:119]
  ds_read_b64_tr_b16 a[230:231], v9 offset:61440
  v_add_f32 v26, v26, v84
  v_mfma_f32_16x16x32_bf16 v[116:119], a[180:183], v[212:215], v[116:119]
  v_exp_f32 v86, v86
  v_mfma_f32_16x16x32_bf16 v[116:119], a[176:179], v[208:211], v[116:119]
  ds_read_b64_tr_b16 a[232:233], v10 offset:49152
  v_add_f32 v27, v27, v85
  v_mfma_f32_16x16x32_bf16 v[120:123], a[176:179], v[224:227], v[40:43]
  v_exp_f32 v87, v87
  v_mfma_f32_16x16x32_bf16 v[120:123], a[180:183], v[228:231], v[120:123]
  v_cvt_pk_bf16_f32 v138, v84, v85
  v_add_f32 v26, v26, v86
  v_mfma_f32_16x16x32_bf16 v[120:123], a[184:187], v[232:235], v[120:123]
  v_exp_f32 v88, v88
  v_mfma_f32_16x16x32_bf16 v[120:123], a[188:191], v[236:239], v[120:123]
  ds_read_b64_tr_b16 a[234:235], v10 offset:53248
  v_add_f32 v27, v27, v87
  v_mfma_f32_16x16x32_bf16 v[124:127], a[188:191], v[252:255], v[44:47]
  v_exp_f32 v89, v89
  v_mfma_f32_16x16x32_bf16 v[124:127], a[184:187], v[248:251], v[124:127]
  ds_read_b64_tr_b16 a[236:237], v10 offset:57344
  v_cvt_pk_bf16_f32 v139, v86, v87
  v_mfma_f32_16x16x32_bf16 v[124:127], a[180:183], v[244:247], v[124:127]
  v_exp_f32 v90, v90
  v_mfma_f32_16x16x32_bf16 v[124:127], a[176:179], v[240:243], v[124:127]
  ds_read_b64_tr_b16 a[238:239], v10 offset:61440
  v_add_f32 v28, v28, v88
  v_mfma_f32_16x16x32_bf16 a[0:3], a[192:195], v[160:163], a[0:3]
  s_waitcnt lgkmcnt(15)
  s_add_u32 m0, s26, 98304
  v_exp_f32 v91, v91
  v_mfma_f32_16x16x32_bf16 a[0:3], a[196:199], v[164:167], a[0:3]
  v_add_u32 v13, 0, v53
  v_add_u32 v14, 3072, v54
  v_mfma_f32_16x16x32_bf16 a[4:7], a[192:195], v[168:171], a[4:7]
  buffer_load_dwordx4 v17, s[8:11], s25 offen offset:0 lds
  v_mfma_f32_16x16x32_bf16 a[4:7], a[196:199], v[172:175], a[4:7]
  v_exp_f32 v92, v92
  v_mfma_f32_16x16x32_bf16 a[8:11], a[192:195], v[176:179], a[8:11]
  ds_read_b64_tr_b16 a[240:241], v11 offset:49152
  v_add_f32 v29, v29, v89
  v_mfma_f32_16x16x32_bf16 a[8:11], a[196:199], v[180:183], a[8:11]
  v_exp_f32 v93, v93
  v_mfma_f32_16x16x32_bf16 a[12:15], a[192:195], v[184:187], a[12:15]
  ds_read_b64_tr_b16 a[242:243], v11 offset:53248
  v_cvt_pk_bf16_f32 v146, v88, v89
  v_mfma_f32_16x16x32_bf16 a[12:15], a[196:199], v[188:191], a[12:15]
  v_exp_f32 v94, v94
  v_mfma_f32_16x16x32_bf16 v[60:63], v[20:23], v[184:187], v[60:63]
  ds_read_b64_tr_b16 a[244:245], v11 offset:57344
  v_add_f32 v28, v28, v90
  v_mfma_f32_16x16x32_bf16 v[60:63], v[20:23], v[188:191], v[60:63]
  v_exp_f32 v95, v95
  v_mfma_f32_16x16x32_bf16 a[28:31], a[200:203], v[184:187], a[28:31]
  v_add_f32 v29, v29, v91
  v_cvt_pk_bf16_f32 v147, v90, v91
  v_mfma_f32_16x16x32_bf16 a[28:31], a[204:207], v[188:191], a[28:31]
  v_exp_f32 v96, v96
  v_mfma_f32_16x16x32_bf16 a[24:27], a[200:203], v[176:179], a[24:27]
  ds_read_b64_tr_b16 a[246:247], v11 offset:61440
  v_cvt_pk_bf16_f32 v154, v92, v93
  v_mfma_f32_16x16x32_bf16 a[24:27], a[204:207], v[180:183], a[24:27]
  v_exp_f32 v97, v97
  v_mfma_f32_16x16x32_bf16 a[20:23], a[200:203], v[168:171], a[20:23]
  ds_read_b64_tr_b16 a[248:249], v12 offset:49152
  v_cvt_pk_bf16_f32 v155, v94, v95
  v_mfma_f32_16x16x32_bf16 a[20:23], a[204:207], v[172:175], a[20:23]
  v_exp_f32 v98, v98
  v_mfma_f32_16x16x32_bf16 a[16:19], a[200:203], v[160:163], a[16:19]
  ds_read_b64_tr_b16 a[250:251], v12 offset:53248
  v_cvt_pk_bf16_f32 v132, v96, v97
  v_mfma_f32_16x16x32_bf16 a[16:19], a[204:207], v[164:167], a[16:19]
  v_exp_f32 v99, v99
  v_mfma_f32_16x16x32_bf16 v[48:51], v[20:23], v[160:163], v[48:51]
  buffer_load_dwordx4 v18, s[8:11], s25 offen offset:1024 lds
  v_mfma_f32_16x16x32_bf16 v[48:51], v[20:23], v[164:167], v[48:51]
  s_waitcnt lgkmcnt(15)
  v_exp_f32 v100, v100
  v_mfma_f32_16x16x32_bf16 a[32:35], a[208:211], v[160:163], a[32:35]
  ds_read_b64_tr_b16 a[252:253], v12 offset:57344
  v_cvt_pk_bf16_f32 v133, v98, v99
  v_mfma_f32_16x16x32_bf16 a[32:35], a[212:215], v[164:167], a[32:35]
  v_exp_f32 v101, v101
  v_mfma_f32_16x16x32_bf16 a[36:39], a[208:211], v[168:171], a[36:39]
  ds_read_b64_tr_b16 a[254:255], v12 offset:61440
  v_add_f32 v26, v26, v100
  v_mfma_f32_16x16x32_bf16 a[36:39], a[212:215], v[172:175], a[36:39]
  v_exp_f32 v102, v102
  v_mfma_f32_16x16x32_bf16 a[40:43], a[208:211], v[176:179], a[40:43]
  ds_read_b128 a[128:131], v1 offset:16384
  v_add_f32 v27, v27, v101
  v_mfma_f32_16x16x32_bf16 a[40:43], a[212:215], v[180:183], a[40:43]
  v_exp_f32 v103, v103
  v_mfma_f32_16x16x32_bf16 a[44:47], a[208:211], v[184:187], a[44:47]
  v_cvt_pk_bf16_f32 v140, v100, v101
  v_add_f32 v26, v26, v102
  v_mfma_f32_16x16x32_bf16 a[44:47], a[212:215], v[188:191], a[44:47]
  v_exp_f32 v104, v104
  v_mfma_f32_16x16x32_bf16 a[60:63], a[216:219], v[184:187], a[60:63]
  s_waitcnt lgkmcnt(15)
  ds_read_b128 a[132:135], v2 offset:16384
  v_add_f32 v27, v27, v103
  v_mfma_f32_16x16x32_bf16 a[60:63], a[220:223], v[188:191], a[60:63]
  v_exp_f32 v105, v105
  v_mfma_f32_16x16x32_bf16 a[56:59], a[216:219], v[176:179], a[56:59]
  ds_read_b128 a[136:139], v3 offset:16384
  v_cvt_pk_bf16_f32 v141, v102, v103
  v_mfma_f32_16x16x32_bf16 a[56:59], a[220:223], v[180:183], a[56:59]
  v_exp_f32 v106, v106
  v_mfma_f32_16x16x32_bf16 a[52:55], a[216:219], v[168:171], a[52:55]
  ds_read_b128 a[140:143], v4 offset:16384
  v_add_f32 v28, v28, v104
  v_mfma_f32_16x16x32_bf16 a[52:55], a[220:223], v[172:175], a[52:55]
  v_exp_f32 v107, v107
  v_mfma_f32_16x16x32_bf16 a[48:51], a[216:219], v[160:163], a[48:51]
  v_add_u32 v15, 6144, v53
  v_add_u32 v16, 9216, v54
  v_mfma_f32_16x16x32_bf16 a[48:51], a[220:223], v[164:167], a[48:51]
  buffer_load_dwordx4 v17, s[8:11], s25 offen offset:2048 lds
  v_mfma_f32_16x16x32_bf16 a[64:67], a[224:227], v[160:163], a[64:67]
  s_waitcnt lgkmcnt(15)
  v_exp_f32 v108, v108
  v_mfma_f32_16x16x32_bf16 a[64:67], a[228:231], v[164:167], a[64:67]
  ds_read_b128 a[144:147], v1 offset:20480
  v_add_f32 v29, v29, v105
  v_mfma_f32_16x16x32_bf16 a[68:71], a[224:227], v[168:171], a[68:71]
  v_exp_f32 v109, v109
  v_mfma_f32_16x16x32_bf16 a[68:71], a[228:231], v[172:175], a[68:71]
  ds_read_b128 a[148:151], v2 offset:20480
  v_cvt_pk_bf16_f32 v148, v104, v105
  v_mfma_f32_16x16x32_bf16 a[72:75], a[224:227], v[176:179], a[72:75]
  v_exp_f32 v110, v110
  v_mfma_f32_16x16x32_bf16 a[72:75], a[228:231], v[180:183], a[72:75]
  ds_read_b128 a[152:155], v3 offset:20480
  v_add_f32 v28, v28, v106
  v_mfma_f32_16x16x32_bf16 a[76:79], a[224:227], v[184:187], a[76:79]
  v_exp_f32 v111, v111
  v_mfma_f32_16x16x32_bf16 a[76:79], a[228:231], v[188:191], a[76:79]
  s_waitcnt lgkmcnt(15)
  v_add_f32 v29, v29, v107
  v_cvt_pk_bf16_f32 v149, v106, v107
  v_mfma_f32_16x16x32_bf16 a[92:95], a[232:235], v[184:187], a[92:95]
  v_exp_f32 v112, v112
  v_mfma_f32_16x16x32_bf16 a[92:95], a[236:239], v[188:191], a[92:95]
  ds_read_b128 a[156:159], v4 offset:20480
  v_cvt_pk_bf16_f32 v156, v108, v109
  v_mfma_f32_16x16x32_bf16 a[88:91], a[232:235], v[176:179], a[88:91]
  v_exp_f32 v113, v113
  v_mfma_f32_16x16x32_bf16 a[88:91], a[236:239], v[180:183], a[88:91]
  ds_read_b128 a[160:163], v1 offset:24576
  v_cvt_pk_bf16_f32 v157, v110, v111
  v_mfma_f32_16x16x32_bf16 a[84:87], a[232:235], v[168:171], a[84:87]
  v_exp_f32 v114, v114
  v_mfma_f32_16x16x32_bf16 a[84:87], a[236:239], v[172:175], a[84:87]
  ds_read_b128 a[164:167], v2 offset:24576
  v_cvt_pk_bf16_f32 v134, v112, v113
  v_mfma_f32_16x16x32_bf16 a[80:83], a[232:235], v[160:163], a[80:83]
  v_exp_f32 v115, v115
  v_mfma_f32_16x16x32_bf16 a[80:83], a[236:239], v[164:167], a[80:83]
  s_waitcnt lgkmcnt(15)
  buffer_load_dwordx4 v18, s[8:11], s25 offen offset:3072 lds
  v_mfma_f32_16x16x32_bf16 a[96:99], a[240:243], v[160:163], a[96:99]
  s_waitcnt lgkmcnt(14)
  s_add_u32 s25, s25, 16384
  v_exp_f32 v116, v116
  v_mfma_f32_16x16x32_bf16 a[96:99], a[244:247], v[164:167], a[96:99]
  ds_read_b128 a[168:171], v3 offset:24576
  v_cvt_pk_bf16_f32 v135, v114, v115
  v_mfma_f32_16x16x32_bf16 a[100:103], a[240:243], v[168:171], a[100:103]
  v_exp_f32 v117, v117
  v_mfma_f32_16x16x32_bf16 a[100:103], a[244:247], v[172:175], a[100:103]
  ds_read_b128 a[172:175], v4 offset:24576
  v_add_f32 v26, v26, v116
  v_mfma_f32_16x16x32_bf16 a[104:107], a[240:243], v[176:179], a[104:107]
  v_exp_f32 v118, v118
  v_mfma_f32_16x16x32_bf16 a[104:107], a[244:247], v[180:183], a[104:107]
  ds_read_b128 a[176:179], v1 offset:28672
  v_add_f32 v27, v27, v117
  v_mfma_f32_16x16x32_bf16 a[108:111], a[240:243], v[184:187], a[108:111]
  v_exp_f32 v119, v119
  v_mfma_f32_16x16x32_bf16 a[108:111], a[244:247], v[188:191], a[108:111]
  s_waitcnt lgkmcnt(15)
  v_cvt_pk_bf16_f32 v142, v116, v117
  v_add_f32 v26, v26, v118
  v_mfma_f32_16x16x32_bf16 a[124:127], a[248:251], v[184:187], a[124:127]
  s_waitcnt lgkmcnt(13)
  v_exp_f32 v120, v120
  v_mfma_f32_16x16x32_bf16 a[124:127], a[252:255], v[188:191], a[124:127]
  ds_read_b128 a[180:183], v2 offset:28672
  v_add_f32 v27, v27, v119
  v_mfma_f32_16x16x32_bf16 a[120:123], a[248:251], v[176:179], a[120:123]
  v_exp_f32 v121, v121
  v_mfma_f32_16x16x32_bf16 a[120:123], a[252:255], v[180:183], a[120:123]
  ds_read_b128 a[184:187], v3 offset:28672
  v_cvt_pk_bf16_f32 v143, v118, v119
  v_mfma_f32_16x16x32_bf16 a[116:119], a[248:251], v[168:171], a[116:119]
  v_exp_f32 v122, v122
  v_mfma_f32_16x16x32_bf16 a[116:119], a[252:255], v[172:175], a[116:119]
  ds_read_b128 a[188:191], v4 offset:28672
  v_add_f32 v28, v28, v120
  v_mfma_f32_16x16x32_bf16 a[112:115], a[248:251], v[160:163], a[112:115]
  s_add_u32 m0, s26, 0
  v_exp_f32 v123, v123
  v_mfma_f32_16x16x32_bf16 a[112:115], a[252:255], v[164:167], a[112:115]
  s_waitcnt vmcnt(13) lgkmcnt(15)
  s_barrier
  v_mfma_f32_16x16x32_bf16 v[64:67], a[128:131], v[192:195], v[32:35]
  s_waitcnt lgkmcnt(14)
  buffer_load_dwordx4 v13, s[12:15], s27 offen offset:0 lds
  v_mfma_f32_16x16x32_bf16 v[64:67], a[132:135], v[196:199], v[64:67]
  s_waitcnt lgkmcnt(13)
  v_exp_f32 v124, v124
  v_mfma_f32_16x16x32_bf16 v[64:67], a[136:139], v[200:203], v[64:67]
  s_waitcnt lgkmcnt(12)
  s_sub_u32 s44, s53, 2359296
  ds_read_b64_tr_b16 a[192:193], v5 offset:0
  v_add_f32 v29, v29, v121
  v_mfma_f32_16x16x32_bf16 v[64:67], a[140:143], v[204:207], v[64:67]
  s_lshr_b32 s44, s44, 10
  v_exp_f32 v125, v125
  v_mfma_f32_16x16x32_bf16 v[68:71], a[140:143], v[220:223], v[36:39]
  s_lshl_b32 s44, s44, 7
  ds_read_b64_tr_b16 a[194:195], v5 offset:4096
  v_cvt_pk_bf16_f32 v150, v120, v121
  v_mfma_f32_16x16x32_bf16 v[68:71], a[136:139], v[216:219], v[68:71]
  s_and_b32 s45, s21, 7
  v_exp_f32 v126, v126
  v_mfma_f32_16x16x32_bf16 v[68:71], a[132:135], v[212:215], v[68:71]
  s_lshl_b32 s45, s45, 3
  ds_read_b64_tr_b16 a[196:197], v5 offset:8192
  v_add_f32 v28, v28, v122
  v_mfma_f32_16x16x32_bf16 v[68:71], a[128:131], v[208:211], v[68:71]
  s_add_u32 s44, s44, s45
  v_exp_f32 v127, v127
  v_mfma_f32_16x16x32_bf16 v[72:75], a[128:131], v[224:227], v[40:43]
  s_add_u32 s44, s44, 2547712
  v_add_f32 v29, v29, v123
  v_cvt_pk_bf16_f32 v151, v122, v123
  v_mfma_f32_16x16x32_bf16 v[72:75], a[132:135], v[228:231], v[72:75]
  s_sub_u32 s45, s54, 2359296
  v_exp_f32 v64, v64
  v_mfma_f32_16x16x32_bf16 v[72:75], a[136:139], v[232:235], v[72:75]
  s_lshr_b32 s45, s45, 3
  ds_read_b64_tr_b16 a[198:199], v5 offset:12288
  v_cvt_pk_bf16_f32 v158, v124, v125
  v_mfma_f32_16x16x32_bf16 v[72:75], a[140:143], v[236:239], v[72:75]
  s_add_u32 s45, s45, 2547712
  v_exp_f32 v65, v65
  v_mfma_f32_16x16x32_bf16 v[76:79], a[140:143], v[252:255], v[44:47]
  s_mov_b32 s64, s42
  ds_read_b64_tr_b16 a[200:201], v6 offset:0
  v_cvt_pk_bf16_f32 v159, v126, v127
  v_mfma_f32_16x16x32_bf16 v[76:79], a[136:139], v[248:251], v[76:79]
  s_mov_b32 s65, s43
  v_exp_f32 v66, v66
  v_mfma_f32_16x16x32_bf16 v[76:79], a[132:135], v[244:247], v[76:79]
  s_mov_b32 s66, 2097152
  ds_read_b64_tr_b16 a[202:203], v6 offset:4096
  v_cvt_pk_bf16_f32 v160, v64, v65
  v_mfma_f32_16x16x32_bf16 v[76:79], a[128:131], v[240:243], v[76:79]
  s_waitcnt lgkmcnt(15)
  s_mov_b32 s68, s40
  v_exp_f32 v67, v67
  v_mfma_f32_16x16x32_bf16 v[80:83], a[144:147], v[192:195], v[32:35]
  s_mov_b32 s69, s41
  buffer_load_dwordx4 v14, s[12:15], s27 offen offset:1024 lds
  v_mfma_f32_16x16x32_bf16 v[80:83], a[148:151], v[196:199], v[80:83]
  s_mov_b32 s70, 1024
  v_exp_f32 v68, v68
  v_mfma_f32_16x16x32_bf16 v[80:83], a[152:155], v[200:203], v[80:83]
  s_waitcnt lgkmcnt(14)
  s_mov_b32 s71, 0x20000
  ds_read_b64_tr_b16 a[204:205], v6 offset:8192
  v_cvt_pk_bf16_f32 v161, v66, v67
  v_mfma_f32_16x16x32_bf16 v[80:83], a[156:159], v[204:207], v[80:83]
  s_mov_b32 s34, 2195456
  v_exp_f32 v69, v69
  v_mfma_f32_16x16x32_bf16 v[84:87], a[156:159], v[220:223], v[36:39]
  s_mov_b32 s35, 2199552
  ds_read_b64_tr_b16 a[206:207], v6 offset:12288
  v_add_f32 v26, v26, v68
  v_mfma_f32_16x16x32_bf16 v[84:87], a[152:155], v[216:219], v[84:87]
  s_lshl_b32 s32, s72, 3
  v_exp_f32 v70, v70
  v_mfma_f32_16x16x32_bf16 v[84:87], a[148:151], v[212:215], v[84:87]
  s_lshl_b32 s33, s20, 1
  ds_read_b64_tr_b16 a[208:209], v7 offset:0
  v_add_f32 v27, v27, v69
  v_mfma_f32_16x16x32_bf16 v[84:87], a[144:147], v[208:211], v[84:87]
  s_add_u32 s32, s32, s33
  v_exp_f32 v71, v71
  v_mfma_f32_16x16x32_bf16 v[88:91], a[144:147], v[224:227], v[40:43]
  s_lshl_b32 s33, s20, 6
  v_cvt_pk_bf16_f32 v168, v68, v69
  v_add_f32 v26, v26, v70
  v_mfma_f32_16x16x32_bf16 v[88:91], a[148:151], v[228:231], v[88:91]
  v_exp_f32 v72, v72
  v_mfma_f32_16x16x32_bf16 v[88:91], a[152:155], v[232:235], v[88:91]
  ds_read_b64_tr_b16 a[210:211], v7 offset:4096
  v_add_f32 v27, v27, v71
  v_mfma_f32_16x16x32_bf16 v[88:91], a[156:159], v[236:239], v[88:91]
  v_exp_f32 v73, v73
  v_mfma_f32_16x16x32_bf16 v[92:95], a[156:159], v[252:255], v[44:47]
  ds_read_b64_tr_b16 a[212:213], v7 offset:8192
  v_cvt_pk_bf16_f32 v169, v70, v71
  v_mfma_f32_16x16x32_bf16 v[92:95], a[152:155], v[248:251], v[92:95]
  v_exp_f32 v74, v74
  v_mfma_f32_16x16x32_bf16 v[92:95], a[148:151], v[244:247], v[92:95]
  ds_read_b64_tr_b16 a[214:215], v7 offset:12288
  v_add_f32 v28, v28, v72
  v_mfma_f32_16x16x32_bf16 v[92:95], a[144:147], v[240:243], v[92:95]
  s_waitcnt lgkmcnt(15)
  v_exp_f32 v75, v75
  v_mfma_f32_16x16x32_bf16 v[96:99], a[160:163], v[192:195], v[32:35]
  v_lshrrev_b32 v58, 1, v0
  v_and_b32 v58, 0x38, v58
  v_mfma_f32_16x16x32_bf16 v[96:99], a[164:167], v[196:199], v[96:99]
  buffer_load_dwordx4 v15, s[12:15], s27 offen offset:2048 lds
  v_mfma_f32_16x16x32_bf16 v[96:99], a[168:171], v[200:203], v[96:99]
  v_exp_f32 v76, v76
  v_mfma_f32_16x16x32_bf16 v[96:99], a[172:175], v[204:207], v[96:99]
  ds_read_b64_tr_b16 a[216:217], v8 offset:0
  v_add_f32 v29, v29, v73
  v_mfma_f32_16x16x32_bf16 v[100:103], a[172:175], v[220:223], v[36:39]
  v_exp_f32 v77, v77
  v_mfma_f32_16x16x32_bf16 v[100:103], a[168:171], v[216:219], v[100:103]
  ds_read_b64_tr_b16 a[218:219], v8 offset:4096
  v_cvt_pk_bf16_f32 v176, v72, v73
  v_mfma_f32_16x16x32_bf16 v[100:103], a[164:167], v[212:215], v[100:103]
  v_exp_f32 v78, v78
  v_mfma_f32_16x16x32_bf16 v[100:103], a[160:163], v[208:211], v[100:103]
  ds_read_b64_tr_b16 a[220:221], v8 offset:8192
  v_add_f32 v28, v28, v74
  v_mfma_f32_16x16x32_bf16 v[104:107], a[160:163], v[224:227], v[40:43]
  v_exp_f32 v79, v79
  v_mfma_f32_16x16x32_bf16 v[104:107], a[164:167], v[228:231], v[104:107]
  v_add_f32 v29, v29, v75
  v_cvt_pk_bf16_f32 v177, v74, v75
  v_mfma_f32_16x16x32_bf16 v[104:107], a[168:171], v[232:235], v[104:107]
  v_exp_f32 v80, v80
  v_mfma_f32_16x16x32_bf16 v[104:107], a[172:175], v[236:239], v[104:107]
  ds_read_b64_tr_b16 a[222:223], v8 offset:12288
  v_cvt_pk_bf16_f32 v184, v76, v77
  v_mfma_f32_16x16x32_bf16 v[108:111], a[172:175], v[252:255], v[44:47]
  v_exp_f32 v81, v81
  v_mfma_f32_16x16x32_bf16 v[108:111], a[168:171], v[248:251], v[108:111]
  ds_read_b64_tr_b16 a[224:225], v9 offset:0
  v_cvt_pk_bf16_f32 v185, v78, v79
  v_mfma_f32_16x16x32_bf16 v[108:111], a[164:167], v[244:247], v[108:111]
  v_exp_f32 v82, v82
  v_mfma_f32_16x16x32_bf16 v[108:111], a[160:163], v[240:243], v[108:111]
  ds_read_b64_tr_b16 a[226:227], v9 offset:4096
  v_cvt_pk_bf16_f32 v162, v80, v81
  v_mfma_f32_16x16x32_bf16 v[112:115], a[176:179], v[192:195], v[32:35]
  s_waitcnt lgkmcnt(15)
  v_exp_f32 v83, v83
  v_mfma_f32_16x16x32_bf16 v[112:115], a[180:183], v[196:199], v[112:115]
  buffer_load_dwordx4 v16, s[12:15], s27 offen offset:3072 lds
  v_mfma_f32_16x16x32_bf16 v[112:115], a[184:187], v[200:203], v[112:115]
  s_add_u32 s27, s27, 262144
  v_exp_f32 v84, v84
  v_mfma_f32_16x16x32_bf16 v[112:115], a[188:191], v[204:207], v[112:115]
  ds_read_b64_tr_b16 a[228:229], v9 offset:8192
  v_cvt_pk_bf16_f32 v163, v82, v83
  v_mfma_f32_16x16x32_bf16 v[116:119], a[188:191], v[220:223], v[36:39]
  v_exp_f32 v85, v85
  v_mfma_f32_16x16x32_bf16 v[116:119], a[184:187], v[216:219], v[116:119]
  ds_read_b64_tr_b16 a[230:231], v9 offset:12288
  v_add_f32 v26, v26, v84
  v_mfma_f32_16x16x32_bf16 v[116:119], a[180:183], v[212:215], v[116:119]
  v_exp_f32 v86, v86
  v_mfma_f32_16x16x32_bf16 v[116:119], a[176:179], v[208:211], v[116:119]
  ds_read_b64_tr_b16 a[232:233], v10 offset:0
  v_add_f32 v27, v27, v85
  v_mfma_f32_16x16x32_bf16 v[120:123], a[176:179], v[224:227], v[40:43]
  v_exp_f32 v87, v87
  v_mfma_f32_16x16x32_bf16 v[120:123], a[180:183], v[228:231], v[120:123]
  v_cvt_pk_bf16_f32 v170, v84, v85
  v_add_f32 v26, v26, v86
  v_mfma_f32_16x16x32_bf16 v[120:123], a[184:187], v[232:235], v[120:123]
  v_exp_f32 v88, v88
  v_mfma_f32_16x16x32_bf16 v[120:123], a[188:191], v[236:239], v[120:123]
  ds_read_b64_tr_b16 a[234:235], v10 offset:4096
  v_add_f32 v27, v27, v87
  v_mfma_f32_16x16x32_bf16 v[124:127], a[188:191], v[252:255], v[44:47]
  v_exp_f32 v89, v89
  v_mfma_f32_16x16x32_bf16 v[124:127], a[184:187], v[248:251], v[124:127]
  ds_read_b64_tr_b16 a[236:237], v10 offset:8192
  v_cvt_pk_bf16_f32 v171, v86, v87
  v_mfma_f32_16x16x32_bf16 v[124:127], a[180:183], v[244:247], v[124:127]
  v_exp_f32 v90, v90
  v_mfma_f32_16x16x32_bf16 v[124:127], a[176:179], v[240:243], v[124:127]
  ds_read_b64_tr_b16 a[238:239], v10 offset:12288
  v_add_f32 v28, v28, v88
  v_mfma_f32_16x16x32_bf16 a[0:3], a[192:195], v[128:131], a[0:3]
  s_waitcnt lgkmcnt(15)
  s_add_u32 m0, s26, 114688
  v_exp_f32 v91, v91
  v_mfma_f32_16x16x32_bf16 a[0:3], a[196:199], v[132:135], a[0:3]
  buffer_load_dword v56, v58, s[16:19], s45 offen sc1
  v_mfma_f32_16x16x32_bf16 a[4:7], a[192:195], v[136:139], a[4:7]
  buffer_load_dwordx4 v17, s[8:11], s25 offen offset:0 lds
  v_mfma_f32_16x16x32_bf16 a[4:7], a[196:199], v[140:143], a[4:7]
  v_exp_f32 v92, v92
  v_mfma_f32_16x16x32_bf16 a[8:11], a[192:195], v[144:147], a[8:11]
  ds_read_b64_tr_b16 a[240:241], v11 offset:0
  v_add_f32 v29, v29, v89
  v_mfma_f32_16x16x32_bf16 a[8:11], a[196:199], v[148:151], a[8:11]
  v_exp_f32 v93, v93
  v_mfma_f32_16x16x32_bf16 a[12:15], a[192:195], v[152:155], a[12:15]
  ds_read_b64_tr_b16 a[242:243], v11 offset:4096
  v_cvt_pk_bf16_f32 v178, v88, v89
  v_mfma_f32_16x16x32_bf16 a[12:15], a[196:199], v[156:159], a[12:15]
  v_exp_f32 v94, v94
  v_mfma_f32_16x16x32_bf16 v[60:63], v[20:23], v[152:155], v[60:63]
  ds_read_b64_tr_b16 a[244:245], v11 offset:8192
  v_add_f32 v28, v28, v90
  v_mfma_f32_16x16x32_bf16 v[60:63], v[20:23], v[156:159], v[60:63]
  v_exp_f32 v95, v95
  v_mfma_f32_16x16x32_bf16 a[28:31], a[200:203], v[152:155], a[28:31]
  v_add_f32 v29, v29, v91
  v_cvt_pk_bf16_f32 v179, v90, v91
  v_mfma_f32_16x16x32_bf16 a[28:31], a[204:207], v[156:159], a[28:31]
  v_exp_f32 v96, v96
  v_mfma_f32_16x16x32_bf16 a[24:27], a[200:203], v[144:147], a[24:27]
  ds_read_b64_tr_b16 a[246:247], v11 offset:12288
  v_cvt_pk_bf16_f32 v186, v92, v93
  v_mfma_f32_16x16x32_bf16 a[24:27], a[204:207], v[148:151], a[24:27]
  v_exp_f32 v97, v97
  v_mfma_f32_16x16x32_bf16 a[20:23], a[200:203], v[136:139], a[20:23]
  ds_read_b64_tr_b16 a[248:249], v12 offset:0
  v_cvt_pk_bf16_f32 v187, v94, v95
  v_mfma_f32_16x16x32_bf16 a[20:23], a[204:207], v[140:143], a[20:23]
  v_exp_f32 v98, v98
  v_mfma_f32_16x16x32_bf16 a[16:19], a[200:203], v[128:131], a[16:19]
  ds_read_b64_tr_b16 a[250:251], v12 offset:4096
  v_cvt_pk_bf16_f32 v164, v96, v97
  v_mfma_f32_16x16x32_bf16 a[16:19], a[204:207], v[132:135], a[16:19]
  v_exp_f32 v99, v99
  v_mfma_f32_16x16x32_bf16 v[48:51], v[20:23], v[128:131], v[48:51]
  buffer_load_dwordx4 v18, s[8:11], s25 offen offset:1024 lds
  v_mfma_f32_16x16x32_bf16 v[48:51], v[20:23], v[132:135], v[48:51]
  s_waitcnt lgkmcnt(15)
  v_exp_f32 v100, v100
  v_mfma_f32_16x16x32_bf16 a[32:35], a[208:211], v[128:131], a[32:35]
  ds_read_b64_tr_b16 a[252:253], v12 offset:8192
  v_cvt_pk_bf16_f32 v165, v98, v99
  v_mfma_f32_16x16x32_bf16 a[32:35], a[212:215], v[132:135], a[32:35]
  v_exp_f32 v101, v101
  v_mfma_f32_16x16x32_bf16 a[36:39], a[208:211], v[136:139], a[36:39]
  ds_read_b64_tr_b16 a[254:255], v12 offset:12288
  v_add_f32 v26, v26, v100
  v_mfma_f32_16x16x32_bf16 a[36:39], a[212:215], v[140:143], a[36:39]
  v_exp_f32 v102, v102
  v_mfma_f32_16x16x32_bf16 a[40:43], a[208:211], v[144:147], a[40:43]
  ds_read_b128 a[128:131], v1 offset:32768
  v_add_f32 v27, v27, v101
  v_mfma_f32_16x16x32_bf16 a[40:43], a[212:215], v[148:151], a[40:43]
  v_exp_f32 v103, v103
  v_mfma_f32_16x16x32_bf16 a[44:47], a[208:211], v[152:155], a[44:47]
  v_cvt_pk_bf16_f32 v172, v100, v101
  v_add_f32 v26, v26, v102
  v_mfma_f32_16x16x32_bf16 a[44:47], a[212:215], v[156:159], a[44:47]
  v_exp_f32 v104, v104
  v_mfma_f32_16x16x32_bf16 a[60:63], a[216:219], v[152:155], a[60:63]
  s_waitcnt lgkmcnt(15)
  ds_read_b128 a[132:135], v2 offset:32768
  v_add_f32 v27, v27, v103
  v_mfma_f32_16x16x32_bf16 a[60:63], a[220:223], v[156:159], a[60:63]
  v_exp_f32 v105, v105
  v_mfma_f32_16x16x32_bf16 a[56:59], a[216:219], v[144:147], a[56:59]
  ds_read_b128 a[136:139], v3 offset:32768
  v_cvt_pk_bf16_f32 v173, v102, v103
  v_mfma_f32_16x16x32_bf16 a[56:59], a[220:223], v[148:151], a[56:59]
  v_exp_f32 v106, v106
  v_mfma_f32_16x16x32_bf16 a[52:55], a[216:219], v[136:139], a[52:55]
  ds_read_b128 a[140:143], v4 offset:32768
  v_add_f32 v28, v28, v104
  v_mfma_f32_16x16x32_bf16 a[52:55], a[220:223], v[140:143], a[52:55]
  v_exp_f32 v107, v107
  v_mfma_f32_16x16x32_bf16 a[48:51], a[216:219], v[128:131], a[48:51]
  v_lshlrev_b32 v53, 4, v58
  v_lshlrev_b32 v55, 21, v0
  v_mfma_f32_16x16x32_bf16 a[48:51], a[220:223], v[132:135], a[48:51]
  buffer_load_dwordx4 v17, s[8:11], s25 offen offset:2048 lds
  v_mfma_f32_16x16x32_bf16 a[64:67], a[224:227], v[128:131], a[64:67]
  s_waitcnt lgkmcnt(15)
  v_exp_f32 v108, v108
  v_mfma_f32_16x16x32_bf16 a[64:67], a[228:231], v[132:135], a[64:67]
  ds_read_b128 a[144:147], v1 offset:36864
  v_add_f32 v29, v29, v105
  v_mfma_f32_16x16x32_bf16 a[68:71], a[224:227], v[136:139], a[68:71]
  v_exp_f32 v109, v109
  v_mfma_f32_16x16x32_bf16 a[68:71], a[228:231], v[140:143], a[68:71]
  ds_read_b128 a[148:151], v2 offset:36864
  v_cvt_pk_bf16_f32 v180, v104, v105
  v_mfma_f32_16x16x32_bf16 a[72:75], a[224:227], v[144:147], a[72:75]
  v_exp_f32 v110, v110
  v_mfma_f32_16x16x32_bf16 a[72:75], a[228:231], v[148:151], a[72:75]
  ds_read_b128 a[152:155], v3 offset:36864
  v_add_f32 v28, v28, v106
  v_mfma_f32_16x16x32_bf16 a[76:79], a[224:227], v[152:155], a[76:79]
  v_exp_f32 v111, v111
  v_mfma_f32_16x16x32_bf16 a[76:79], a[228:231], v[156:159], a[76:79]
  s_waitcnt lgkmcnt(15)
  v_add_f32 v29, v29, v107
  v_cvt_pk_bf16_f32 v181, v106, v107
  v_mfma_f32_16x16x32_bf16 a[92:95], a[232:235], v[152:155], a[92:95]
  v_exp_f32 v112, v112
  v_mfma_f32_16x16x32_bf16 a[92:95], a[236:239], v[156:159], a[92:95]
  ds_read_b128 a[156:159], v4 offset:36864
  v_cvt_pk_bf16_f32 v188, v108, v109
  v_mfma_f32_16x16x32_bf16 a[88:91], a[232:235], v[144:147], a[88:91]
  v_exp_f32 v113, v113
  v_mfma_f32_16x16x32_bf16 a[88:91], a[236:239], v[148:151], a[88:91]
  ds_read_b128 a[160:163], v1 offset:40960
  v_cvt_pk_bf16_f32 v189, v110, v111
  v_mfma_f32_16x16x32_bf16 a[84:87], a[232:235], v[136:139], a[84:87]
  v_exp_f32 v114, v114
  v_mfma_f32_16x16x32_bf16 a[84:87], a[236:239], v[140:143], a[84:87]
  ds_read_b128 a[164:167], v2 offset:40960
  v_cvt_pk_bf16_f32 v166, v112, v113
  v_mfma_f32_16x16x32_bf16 a[80:83], a[232:235], v[128:131], a[80:83]
  v_exp_f32 v115, v115
  v_mfma_f32_16x16x32_bf16 a[80:83], a[236:239], v[132:135], a[80:83]
  s_waitcnt lgkmcnt(15)
  buffer_load_dwordx4 v18, s[8:11], s25 offen offset:3072 lds
  v_mfma_f32_16x16x32_bf16 a[96:99], a[240:243], v[128:131], a[96:99]
  s_waitcnt lgkmcnt(14)
  s_add_u32 s25, s25, 16384
  v_exp_f32 v116, v116
  v_mfma_f32_16x16x32_bf16 a[96:99], a[244:247], v[132:135], a[96:99]
  ds_read_b128 a[168:171], v3 offset:40960
  v_cvt_pk_bf16_f32 v167, v114, v115
  v_mfma_f32_16x16x32_bf16 a[100:103], a[240:243], v[136:139], a[100:103]
  v_exp_f32 v117, v117
  v_mfma_f32_16x16x32_bf16 a[100:103], a[244:247], v[140:143], a[100:103]
  ds_read_b128 a[172:175], v4 offset:40960
  v_add_f32 v26, v26, v116
  v_mfma_f32_16x16x32_bf16 a[104:107], a[240:243], v[144:147], a[104:107]
  v_exp_f32 v118, v118
  v_mfma_f32_16x16x32_bf16 a[104:107], a[244:247], v[148:151], a[104:107]
  ds_read_b128 a[176:179], v1 offset:45056
  v_add_f32 v27, v27, v117
  v_mfma_f32_16x16x32_bf16 a[108:111], a[240:243], v[152:155], a[108:111]
  v_exp_f32 v119, v119
  v_mfma_f32_16x16x32_bf16 a[108:111], a[244:247], v[156:159], a[108:111]
  s_waitcnt lgkmcnt(15)
  v_cvt_pk_bf16_f32 v174, v116, v117
  v_add_f32 v26, v26, v118
  v_mfma_f32_16x16x32_bf16 a[124:127], a[248:251], v[152:155], a[124:127]
  s_waitcnt lgkmcnt(13)
  v_exp_f32 v120, v120
  v_mfma_f32_16x16x32_bf16 a[124:127], a[252:255], v[156:159], a[124:127]
  ds_read_b128 a[180:183], v2 offset:45056
  v_add_f32 v27, v27, v119
  v_mfma_f32_16x16x32_bf16 a[120:123], a[248:251], v[144:147], a[120:123]
  v_exp_f32 v121, v121
  v_mfma_f32_16x16x32_bf16 a[120:123], a[252:255], v[148:151], a[120:123]
  ds_read_b128 a[184:187], v3 offset:45056
  v_cvt_pk_bf16_f32 v175, v118, v119
  v_mfma_f32_16x16x32_bf16 a[116:119], a[248:251], v[136:139], a[116:119]
  v_exp_f32 v122, v122
  v_mfma_f32_16x16x32_bf16 a[116:119], a[252:255], v[140:143], a[116:119]
  ds_read_b128 a[188:191], v4 offset:45056
  v_add_f32 v28, v28, v120
  v_mfma_f32_16x16x32_bf16 a[112:115], a[248:251], v[128:131], a[112:115]
  s_add_u32 m0, s26, 16384
  v_exp_f32 v123, v123
  v_mfma_f32_16x16x32_bf16 a[112:115], a[252:255], v[132:135], a[112:115]
  s_waitcnt vmcnt(13) lgkmcnt(15)
  s_barrier
  v_mfma_f32_16x16x32_bf16 v[64:67], a[128:131], v[192:195], v[32:35]
  s_waitcnt lgkmcnt(14)
  buffer_load_dwordx4 v13, s[12:15], s27 offen offset:0 lds
  v_mfma_f32_16x16x32_bf16 v[64:67], a[132:135], v[196:199], v[64:67]
  s_waitcnt lgkmcnt(13)
  v_exp_f32 v124, v124
  v_mfma_f32_16x16x32_bf16 v[64:67], a[136:139], v[200:203], v[64:67]
  s_waitcnt lgkmcnt(12)
  ds_read_b64_tr_b16 a[192:193], v5 offset:16384
  v_add_f32 v29, v29, v121
  v_mfma_f32_16x16x32_bf16 v[64:67], a[140:143], v[204:207], v[64:67]
  v_exp_f32 v125, v125
  v_mfma_f32_16x16x32_bf16 v[68:71], a[140:143], v[220:223], v[36:39]
  ds_read_b64_tr_b16 a[194:195], v5 offset:20480
  v_cvt_pk_bf16_f32 v182, v120, v121
  v_mfma_f32_16x16x32_bf16 v[68:71], a[136:139], v[216:219], v[68:71]
  v_exp_f32 v126, v126
  v_mfma_f32_16x16x32_bf16 v[68:71], a[132:135], v[212:215], v[68:71]
  ds_read_b64_tr_b16 a[196:197], v5 offset:24576
  v_add_f32 v28, v28, v122
  v_mfma_f32_16x16x32_bf16 v[68:71], a[128:131], v[208:211], v[68:71]
  v_exp_f32 v127, v127
  v_mfma_f32_16x16x32_bf16 v[72:75], a[128:131], v[224:227], v[40:43]
  v_add_f32 v29, v29, v123
  v_cvt_pk_bf16_f32 v183, v122, v123
  v_mfma_f32_16x16x32_bf16 v[72:75], a[132:135], v[228:231], v[72:75]
  v_exp_f32 v64, v64
  v_mfma_f32_16x16x32_bf16 v[72:75], a[136:139], v[232:235], v[72:75]
  ds_read_b64_tr_b16 a[198:199], v5 offset:28672
  v_cvt_pk_bf16_f32 v190, v124, v125
  v_mfma_f32_16x16x32_bf16 v[72:75], a[140:143], v[236:239], v[72:75]
  v_exp_f32 v65, v65
  v_mfma_f32_16x16x32_bf16 v[76:79], a[140:143], v[252:255], v[44:47]
  ds_read_b64_tr_b16 a[200:201], v6 offset:16384
  v_cvt_pk_bf16_f32 v191, v126, v127
  v_mfma_f32_16x16x32_bf16 v[76:79], a[136:139], v[248:251], v[76:79]
  v_exp_f32 v66, v66
  v_mfma_f32_16x16x32_bf16 v[76:79], a[132:135], v[244:247], v[76:79]
  ds_read_b64_tr_b16 a[202:203], v6 offset:20480
  v_cvt_pk_bf16_f32 v128, v64, v65
  v_mfma_f32_16x16x32_bf16 v[76:79], a[128:131], v[240:243], v[76:79]
  s_waitcnt lgkmcnt(15)
  v_exp_f32 v67, v67
  v_mfma_f32_16x16x32_bf16 v[80:83], a[144:147], v[192:195], v[32:35]
  buffer_load_dwordx4 v14, s[12:15], s27 offen offset:1024 lds
  v_mfma_f32_16x16x32_bf16 v[80:83], a[148:151], v[196:199], v[80:83]
  v_exp_f32 v68, v68
  v_mfma_f32_16x16x32_bf16 v[80:83], a[152:155], v[200:203], v[80:83]
  s_waitcnt lgkmcnt(14)
  ds_read_b64_tr_b16 a[204:205], v6 offset:24576
  v_cvt_pk_bf16_f32 v129, v66, v67
  v_mfma_f32_16x16x32_bf16 v[80:83], a[156:159], v[204:207], v[80:83]
  v_exp_f32 v69, v69
  v_mfma_f32_16x16x32_bf16 v[84:87], a[156:159], v[220:223], v[36:39]
  ds_read_b64_tr_b16 a[206:207], v6 offset:28672
  v_add_f32 v26, v26, v68
  v_mfma_f32_16x16x32_bf16 v[84:87], a[152:155], v[216:219], v[84:87]
  v_exp_f32 v70, v70
  v_mfma_f32_16x16x32_bf16 v[84:87], a[148:151], v[212:215], v[84:87]
  ds_read_b64_tr_b16 a[208:209], v7 offset:16384
  v_add_f32 v27, v27, v69
  v_mfma_f32_16x16x32_bf16 v[84:87], a[144:147], v[208:211], v[84:87]
  v_exp_f32 v71, v71
  v_mfma_f32_16x16x32_bf16 v[88:91], a[144:147], v[224:227], v[40:43]
  v_cvt_pk_bf16_f32 v136, v68, v69
  v_add_f32 v26, v26, v70
  v_mfma_f32_16x16x32_bf16 v[88:91], a[148:151], v[228:231], v[88:91]
  v_exp_f32 v72, v72
  v_mfma_f32_16x16x32_bf16 v[88:91], a[152:155], v[232:235], v[88:91]
  ds_read_b64_tr_b16 a[210:211], v7 offset:20480
  v_add_f32 v27, v27, v71
  v_mfma_f32_16x16x32_bf16 v[88:91], a[156:159], v[236:239], v[88:91]
  v_exp_f32 v73, v73
  v_mfma_f32_16x16x32_bf16 v[92:95], a[156:159], v[252:255], v[44:47]
  ds_read_b64_tr_b16 a[212:213], v7 offset:24576
  v_cvt_pk_bf16_f32 v137, v70, v71
  v_mfma_f32_16x16x32_bf16 v[92:95], a[152:155], v[248:251], v[92:95]
  v_exp_f32 v74, v74
  v_mfma_f32_16x16x32_bf16 v[92:95], a[148:151], v[244:247], v[92:95]
  ds_read_b64_tr_b16 a[214:215], v7 offset:28672
  v_add_f32 v28, v28, v72
  v_mfma_f32_16x16x32_bf16 v[92:95], a[144:147], v[240:243], v[92:95]
  s_waitcnt lgkmcnt(15)
  v_exp_f32 v75, v75
  v_mfma_f32_16x16x32_bf16 v[96:99], a[160:163], v[192:195], v[32:35]
  v_mov_b32 v52, v19
  v_mfma_f32_16x16x32_bf16 v[96:99], a[164:167], v[196:199], v[96:99]
  buffer_load_dwordx4 v15, s[12:15], s27 offen offset:2048 lds
  v_mfma_f32_16x16x32_bf16 v[96:99], a[168:171], v[200:203], v[96:99]
  v_exp_f32 v76, v76
  v_mfma_f32_16x16x32_bf16 v[96:99], a[172:175], v[204:207], v[96:99]
  ds_read_b64_tr_b16 a[216:217], v8 offset:16384
  v_add_f32 v29, v29, v73
  v_mfma_f32_16x16x32_bf16 v[100:103], a[172:175], v[220:223], v[36:39]
  v_exp_f32 v77, v77
  v_mfma_f32_16x16x32_bf16 v[100:103], a[168:171], v[216:219], v[100:103]
  ds_read_b64_tr_b16 a[218:219], v8 offset:20480
  v_cvt_pk_bf16_f32 v144, v72, v73
  v_mfma_f32_16x16x32_bf16 v[100:103], a[164:167], v[212:215], v[100:103]
  v_exp_f32 v78, v78
  v_mfma_f32_16x16x32_bf16 v[100:103], a[160:163], v[208:211], v[100:103]
  ds_read_b64_tr_b16 a[220:221], v8 offset:24576
  v_add_f32 v28, v28, v74
  v_mfma_f32_16x16x32_bf16 v[104:107], a[160:163], v[224:227], v[40:43]
  v_exp_f32 v79, v79
  v_mfma_f32_16x16x32_bf16 v[104:107], a[164:167], v[228:231], v[104:107]
  v_add_f32 v29, v29, v75
  v_cvt_pk_bf16_f32 v145, v74, v75
  v_mfma_f32_16x16x32_bf16 v[104:107], a[168:171], v[232:235], v[104:107]
  v_exp_f32 v80, v80
  v_mfma_f32_16x16x32_bf16 v[104:107], a[172:175], v[236:239], v[104:107]
  ds_read_b64_tr_b16 a[222:223], v8 offset:28672
  v_cvt_pk_bf16_f32 v152, v76, v77
  v_mfma_f32_16x16x32_bf16 v[108:111], a[172:175], v[252:255], v[44:47]
  v_exp_f32 v81, v81
  v_mfma_f32_16x16x32_bf16 v[108:111], a[168:171], v[248:251], v[108:111]
  ds_read_b64_tr_b16 a[224:225], v9 offset:16384
  v_cvt_pk_bf16_f32 v153, v78, v79
  v_mfma_f32_16x16x32_bf16 v[108:111], a[164:167], v[244:247], v[108:111]
  v_exp_f32 v82, v82
  v_mfma_f32_16x16x32_bf16 v[108:111], a[160:163], v[240:243], v[108:111]
  ds_read_b64_tr_b16 a[226:227], v9 offset:20480
  v_cvt_pk_bf16_f32 v130, v80, v81
  v_mfma_f32_16x16x32_bf16 v[112:115], a[176:179], v[192:195], v[32:35]
  s_waitcnt lgkmcnt(15)
  v_exp_f32 v83, v83
  v_mfma_f32_16x16x32_bf16 v[112:115], a[180:183], v[196:199], v[112:115]
  buffer_load_dwordx4 v16, s[12:15], s27 offen offset:3072 lds
  v_mfma_f32_16x16x32_bf16 v[112:115], a[184:187], v[200:203], v[112:115]
  s_add_u32 s27, s27, 262144
  v_exp_f32 v84, v84
  v_mfma_f32_16x16x32_bf16 v[112:115], a[188:191], v[204:207], v[112:115]
  ds_read_b64_tr_b16 a[228:229], v9 offset:24576
  v_cvt_pk_bf16_f32 v131, v82, v83
  v_mfma_f32_16x16x32_bf16 v[116:119], a[188:191], v[220:223], v[36:39]
  v_exp_f32 v85, v85
  v_mfma_f32_16x16x32_bf16 v[116:119], a[184:187], v[216:219], v[116:119]
  ds_read_b64_tr_b16 a[230:231], v9 offset:28672
  v_add_f32 v26, v26, v84
  v_mfma_f32_16x16x32_bf16 v[116:119], a[180:183], v[212:215], v[116:119]
  v_exp_f32 v86, v86
  v_mfma_f32_16x16x32_bf16 v[116:119], a[176:179], v[208:211], v[116:119]
  ds_read_b64_tr_b16 a[232:233], v10 offset:16384
  v_add_f32 v27, v27, v85
  v_mfma_f32_16x16x32_bf16 v[120:123], a[176:179], v[224:227], v[40:43]
  v_exp_f32 v87, v87
  v_mfma_f32_16x16x32_bf16 v[120:123], a[180:183], v[228:231], v[120:123]
  v_cvt_pk_bf16_f32 v138, v84, v85
  v_add_f32 v26, v26, v86
  v_mfma_f32_16x16x32_bf16 v[120:123], a[184:187], v[232:235], v[120:123]
  v_exp_f32 v88, v88
  v_mfma_f32_16x16x32_bf16 v[120:123], a[188:191], v[236:239], v[120:123]
  ds_read_b64_tr_b16 a[234:235], v10 offset:20480
  v_add_f32 v27, v27, v87
  v_mfma_f32_16x16x32_bf16 v[124:127], a[188:191], v[252:255], v[44:47]
  v_exp_f32 v89, v89
  v_mfma_f32_16x16x32_bf16 v[124:127], a[184:187], v[248:251], v[124:127]
  ds_read_b64_tr_b16 a[236:237], v10 offset:24576
  v_cvt_pk_bf16_f32 v139, v86, v87
  v_mfma_f32_16x16x32_bf16 v[124:127], a[180:183], v[244:247], v[124:127]
  v_exp_f32 v90, v90
  v_mfma_f32_16x16x32_bf16 v[124:127], a[176:179], v[240:243], v[124:127]
  ds_read_b64_tr_b16 a[238:239], v10 offset:28672
  v_add_f32 v28, v28, v88
  v_mfma_f32_16x16x32_bf16 a[0:3], a[192:195], v[160:163], a[0:3]
  s_waitcnt lgkmcnt(15)
  s_add_u32 m0, s26, 65536
  v_exp_f32 v91, v91
  v_mfma_f32_16x16x32_bf16 a[0:3], a[196:199], v[164:167], a[0:3]
  v_mfma_f32_16x16x32_bf16 a[4:7], a[192:195], v[168:171], a[4:7]
  buffer_load_dwordx4 v13, s[12:15], s27 offen offset:0 lds
  v_mfma_f32_16x16x32_bf16 a[4:7], a[196:199], v[172:175], a[4:7]
  v_exp_f32 v92, v92
  v_mfma_f32_16x16x32_bf16 a[8:11], a[192:195], v[176:179], a[8:11]
  ds_read_b64_tr_b16 a[240:241], v11 offset:16384
  v_add_f32 v29, v29, v89
  v_mfma_f32_16x16x32_bf16 a[8:11], a[196:199], v[180:183], a[8:11]
  v_exp_f32 v93, v93
  v_mfma_f32_16x16x32_bf16 a[12:15], a[192:195], v[184:187], a[12:15]
  ds_read_b64_tr_b16 a[242:243], v11 offset:20480
  v_cvt_pk_bf16_f32 v146, v88, v89
  v_mfma_f32_16x16x32_bf16 a[12:15], a[196:199], v[188:191], a[12:15]
  v_exp_f32 v94, v94
  v_mfma_f32_16x16x32_bf16 v[60:63], v[20:23], v[184:187], v[60:63]
  ds_read_b64_tr_b16 a[244:245], v11 offset:24576
  v_add_f32 v28, v28, v90
  v_mfma_f32_16x16x32_bf16 v[60:63], v[20:23], v[188:191], v[60:63]
  v_exp_f32 v95, v95
  v_mfma_f32_16x16x32_bf16 a[28:31], a[200:203], v[184:187], a[28:31]
  v_add_f32 v29, v29, v91
  v_cvt_pk_bf16_f32 v147, v90, v91
  v_mfma_f32_16x16x32_bf16 a[28:31], a[204:207], v[188:191], a[28:31]
  v_exp_f32 v96, v96
  v_mfma_f32_16x16x32_bf16 a[24:27], a[200:203], v[176:179], a[24:27]
  ds_read_b64_tr_b16 a[246:247], v11 offset:28672
  v_cvt_pk_bf16_f32 v154, v92, v93
  v_mfma_f32_16x16x32_bf16 a[24:27], a[204:207], v[180:183], a[24:27]
  v_exp_f32 v97, v97
  v_mfma_f32_16x16x32_bf16 a[20:23], a[200:203], v[168:171], a[20:23]
  ds_read_b64_tr_b16 a[248:249], v12 offset:16384
  v_cvt_pk_bf16_f32 v155, v94, v95
  v_mfma_f32_16x16x32_bf16 a[20:23], a[204:207], v[172:175], a[20:23]
  v_exp_f32 v98, v98
  v_mfma_f32_16x16x32_bf16 a[16:19], a[200:203], v[160:163], a[16:19]
  ds_read_b64_tr_b16 a[250:251], v12 offset:20480
  v_cvt_pk_bf16_f32 v132, v96, v97
  v_mfma_f32_16x16x32_bf16 a[16:19], a[204:207], v[164:167], a[16:19]
  v_exp_f32 v99, v99
  v_mfma_f32_16x16x32_bf16 v[48:51], v[20:23], v[160:163], v[48:51]
  buffer_load_dwordx4 v14, s[12:15], s27 offen offset:1024 lds
  v_mfma_f32_16x16x32_bf16 v[48:51], v[20:23], v[164:167], v[48:51]
  s_waitcnt lgkmcnt(15)
  v_exp_f32 v100, v100
  v_mfma_f32_16x16x32_bf16 a[32:35], a[208:211], v[160:163], a[32:35]
  ds_read_b64_tr_b16 a[252:253], v12 offset:24576
  v_cvt_pk_bf16_f32 v133, v98, v99
  v_mfma_f32_16x16x32_bf16 a[32:35], a[212:215], v[164:167], a[32:35]
  v_exp_f32 v101, v101
  v_mfma_f32_16x16x32_bf16 a[36:39], a[208:211], v[168:171], a[36:39]
  ds_read_b64_tr_b16 a[254:255], v12 offset:28672
  v_add_f32 v26, v26, v100
  v_mfma_f32_16x16x32_bf16 a[36:39], a[212:215], v[172:175], a[36:39]
  v_exp_f32 v102, v102
  v_mfma_f32_16x16x32_bf16 a[40:43], a[208:211], v[176:179], a[40:43]
  ds_read_b128 a[128:131], v1 offset:49152
  v_add_f32 v27, v27, v101
  v_mfma_f32_16x16x32_bf16 a[40:43], a[212:215], v[180:183], a[40:43]
  v_exp_f32 v103, v103
  v_mfma_f32_16x16x32_bf16 a[44:47], a[208:211], v[184:187], a[44:47]
  v_cvt_pk_bf16_f32 v140, v100, v101
  v_add_f32 v26, v26, v102
  v_mfma_f32_16x16x32_bf16 a[44:47], a[212:215], v[188:191], a[44:47]
  v_exp_f32 v104, v104
  v_mfma_f32_16x16x32_bf16 a[60:63], a[216:219], v[184:187], a[60:63]
  s_waitcnt lgkmcnt(15)
  ds_read_b128 a[132:135], v2 offset:49152
  v_add_f32 v27, v27, v103
  v_mfma_f32_16x16x32_bf16 a[60:63], a[220:223], v[188:191], a[60:63]
  v_exp_f32 v105, v105
  v_mfma_f32_16x16x32_bf16 a[56:59], a[216:219], v[176:179], a[56:59]
  ds_read_b128 a[136:139], v3 offset:49152
  v_cvt_pk_bf16_f32 v141, v102, v103
  v_mfma_f32_16x16x32_bf16 a[56:59], a[220:223], v[180:183], a[56:59]
  v_exp_f32 v106, v106
  v_mfma_f32_16x16x32_bf16 a[52:55], a[216:219], v[168:171], a[52:55]
  ds_read_b128 a[140:143], v4 offset:49152
  v_add_f32 v28, v28, v104
  v_mfma_f32_16x16x32_bf16 a[52:55], a[220:223], v[172:175], a[52:55]
  v_exp_f32 v107, v107
  v_mfma_f32_16x16x32_bf16 a[48:51], a[216:219], v[160:163], a[48:51]
  v_mfma_f32_16x16x32_bf16 a[48:51], a[220:223], v[164:167], a[48:51]
  buffer_load_dwordx4 v15, s[12:15], s27 offen offset:2048 lds
  v_mfma_f32_16x16x32_bf16 a[64:67], a[224:227], v[160:163], a[64:67]
  s_waitcnt lgkmcnt(15)
  v_exp_f32 v108, v108
  v_mfma_f32_16x16x32_bf16 a[64:67], a[228:231], v[164:167], a[64:67]
  ds_read_b128 a[144:147], v1 offset:53248
  v_add_f32 v29, v29, v105
  v_mfma_f32_16x16x32_bf16 a[68:71], a[224:227], v[168:171], a[68:71]
  v_exp_f32 v109, v109
  v_mfma_f32_16x16x32_bf16 a[68:71], a[228:231], v[172:175], a[68:71]
  ds_read_b128 a[148:151], v2 offset:53248
  v_cvt_pk_bf16_f32 v148, v104, v105
  v_mfma_f32_16x16x32_bf16 a[72:75], a[224:227], v[176:179], a[72:75]
  v_exp_f32 v110, v110
  v_mfma_f32_16x16x32_bf16 a[72:75], a[228:231], v[180:183], a[72:75]
  ds_read_b128 a[152:155], v3 offset:53248
  v_add_f32 v28, v28, v106
  v_mfma_f32_16x16x32_bf16 a[76:79], a[224:227], v[184:187], a[76:79]
  v_exp_f32 v111, v111
  v_mfma_f32_16x16x32_bf16 a[76:79], a[228:231], v[188:191], a[76:79]
  s_waitcnt lgkmcnt(15)
  v_add_f32 v29, v29, v107
  v_cvt_pk_bf16_f32 v149, v106, v107
  v_mfma_f32_16x16x32_bf16 a[92:95], a[232:235], v[184:187], a[92:95]
  v_exp_f32 v112, v112
  v_mfma_f32_16x16x32_bf16 a[92:95], a[236:239], v[188:191], a[92:95]
  ds_read_b128 a[156:159], v4 offset:53248
  v_cvt_pk_bf16_f32 v156, v108, v109
  v_mfma_f32_16x16x32_bf16 a[88:91], a[232:235], v[176:179], a[88:91]
  v_exp_f32 v113, v113
  v_mfma_f32_16x16x32_bf16 a[88:91], a[236:239], v[180:183], a[88:91]
  ds_read_b128 a[160:163], v1 offset:57344
  v_cvt_pk_bf16_f32 v157, v110, v111
  v_mfma_f32_16x16x32_bf16 a[84:87], a[232:235], v[168:171], a[84:87]
  v_exp_f32 v114, v114
  v_mfma_f32_16x16x32_bf16 a[84:87], a[236:239], v[172:175], a[84:87]
  ds_read_b128 a[164:167], v2 offset:57344
  v_cvt_pk_bf16_f32 v134, v112, v113
  v_mfma_f32_16x16x32_bf16 a[80:83], a[232:235], v[160:163], a[80:83]
  v_exp_f32 v115, v115
  v_mfma_f32_16x16x32_bf16 a[80:83], a[236:239], v[164:167], a[80:83]
  s_waitcnt lgkmcnt(15)
  buffer_load_dwordx4 v16, s[12:15], s27 offen offset:3072 lds
  v_mfma_f32_16x16x32_bf16 a[96:99], a[240:243], v[160:163], a[96:99]
  s_waitcnt lgkmcnt(14)
  s_add_u32 s27, s27, 262144
  v_exp_f32 v116, v116
  v_mfma_f32_16x16x32_bf16 a[96:99], a[244:247], v[164:167], a[96:99]
  ds_read_b128 a[168:171], v3 offset:57344
  v_cvt_pk_bf16_f32 v135, v114, v115
  v_mfma_f32_16x16x32_bf16 a[100:103], a[240:243], v[168:171], a[100:103]
  v_exp_f32 v117, v117
  v_mfma_f32_16x16x32_bf16 a[100:103], a[244:247], v[172:175], a[100:103]
  ds_read_b128 a[172:175], v4 offset:57344
  v_add_f32 v26, v26, v116
  v_mfma_f32_16x16x32_bf16 a[104:107], a[240:243], v[176:179], a[104:107]
  v_exp_f32 v118, v118
  v_mfma_f32_16x16x32_bf16 a[104:107], a[244:247], v[180:183], a[104:107]
  ds_read_b128 a[176:179], v1 offset:61440
  v_add_f32 v27, v27, v117
  v_mfma_f32_16x16x32_bf16 a[108:111], a[240:243], v[184:187], a[108:111]
  v_exp_f32 v119, v119
  v_mfma_f32_16x16x32_bf16 a[108:111], a[244:247], v[188:191], a[108:111]
  s_waitcnt lgkmcnt(15)
  v_cvt_pk_bf16_f32 v142, v116, v117
  v_add_f32 v26, v26, v118
  v_mfma_f32_16x16x32_bf16 a[124:127], a[248:251], v[184:187], a[124:127]
  s_waitcnt lgkmcnt(13)
  v_exp_f32 v120, v120
  v_mfma_f32_16x16x32_bf16 a[124:127], a[252:255], v[188:191], a[124:127]
  ds_read_b128 a[180:183], v2 offset:61440
  v_add_f32 v27, v27, v119
  v_mfma_f32_16x16x32_bf16 a[120:123], a[248:251], v[176:179], a[120:123]
  v_exp_f32 v121, v121
  v_mfma_f32_16x16x32_bf16 a[120:123], a[252:255], v[180:183], a[120:123]
  ds_read_b128 a[184:187], v3 offset:61440
  v_cvt_pk_bf16_f32 v143, v118, v119
  v_mfma_f32_16x16x32_bf16 a[116:119], a[248:251], v[168:171], a[116:119]
  v_exp_f32 v122, v122
  v_mfma_f32_16x16x32_bf16 a[116:119], a[252:255], v[172:175], a[116:119]
  ds_read_b128 a[188:191], v4 offset:61440
  v_add_f32 v28, v28, v120
  v_mfma_f32_16x16x32_bf16 a[112:115], a[248:251], v[160:163], a[112:115]
  s_add_u32 m0, s26, 32768
  v_exp_f32 v123, v123
  v_mfma_f32_16x16x32_bf16 a[112:115], a[252:255], v[164:167], a[112:115]
  s_waitcnt vmcnt(8) lgkmcnt(15)
  s_barrier
  v_mfma_f32_16x16x32_bf16 v[64:67], a[128:131], v[192:195], v[32:35]
  s_waitcnt lgkmcnt(14)
  buffer_load_dwordx4 v13, s[12:15], s27 offen offset:0 lds
  v_mfma_f32_16x16x32_bf16 v[64:67], a[132:135], v[196:199], v[64:67]
  s_waitcnt lgkmcnt(13)
  v_exp_f32 v124, v124
  v_mfma_f32_16x16x32_bf16 v[64:67], a[136:139], v[200:203], v[64:67]
  s_waitcnt lgkmcnt(12)
  ds_read_b64_tr_b16 a[192:193], v5 offset:32768
  v_add_f32 v29, v29, v121
  v_lshrrev_b32 v17, 7, v0
  v_mfma_f32_16x16x32_bf16 v[64:67], a[140:143], v[204:207], v[64:67]
  v_exp_f32 v125, v125
  v_mfma_f32_16x16x32_bf16 v[68:71], a[140:143], v[220:223], v[36:39]
  ds_read_b64_tr_b16 a[194:195], v5 offset:36864
  v_cvt_pk_bf16_f32 v150, v120, v121
  v_mfma_f32_16x16x32_bf16 v[68:71], a[136:139], v[216:219], v[68:71]
  v_exp_f32 v126, v126
  v_mfma_f32_16x16x32_bf16 v[68:71], a[132:135], v[212:215], v[68:71]
  ds_read_b64_tr_b16 a[196:197], v5 offset:40960
  v_add_f32 v28, v28, v122
  v_lshl_add_u32 v17, v17, 25, v0
  v_mfma_f32_16x16x32_bf16 v[68:71], a[128:131], v[208:211], v[68:71]
  v_exp_f32 v127, v127
  v_mfma_f32_16x16x32_bf16 v[72:75], a[128:131], v[224:227], v[40:43]
  v_add_f32 v29, v29, v123
  v_cvt_pk_bf16_f32 v151, v122, v123
  v_mfma_f32_16x16x32_bf16 v[72:75], a[132:135], v[228:231], v[72:75]
  v_exp_f32 v64, v64
  v_mfma_f32_16x16x32_bf16 v[72:75], a[136:139], v[232:235], v[72:75]
  ds_read_b64_tr_b16 a[198:199], v5 offset:45056
  v_cvt_pk_bf16_f32 v158, v124, v125
  v_mov_b32 v18, s29
  v_mfma_f32_16x16x32_bf16 v[72:75], a[140:143], v[236:239], v[72:75]
  v_exp_f32 v65, v65
  v_mfma_f32_16x16x32_bf16 v[76:79], a[140:143], v[252:255], v[44:47]
  ds_read_b64_tr_b16 a[200:201], v6 offset:32768
  v_cvt_pk_bf16_f32 v159, v126, v127
  v_mfma_f32_16x16x32_bf16 v[76:79], a[136:139], v[248:251], v[76:79]
  v_exp_f32 v66, v66
  v_mfma_f32_16x16x32_bf16 v[76:79], a[132:135], v[244:247], v[76:79]
  ds_read_b64_tr_b16 a[202:203], v6 offset:36864
  v_cvt_pk_bf16_f32 v160, v64, v65
  v_not_b32 v19, v18
  v_mfma_f32_16x16x32_bf16 v[76:79], a[128:131], v[240:243], v[76:79]
  s_waitcnt lgkmcnt(15)
  v_exp_f32 v67, v67
  v_mfma_f32_16x16x32_bf16 v[80:83], a[144:147], v[192:195], v[32:35]
  buffer_load_dwordx4 v14, s[12:15], s27 offen offset:1024 lds
  v_mfma_f32_16x16x32_bf16 v[80:83], a[148:151], v[196:199], v[80:83]
  v_exp_f32 v68, v68
  v_mfma_f32_16x16x32_bf16 v[80:83], a[152:155], v[200:203], v[80:83]
  s_waitcnt lgkmcnt(14)
  ds_read_b64_tr_b16 a[204:205], v6 offset:40960
  v_cvt_pk_bf16_f32 v161, v66, v67
  v_and_b32 v2, 0x80, v0
  v_mfma_f32_16x16x32_bf16 v[80:83], a[156:159], v[204:207], v[80:83]
  v_exp_f32 v69, v69
  v_mfma_f32_16x16x32_bf16 v[84:87], a[156:159], v[220:223], v[36:39]
  ds_read_b64_tr_b16 a[206:207], v6 offset:45056
  v_add_f32 v26, v26, v68
  v_mfma_f32_16x16x32_bf16 v[84:87], a[152:155], v[216:219], v[84:87]
  v_exp_f32 v70, v70
  v_mfma_f32_16x16x32_bf16 v[84:87], a[148:151], v[212:215], v[84:87]
  ds_read_b64_tr_b16 a[208:209], v7 offset:32768
  v_add_f32 v27, v27, v69
  v_lshrrev_b32 v4, 8, v0
  v_mfma_f32_16x16x32_bf16 v[84:87], a[144:147], v[208:211], v[84:87]
  v_exp_f32 v71, v71
  v_mfma_f32_16x16x32_bf16 v[88:91], a[144:147], v[224:227], v[40:43]
  v_cvt_pk_bf16_f32 v168, v68, v69
  v_add_f32 v26, v26, v70
  v_mfma_f32_16x16x32_bf16 v[88:91], a[148:151], v[228:231], v[88:91]
  v_exp_f32 v72, v72
  v_mfma_f32_16x16x32_bf16 v[88:91], a[152:155], v[232:235], v[88:91]
  ds_read_b64_tr_b16 a[210:211], v7 offset:36864
  v_add_f32 v27, v27, v71
  v_lshl_add_u32 v2, v4, 9, v2
  v_mfma_f32_16x16x32_bf16 v[88:91], a[156:159], v[236:239], v[88:91]
  v_exp_f32 v73, v73
  v_mfma_f32_16x16x32_bf16 v[92:95], a[156:159], v[252:255], v[44:47]
  ds_read_b64_tr_b16 a[212:213], v7 offset:40960
  v_cvt_pk_bf16_f32 v169, v70, v71
  v_mfma_f32_16x16x32_bf16 v[92:95], a[152:155], v[248:251], v[92:95]
  v_exp_f32 v74, v74
  v_mfma_f32_16x16x32_bf16 v[92:95], a[148:151], v[244:247], v[92:95]
  ds_read_b64_tr_b16 a[214:215], v7 offset:45056
  v_add_f32 v28, v28, v72
  v_bfe_u32 v4, v0, 5, 2
  v_mfma_f32_16x16x32_bf16 v[92:95], a[144:147], v[240:243], v[92:95]
  s_waitcnt lgkmcnt(15)
  v_exp_f32 v75, v75
  v_mfma_f32_16x16x32_bf16 v[96:99], a[160:163], v[192:195], v[32:35]
  v_mfma_f32_16x16x32_bf16 v[96:99], a[164:167], v[196:199], v[96:99]
  buffer_load_dwordx4 v15, s[12:15], s27 offen offset:2048 lds
  v_mfma_f32_16x16x32_bf16 v[96:99], a[168:171], v[200:203], v[96:99]
  v_exp_f32 v76, v76
  v_lshl_add_u32 v2, v4, 4, v2
  v_mfma_f32_16x16x32_bf16 v[96:99], a[172:175], v[204:207], v[96:99]
  ds_read_b64_tr_b16 a[216:217], v8 offset:32768
  v_add_f32 v29, v29, v73
  v_mfma_f32_16x16x32_bf16 v[100:103], a[172:175], v[220:223], v[36:39]
  v_exp_f32 v77, v77
  v_mfma_f32_16x16x32_bf16 v[100:103], a[168:171], v[216:219], v[100:103]
  ds_read_b64_tr_b16 a[218:219], v8 offset:36864
  v_cvt_pk_bf16_f32 v176, v72, v73
  v_mfma_f32_16x16x32_bf16 v[100:103], a[164:167], v[212:215], v[100:103]
  v_exp_f32 v78, v78
  v_bfe_u32 v3, v0, 4, 1
  v_mfma_f32_16x16x32_bf16 v[100:103], a[160:163], v[208:211], v[100:103]
  ds_read_b64_tr_b16 a[220:221], v8 offset:40960
  v_add_f32 v28, v28, v74
  v_mfma_f32_16x16x32_bf16 v[104:107], a[160:163], v[224:227], v[40:43]
  v_exp_f32 v79, v79
  v_mfma_f32_16x16x32_bf16 v[104:107], a[164:167], v[228:231], v[104:107]
  v_add_f32 v29, v29, v75
  v_cvt_pk_bf16_f32 v177, v74, v75
  v_mfma_f32_16x16x32_bf16 v[104:107], a[168:171], v[232:235], v[104:107]
  v_exp_f32 v80, v80
  v_add_u32 v3, s32, v3
  v_mfma_f32_16x16x32_bf16 v[104:107], a[172:175], v[236:239], v[104:107]
  ds_read_b64_tr_b16 a[222:223], v8 offset:45056
  v_cvt_pk_bf16_f32 v184, v76, v77
  v_mfma_f32_16x16x32_bf16 v[108:111], a[172:175], v[252:255], v[44:47]
  v_exp_f32 v81, v81
  v_mfma_f32_16x16x32_bf16 v[108:111], a[168:171], v[248:251], v[108:111]
  ds_read_b64_tr_b16 a[224:225], v9 offset:32768
  v_cvt_pk_bf16_f32 v185, v78, v79
  v_mfma_f32_16x16x32_bf16 v[108:111], a[164:167], v[244:247], v[108:111]
  v_exp_f32 v82, v82
  v_lshrrev_b32 v54, 1, v2
  v_mfma_f32_16x16x32_bf16 v[108:111], a[160:163], v[240:243], v[108:111]
  ds_read_b64_tr_b16 a[226:227], v9 offset:36864
  v_cvt_pk_bf16_f32 v162, v80, v81
  v_mfma_f32_16x16x32_bf16 v[112:115], a[176:179], v[192:195], v[32:35]
  s_waitcnt lgkmcnt(15)
  v_exp_f32 v83, v83
  v_mfma_f32_16x16x32_bf16 v[112:115], a[180:183], v[196:199], v[112:115]
  buffer_load_dwordx4 v16, s[12:15], s27 offen offset:3072 lds
  v_mfma_f32_16x16x32_bf16 v[112:115], a[184:187], v[200:203], v[112:115]
  s_add_u32 s27, s27, 4294213632
  v_exp_f32 v84, v84
  v_lshl_add_u32 v1, v3, 10, v54
  v_mfma_f32_16x16x32_bf16 v[112:115], a[188:191], v[204:207], v[112:115]
  ds_read_b64_tr_b16 a[228:229], v9 offset:40960
  v_cvt_pk_bf16_f32 v163, v82, v83
  v_mfma_f32_16x16x32_bf16 v[116:119], a[188:191], v[220:223], v[36:39]
  v_exp_f32 v85, v85
  v_mfma_f32_16x16x32_bf16 v[116:119], a[184:187], v[216:219], v[116:119]
  ds_read_b64_tr_b16 a[230:231], v9 offset:45056
  v_add_f32 v26, v26, v84
  v_mfma_f32_16x16x32_bf16 v[116:119], a[180:183], v[212:215], v[116:119]
  v_exp_f32 v86, v86
  v_lshrrev_b32 v4, 4, v0
  v_mfma_f32_16x16x32_bf16 v[116:119], a[176:179], v[208:211], v[116:119]
  ds_read_b64_tr_b16 a[232:233], v10 offset:32768
  v_add_f32 v27, v27, v85
  v_mfma_f32_16x16x32_bf16 v[120:123], a[176:179], v[224:227], v[40:43]
  v_exp_f32 v87, v87
  v_mfma_f32_16x16x32_bf16 v[120:123], a[180:183], v[228:231], v[120:123]
  v_cvt_pk_bf16_f32 v170, v84, v85
  v_add_f32 v26, v26, v86
  v_mfma_f32_16x16x32_bf16 v[120:123], a[184:187], v[232:235], v[120:123]
  v_exp_f32 v88, v88
  v_add_u32 v4, s33, v4
  v_mfma_f32_16x16x32_bf16 v[120:123], a[188:191], v[236:239], v[120:123]
  ds_read_b64_tr_b16 a[234:235], v10 offset:36864
  v_add_f32 v27, v27, v87
  v_mfma_f32_16x16x32_bf16 v[124:127], a[188:191], v[252:255], v[44:47]
  v_exp_f32 v89, v89
  v_mfma_f32_16x16x32_bf16 v[124:127], a[184:187], v[248:251], v[124:127]
  ds_read_b64_tr_b16 a[236:237], v10 offset:40960
  v_cvt_pk_bf16_f32 v171, v86, v87
  v_mfma_f32_16x16x32_bf16 v[124:127], a[180:183], v[244:247], v[124:127]
  v_exp_f32 v90, v90
  v_mfma_f32_16x16x32_bf16 v[124:127], a[176:179], v[240:243], v[124:127]
  ds_read_b64_tr_b16 a[238:239], v10 offset:45056
  v_add_f32 v28, v28, v88
  v_mfma_f32_16x16x32_bf16 a[0:3], a[192:195], v[128:131], a[0:3]
  s_waitcnt lgkmcnt(15)
  s_add_u32 m0, s26, 81920
  v_exp_f32 v91, v91
  v_mfma_f32_16x16x32_bf16 a[0:3], a[196:199], v[132:135], a[0:3]
  v_mfma_f32_16x16x32_bf16 a[4:7], a[192:195], v[136:139], a[4:7]
  buffer_load_dwordx4 v13, s[12:15], s27 offen offset:0 lds
  v_mfma_f32_16x16x32_bf16 a[4:7], a[196:199], v[140:143], a[4:7]
  v_exp_f32 v92, v92
  v_mfma_f32_16x16x32_bf16 a[8:11], a[192:195], v[144:147], a[8:11]
  ds_read_b64_tr_b16 a[240:241], v11 offset:32768
  v_add_f32 v29, v29, v89
  v_mfma_f32_16x16x32_bf16 a[8:11], a[196:199], v[148:151], a[8:11]
  v_exp_f32 v93, v93
  v_mfma_f32_16x16x32_bf16 a[12:15], a[192:195], v[152:155], a[12:15]
  ds_read_b64_tr_b16 a[242:243], v11 offset:36864
  v_cvt_pk_bf16_f32 v178, v88, v89
  v_mfma_f32_16x16x32_bf16 a[12:15], a[196:199], v[156:159], a[12:15]
  v_exp_f32 v94, v94
  v_mfma_f32_16x16x32_bf16 v[60:63], v[20:23], v[152:155], v[60:63]
  ds_read_b64_tr_b16 a[244:245], v11 offset:40960
  v_add_f32 v28, v28, v90
  v_mfma_f32_16x16x32_bf16 v[60:63], v[20:23], v[156:159], v[60:63]
  v_exp_f32 v95, v95
  v_mfma_f32_16x16x32_bf16 a[28:31], a[200:203], v[152:155], a[28:31]
  v_add_f32 v29, v29, v91
  v_cvt_pk_bf16_f32 v179, v90, v91
  v_mfma_f32_16x16x32_bf16 a[28:31], a[204:207], v[156:159], a[28:31]
  v_exp_f32 v96, v96
  v_mfma_f32_16x16x32_bf16 a[24:27], a[200:203], v[144:147], a[24:27]
  ds_read_b64_tr_b16 a[246:247], v11 offset:45056
  v_cvt_pk_bf16_f32 v186, v92, v93
  v_mfma_f32_16x16x32_bf16 a[24:27], a[204:207], v[148:151], a[24:27]
  v_exp_f32 v97, v97
  v_mfma_f32_16x16x32_bf16 a[20:23], a[200:203], v[136:139], a[20:23]
  ds_read_b64_tr_b16 a[248:249], v12 offset:32768
  v_cvt_pk_bf16_f32 v187, v94, v95
  v_mfma_f32_16x16x32_bf16 a[20:23], a[204:207], v[140:143], a[20:23]
  v_exp_f32 v98, v98
  v_mfma_f32_16x16x32_bf16 a[16:19], a[200:203], v[128:131], a[16:19]
  ds_read_b64_tr_b16 a[250:251], v12 offset:36864
  v_cvt_pk_bf16_f32 v164, v96, v97
  v_mfma_f32_16x16x32_bf16 a[16:19], a[204:207], v[132:135], a[16:19]
  v_exp_f32 v99, v99
  v_mfma_f32_16x16x32_bf16 v[48:51], v[20:23], v[128:131], v[48:51]
  buffer_load_dwordx4 v14, s[12:15], s27 offen offset:1024 lds
  v_mfma_f32_16x16x32_bf16 v[48:51], v[20:23], v[132:135], v[48:51]
  s_waitcnt lgkmcnt(15)
  v_exp_f32 v100, v100
  v_mfma_f32_16x16x32_bf16 a[32:35], a[208:211], v[128:131], a[32:35]
  ds_read_b64_tr_b16 a[252:253], v12 offset:40960
  v_cvt_pk_bf16_f32 v165, v98, v99
  v_mfma_f32_16x16x32_bf16 a[32:35], a[212:215], v[132:135], a[32:35]
  v_exp_f32 v101, v101
  v_mfma_f32_16x16x32_bf16 a[36:39], a[208:211], v[136:139], a[36:39]
  ds_read_b64_tr_b16 a[254:255], v12 offset:45056
  v_add_f32 v26, v26, v100
  v_mfma_f32_16x16x32_bf16 a[36:39], a[212:215], v[140:143], a[36:39]
  v_exp_f32 v102, v102
  v_mfma_f32_16x16x32_bf16 a[40:43], a[208:211], v[144:147], a[40:43]
  ds_read_b64_tr_b16 a[192:193], v5 offset:49152
  v_add_f32 v27, v27, v101
  v_mfma_f32_16x16x32_bf16 a[40:43], a[212:215], v[148:151], a[40:43]
  v_exp_f32 v103, v103
  v_mfma_f32_16x16x32_bf16 a[44:47], a[208:211], v[152:155], a[44:47]
  v_cvt_pk_bf16_f32 v172, v100, v101
  v_add_f32 v26, v26, v102
  v_mfma_f32_16x16x32_bf16 a[44:47], a[212:215], v[156:159], a[44:47]
  v_exp_f32 v104, v104
  v_mfma_f32_16x16x32_bf16 a[60:63], a[216:219], v[152:155], a[60:63]
  s_waitcnt lgkmcnt(15)
  ds_read_b64_tr_b16 a[194:195], v5 offset:53248
  v_add_f32 v27, v27, v103
  v_mfma_f32_16x16x32_bf16 a[60:63], a[220:223], v[156:159], a[60:63]
  v_exp_f32 v105, v105
  v_mfma_f32_16x16x32_bf16 a[56:59], a[216:219], v[144:147], a[56:59]
  ds_read_b64_tr_b16 a[196:197], v5 offset:57344
  v_cvt_pk_bf16_f32 v173, v102, v103
  v_mfma_f32_16x16x32_bf16 a[56:59], a[220:223], v[148:151], a[56:59]
  v_exp_f32 v106, v106
  v_mfma_f32_16x16x32_bf16 a[52:55], a[216:219], v[136:139], a[52:55]
  ds_read_b64_tr_b16 a[198:199], v5 offset:61440
  v_add_f32 v28, v28, v104
  v_mfma_f32_16x16x32_bf16 a[52:55], a[220:223], v[140:143], a[52:55]
  v_exp_f32 v107, v107
  v_mfma_f32_16x16x32_bf16 a[48:51], a[216:219], v[128:131], a[48:51]
  v_mfma_f32_16x16x32_bf16 a[48:51], a[220:223], v[132:135], a[48:51]
  buffer_load_dwordx4 v15, s[12:15], s27 offen offset:2048 lds
  v_mfma_f32_16x16x32_bf16 a[64:67], a[224:227], v[128:131], a[64:67]
  s_waitcnt lgkmcnt(15)
  v_exp_f32 v108, v108
  v_mfma_f32_16x16x32_bf16 a[64:67], a[228:231], v[132:135], a[64:67]
  ds_read_b64_tr_b16 a[200:201], v6 offset:49152
  v_add_f32 v29, v29, v105
  v_mfma_f32_16x16x32_bf16 a[68:71], a[224:227], v[136:139], a[68:71]
  v_exp_f32 v109, v109
  v_mfma_f32_16x16x32_bf16 a[68:71], a[228:231], v[140:143], a[68:71]
  ds_read_b64_tr_b16 a[202:203], v6 offset:53248
  v_cvt_pk_bf16_f32 v180, v104, v105
  v_mfma_f32_16x16x32_bf16 a[72:75], a[224:227], v[144:147], a[72:75]
  v_exp_f32 v110, v110
  v_mfma_f32_16x16x32_bf16 a[72:75], a[228:231], v[148:151], a[72:75]
  ds_read_b64_tr_b16 a[204:205], v6 offset:57344
  v_add_f32 v28, v28, v106
  v_mfma_f32_16x16x32_bf16 a[76:79], a[224:227], v[152:155], a[76:79]
  v_exp_f32 v111, v111
  v_mfma_f32_16x16x32_bf16 a[76:79], a[228:231], v[156:159], a[76:79]
  s_waitcnt lgkmcnt(15)
  v_add_f32 v29, v29, v107
  v_cvt_pk_bf16_f32 v181, v106, v107
  v_mfma_f32_16x16x32_bf16 a[92:95], a[232:235], v[152:155], a[92:95]
  v_exp_f32 v112, v112
  v_mfma_f32_16x16x32_bf16 a[92:95], a[236:239], v[156:159], a[92:95]
  ds_read_b64_tr_b16 a[206:207], v6 offset:61440
  v_cvt_pk_bf16_f32 v188, v108, v109
  v_mfma_f32_16x16x32_bf16 a[88:91], a[232:235], v[144:147], a[88:91]
  v_exp_f32 v113, v113
  v_mfma_f32_16x16x32_bf16 a[88:91], a[236:239], v[148:151], a[88:91]
  ds_read_b64_tr_b16 a[208:209], v7 offset:49152
  v_cvt_pk_bf16_f32 v189, v110, v111
  v_mfma_f32_16x16x32_bf16 a[84:87], a[232:235], v[136:139], a[84:87]
  v_exp_f32 v114, v114
  v_mfma_f32_16x16x32_bf16 a[84:87], a[236:239], v[140:143], a[84:87]
  ds_read_b64_tr_b16 a[210:211], v7 offset:53248
  v_cvt_pk_bf16_f32 v166, v112, v113
  v_mfma_f32_16x16x32_bf16 a[80:83], a[232:235], v[128:131], a[80:83]
  v_exp_f32 v115, v115
  v_mfma_f32_16x16x32_bf16 a[80:83], a[236:239], v[132:135], a[80:83]
  s_waitcnt lgkmcnt(15)
  buffer_load_dwordx4 v16, s[12:15], s27 offen offset:3072 lds
  v_mfma_f32_16x16x32_bf16 a[96:99], a[240:243], v[128:131], a[96:99]
  s_waitcnt lgkmcnt(14)
  s_add_u32 s27, s27, 262144
  v_exp_f32 v116, v116
  v_mfma_f32_16x16x32_bf16 a[96:99], a[244:247], v[132:135], a[96:99]
  ds_read_b64_tr_b16 a[212:213], v7 offset:57344
  v_cvt_pk_bf16_f32 v167, v114, v115
  v_mfma_f32_16x16x32_bf16 a[100:103], a[240:243], v[136:139], a[100:103]
  v_exp_f32 v117, v117
  v_mfma_f32_16x16x32_bf16 a[100:103], a[244:247], v[140:143], a[100:103]
  ds_read_b64_tr_b16 a[214:215], v7 offset:61440
  v_add_f32 v26, v26, v116
  v_mfma_f32_16x16x32_bf16 a[104:107], a[240:243], v[144:147], a[104:107]
  v_exp_f32 v118, v118
  v_mfma_f32_16x16x32_bf16 a[104:107], a[244:247], v[148:151], a[104:107]
  ds_read_b64_tr_b16 a[216:217], v8 offset:49152
  v_add_f32 v27, v27, v117
  v_mfma_f32_16x16x32_bf16 a[108:111], a[240:243], v[152:155], a[108:111]
  v_exp_f32 v119, v119
  v_mfma_f32_16x16x32_bf16 a[108:111], a[244:247], v[156:159], a[108:111]
  s_waitcnt lgkmcnt(15)
  v_cvt_pk_bf16_f32 v174, v116, v117
  v_add_f32 v26, v26, v118
  v_mfma_f32_16x16x32_bf16 a[124:127], a[248:251], v[152:155], a[124:127]
  s_waitcnt lgkmcnt(13)
  v_exp_f32 v120, v120
  v_mfma_f32_16x16x32_bf16 a[124:127], a[252:255], v[156:159], a[124:127]
  ds_read_b64_tr_b16 a[218:219], v8 offset:53248
  v_add_f32 v27, v27, v119
  v_mfma_f32_16x16x32_bf16 a[120:123], a[248:251], v[144:147], a[120:123]
  v_exp_f32 v121, v121
  v_mfma_f32_16x16x32_bf16 a[120:123], a[252:255], v[148:151], a[120:123]
  ds_read_b64_tr_b16 a[220:221], v8 offset:57344
  v_cvt_pk_bf16_f32 v175, v118, v119
  v_mfma_f32_16x16x32_bf16 a[116:119], a[248:251], v[136:139], a[116:119]
  v_exp_f32 v122, v122
  v_mfma_f32_16x16x32_bf16 a[116:119], a[252:255], v[140:143], a[116:119]
  ds_read_b64_tr_b16 a[222:223], v8 offset:61440
  v_add_f32 v28, v28, v120
  v_mfma_f32_16x16x32_bf16 a[112:115], a[248:251], v[128:131], a[112:115]
  s_add_u32 m0, s26, 49152
  v_exp_f32 v123, v123
  v_mfma_f32_16x16x32_bf16 a[112:115], a[252:255], v[132:135], a[112:115]
  s_waitcnt vmcnt(8)
  s_barrier
  v_exp_f32 v124, v124
  v_add_f32 v29, v29, v121
  v_exp_f32 v125, v125
  v_cvt_pk_bf16_f32 v182, v120, v121
  v_exp_f32 v126, v126
  v_add_f32 v28, v28, v122
  v_exp_f32 v127, v127
  v_add_f32 v29, v29, v123
  v_cvt_pk_bf16_f32 v183, v122, v123
  v_cvt_pk_bf16_f32 v190, v124, v125
  v_cvt_pk_bf16_f32 v191, v126, v127
  v_mfma_f32_16x16x32_bf16 v[48:51], v[20:23], v[160:163], v[48:51]
  s_add_u32 m0, s26, 49152
  ds_read_b64_tr_b16 a[224:225], v9 offset:49152
  v_add_f32 v65, v26, v27
  v_mfma_f32_16x16x32_bf16 v[48:51], v[20:23], v[164:167], v[48:51]
  ds_read_b64_tr_b16 a[226:227], v9 offset:53248
  buffer_load_dwordx4 v13, s[12:15], s27 offen offset:0 lds
  v_add_f32 v66, v28, v29
  v_mfma_f32_16x16x32_bf16 v[60:63], v[20:23], v[184:187], v[60:63]
  ds_read_b64_tr_b16 a[228:229], v9 offset:57344
  v_mov_b32 v69, v65
  v_mfma_f32_16x16x32_bf16 v[60:63], v[20:23], v[188:191], v[60:63]
  s_waitcnt lgkmcnt(15)
  ds_read_b64_tr_b16 a[230:231], v9 offset:61440
  v_mov_b32 v70, v66
  v_mfma_f32_16x16x32_bf16 a[0:3], a[192:195], v[160:163], a[0:3]
  ds_read_b64_tr_b16 a[232:233], v10 offset:49152
  buffer_load_dwordx4 v14, s[12:15], s27 offen offset:1024 lds
  v_permlane16_swap_b32 v69, v65
  v_mfma_f32_16x16x32_bf16 a[0:3], a[196:199], v[164:167], a[0:3]
  ds_read_b64_tr_b16 a[234:235], v10 offset:53248
  v_permlane16_swap_b32 v70, v66
  v_mfma_f32_16x16x32_bf16 a[4:7], a[192:195], v[168:171], a[4:7]
  ds_read_b64_tr_b16 a[236:237], v10 offset:57344
  v_add_f32 v65, v65, v69
  v_mfma_f32_16x16x32_bf16 a[4:7], a[196:199], v[172:175], a[4:7]
  ds_read_b64_tr_b16 a[238:239], v10 offset:61440
  buffer_load_dwordx4 v15, s[12:15], s27 offen offset:2048 lds
  v_add_f32 v66, v66, v70
  v_mfma_f32_16x16x32_bf16 a[8:11], a[192:195], v[176:179], a[8:11]
  ds_read_b64_tr_b16 a[240:241], v11 offset:49152
  v_mov_b32 v69, v65
  v_mfma_f32_16x16x32_bf16 a[8:11], a[196:199], v[180:183], a[8:11]
  ds_read_b64_tr_b16 a[242:243], v11 offset:53248
  v_mov_b32 v70, v66
  v_mfma_f32_16x16x32_bf16 a[12:15], a[192:195], v[184:187], a[12:15]
  ds_read_b64_tr_b16 a[244:245], v11 offset:57344
  buffer_load_dwordx4 v16, s[12:15], s27 offen offset:3072 lds
  v_permlane32_swap_b32 v69, v65
  v_mfma_f32_16x16x32_bf16 a[12:15], a[196:199], v[188:191], a[12:15]
  s_waitcnt lgkmcnt(15)
  s_add_u32 s27, s27, 262144
  ds_read_b64_tr_b16 a[246:247], v11 offset:61440
  v_permlane32_swap_b32 v70, v66
  v_mfma_f32_16x16x32_bf16 a[28:31], a[200:203], v[184:187], a[28:31]
  s_add_u32 m0, s26, 98304
  ds_read_b64_tr_b16 a[248:249], v12 offset:49152
  v_add_f32 v65, v65, v69
  v_mfma_f32_16x16x32_bf16 a[28:31], a[204:207], v[188:191], a[28:31]
  ds_read_b64_tr_b16 a[250:251], v12 offset:53248
  buffer_load_dwordx4 v13, s[12:15], s27 offen offset:0 lds
  v_add_f32 v66, v66, v70
  v_mfma_f32_16x16x32_bf16 a[24:27], a[200:203], v[176:179], a[24:27]
  ds_read_b64_tr_b16 a[252:253], v12 offset:57344
  v_mov_b32 v64, v48
  v_mfma_f32_16x16x32_bf16 a[24:27], a[204:207], v[180:183], a[24:27]
  ds_read_b64_tr_b16 a[254:255], v12 offset:61440
  v_mov_b32 v67, v60
  v_mfma_f32_16x16x32_bf16 a[20:23], a[200:203], v[168:171], a[20:23]
  s_mov_b32 s32, 0x53800000
  buffer_load_dwordx4 v14, s[12:15], s27 offen offset:1024 lds
  v_rcp_f32 v68, v64
  v_mfma_f32_16x16x32_bf16 a[20:23], a[204:207], v[172:175], a[20:23]
  s_mov_b32 s33, 0x31800000
  v_rcp_f32 v69, v65
  v_mfma_f32_16x16x32_bf16 a[16:19], a[200:203], v[160:163], a[16:19]
  v_rcp_f32 v70, v66
  v_mfma_f32_16x16x32_bf16 a[16:19], a[204:207], v[164:167], a[16:19]
  buffer_load_dwordx4 v15, s[12:15], s27 offen offset:2048 lds
  v_rcp_f32 v71, v67
  v_mfma_f32_16x16x32_bf16 a[32:35], a[208:211], v[160:163], a[32:35]
  v_min3_f32 v104, v64, v65, v66
  v_add_f32 v105, v64, v65
  v_mfma_f32_16x16x32_bf16 a[32:35], a[212:215], v[164:167], a[32:35]
  v_add_f32 v106, v66, v67
  v_min_f32 v104, v104, v67
  v_mfma_f32_16x16x32_bf16 a[36:39], a[208:211], v[168:171], a[36:39]
  buffer_load_dwordx4 v16, s[12:15], s27 offen offset:3072 lds
  v_add_f32 v105, v105, v106
  v_cmp_nge_f32 s[46:47], s32, v105
  v_mfma_f32_16x16x32_bf16 a[36:39], a[212:215], v[172:175], a[36:39]
  s_add_u32 s27, s27, 262144
  v_cmp_nle_f32 vcc, s33, v104
  v_mfma_f32_16x16x32_bf16 a[40:43], a[208:211], v[176:179], a[40:43]
  v_accvgpr_read_b32 v88, a12
  v_accvgpr_read_b32 v89, a13
  v_mfma_f32_16x16x32_bf16 a[40:43], a[212:215], v[180:183], a[40:43]
  s_or_b64 s[46:47], vcc, s[46:47]
  s_cselect_b32 s46, 1, 0
  v_accvgpr_read_b32 v90, a14
  v_accvgpr_read_b32 v91, a15
  v_mfma_f32_16x16x32_bf16 a[44:47], a[208:211], v[184:187], a[44:47]
  s_cmp_eq_u32 s28, 0
  s_cselect_b32 s46, s46, 0
  v_accvgpr_read_b32 v92, a28
  v_accvgpr_read_b32 v93, a29
  v_mfma_f32_16x16x32_bf16 a[44:47], a[212:215], v[188:191], a[44:47]
  s_waitcnt lgkmcnt(15)
  s_cmp_eq_u32 s46, 0
  s_cselect_b32 s47, s44, 0x7f000000
  v_accvgpr_read_b32 v94, a30
  v_accvgpr_read_b32 v95, a31
  v_mfma_f32_16x16x32_bf16 a[60:63], a[216:219], v[184:187], a[60:63]
  v_mul_f32 v88, v88, v71
  v_mul_f32 v89, v89, v71
  v_mfma_f32_16x16x32_bf16 a[60:63], a[220:223], v[188:191], a[60:63]
  v_mul_f32 v90, v90, v71
  v_mul_f32 v91, v91, v71
  v_mfma_f32_16x16x32_bf16 a[56:59], a[216:219], v[176:179], a[56:59]
  v_mul_f32 v92, v92, v71
  v_mul_f32 v93, v93, v71
  v_mfma_f32_16x16x32_bf16 a[56:59], a[220:223], v[180:183], a[56:59]
  v_mul_f32 v94, v94, v71
  v_mul_f32 v95, v95, v71
  v_mfma_f32_16x16x32_bf16 a[52:55], a[216:219], v[168:171], a[52:55]
  v_cvt_pk_bf16_f32 v72, v88, v89
  v_cvt_pk_bf16_f32 v73, v90, v91
  v_mfma_f32_16x16x32_bf16 a[52:55], a[220:223], v[172:175], a[52:55]
  v_cvt_pk_bf16_f32 v74, v92, v93
  v_cvt_pk_bf16_f32 v75, v94, v95
  v_mfma_f32_16x16x32_bf16 a[48:51], a[216:219], v[160:163], a[48:51]
  buffer_store_dwordx4 v[72:75], v0, s[16:19], s48 offen offset:3072 sc1
  v_mfma_f32_16x16x32_bf16 a[48:51], a[220:223], v[164:167], a[48:51]
  s_waitcnt lgkmcnt(14)
  v_accvgpr_read_b32 v96, a8
  v_accvgpr_read_b32 v97, a9
  v_mfma_f32_16x16x32_bf16 a[64:67], a[224:227], v[160:163], a[64:67]
  s_waitcnt lgkmcnt(12)
  v_accvgpr_read_b32 v98, a10
  v_accvgpr_read_b32 v99, a11
  v_mfma_f32_16x16x32_bf16 a[64:67], a[228:231], v[164:167], a[64:67]
  v_accvgpr_read_b32 v100, a24
  v_accvgpr_read_b32 v101, a25
  v_mfma_f32_16x16x32_bf16 a[68:71], a[224:227], v[168:171], a[68:71]
  v_accvgpr_read_b32 v102, a26
  v_accvgpr_read_b32 v103, a27
  v_mfma_f32_16x16x32_bf16 a[68:71], a[228:231], v[172:175], a[68:71]
  v_mul_f32 v96, v96, v70
  v_mul_f32 v97, v97, v70
  v_mfma_f32_16x16x32_bf16 a[72:75], a[224:227], v[176:179], a[72:75]
  v_mul_f32 v98, v98, v70
  v_mul_f32 v99, v99, v70
  v_mfma_f32_16x16x32_bf16 a[72:75], a[228:231], v[180:183], a[72:75]
  v_mul_f32 v100, v100, v70
  v_mul_f32 v101, v101, v70
  v_mfma_f32_16x16x32_bf16 a[76:79], a[224:227], v[184:187], a[76:79]
  v_mul_f32 v102, v102, v70
  v_mul_f32 v103, v103, v70
  v_mfma_f32_16x16x32_bf16 a[76:79], a[228:231], v[188:191], a[76:79]
  s_waitcnt lgkmcnt(10)
  v_cvt_pk_bf16_f32 v76, v96, v97
  v_cvt_pk_bf16_f32 v77, v98, v99
  v_mfma_f32_16x16x32_bf16 a[92:95], a[232:235], v[184:187], a[92:95]
  s_waitcnt lgkmcnt(8)
  v_cvt_pk_bf16_f32 v78, v100, v101
  v_cvt_pk_bf16_f32 v79, v102, v103
  v_mfma_f32_16x16x32_bf16 a[92:95], a[236:239], v[188:191], a[92:95]
  buffer_store_dwordx4 v[76:79], v0, s[16:19], s48 offen offset:2048 sc1
  v_mfma_f32_16x16x32_bf16 a[88:91], a[232:235], v[176:179], a[88:91]
  v_accvgpr_read_b32 v88, a4
  v_accvgpr_read_b32 v89, a5
  v_mfma_f32_16x16x32_bf16 a[88:91], a[236:239], v[180:183], a[88:91]
  v_accvgpr_read_b32 v90, a6
  v_accvgpr_read_b32 v91, a7
  v_mfma_f32_16x16x32_bf16 a[84:87], a[232:235], v[168:171], a[84:87]
  v_accvgpr_read_b32 v92, a20
  v_accvgpr_read_b32 v93, a21
  v_mfma_f32_16x16x32_bf16 a[84:87], a[236:239], v[172:175], a[84:87]
  v_accvgpr_read_b32 v94, a22
  v_accvgpr_read_b32 v95, a23
  v_mfma_f32_16x16x32_bf16 a[80:83], a[232:235], v[160:163], a[80:83]
  v_mul_f32 v88, v88, v69
  v_mul_f32 v89, v89, v69
  v_mfma_f32_16x16x32_bf16 a[80:83], a[236:239], v[164:167], a[80:83]
  s_waitcnt lgkmcnt(6)
  v_mul_f32 v90, v90, v69
  v_mul_f32 v91, v91, v69
  v_mfma_f32_16x16x32_bf16 a[96:99], a[240:243], v[160:163], a[96:99]
  s_waitcnt lgkmcnt(4)
  v_mul_f32 v92, v92, v69
  v_mul_f32 v93, v93, v69
  v_mfma_f32_16x16x32_bf16 a[96:99], a[244:247], v[164:167], a[96:99]
  v_mul_f32 v94, v94, v69
  v_mul_f32 v95, v95, v69
  v_mfma_f32_16x16x32_bf16 a[100:103], a[240:243], v[168:171], a[100:103]
  v_cvt_pk_bf16_f32 v80, v88, v89
  v_cvt_pk_bf16_f32 v81, v90, v91
  v_mfma_f32_16x16x32_bf16 a[100:103], a[244:247], v[172:175], a[100:103]
  v_cvt_pk_bf16_f32 v82, v92, v93
  v_cvt_pk_bf16_f32 v83, v94, v95
  v_mfma_f32_16x16x32_bf16 a[104:107], a[240:243], v[176:179], a[104:107]
  buffer_store_dwordx4 v[80:83], v0, s[16:19], s48 offen offset:1024 sc1
  v_mfma_f32_16x16x32_bf16 a[104:107], a[244:247], v[180:183], a[104:107]
  v_accvgpr_read_b32 v96, a0
  v_accvgpr_read_b32 v97, a1
  v_mfma_f32_16x16x32_bf16 a[108:111], a[240:243], v[184:187], a[108:111]
  v_accvgpr_read_b32 v98, a2
  v_accvgpr_read_b32 v99, a3
  v_mfma_f32_16x16x32_bf16 a[108:111], a[244:247], v[188:191], a[108:111]
  s_waitcnt lgkmcnt(2)
  v_accvgpr_read_b32 v100, a16
  v_accvgpr_read_b32 v101, a17
  v_mfma_f32_16x16x32_bf16 a[124:127], a[248:251], v[184:187], a[124:127]
  s_waitcnt lgkmcnt(0)
  v_accvgpr_read_b32 v102, a18
  v_accvgpr_read_b32 v103, a19
  v_mfma_f32_16x16x32_bf16 a[124:127], a[252:255], v[188:191], a[124:127]
  v_mul_f32 v96, v96, v68
  v_mul_f32 v97, v97, v68
  v_mfma_f32_16x16x32_bf16 a[120:123], a[248:251], v[176:179], a[120:123]
  v_mul_f32 v98, v98, v68
  v_mul_f32 v99, v99, v68
  v_mfma_f32_16x16x32_bf16 a[120:123], a[252:255], v[180:183], a[120:123]
  v_mul_f32 v100, v100, v68
  v_mul_f32 v101, v101, v68
  v_mfma_f32_16x16x32_bf16 a[116:119], a[248:251], v[168:171], a[116:119]
  v_mul_f32 v102, v102, v68
  v_mul_f32 v103, v103, v68
  v_mfma_f32_16x16x32_bf16 a[116:119], a[252:255], v[172:175], a[116:119]
  v_cvt_pk_bf16_f32 v84, v96, v97
  v_cvt_pk_bf16_f32 v85, v98, v99
  v_mfma_f32_16x16x32_bf16 a[112:115], a[248:251], v[160:163], a[112:115]
  v_cvt_pk_bf16_f32 v86, v100, v101
  v_cvt_pk_bf16_f32 v87, v102, v103
  v_mfma_f32_16x16x32_bf16 a[112:115], a[252:255], v[164:167], a[112:115]
  buffer_store_dwordx4 v[84:87], v0, s[16:19], s48 offen offset:0 sc1
  v_accvgpr_read_b32 v88, a32
  v_accvgpr_read_b32 v89, a33
  v_accvgpr_read_b32 v90, a34
  v_accvgpr_read_b32 v91, a35
  v_accvgpr_read_b32 v92, a48
  v_accvgpr_read_b32 v93, a49
  v_accvgpr_read_b32 v94, a50
  v_accvgpr_read_b32 v95, a51
  v_pk_mul_f32 v[88:89], v[88:89], v[68:69] op_sel:[0,0] op_sel_hi:[1,0]
  v_pk_mul_f32 v[90:91], v[90:91], v[68:69] op_sel:[0,0] op_sel_hi:[1,0]
  v_pk_mul_f32 v[92:93], v[92:93], v[68:69] op_sel:[0,0] op_sel_hi:[1,0]
  v_pk_mul_f32 v[94:95], v[94:95], v[68:69] op_sel:[0,0] op_sel_hi:[1,0]
  v_cvt_pk_bf16_f32 v72, v88, v89
  v_cvt_pk_bf16_f32 v73, v90, v91
  v_cvt_pk_bf16_f32 v74, v92, v93
  v_cvt_pk_bf16_f32 v75, v94, v95
  buffer_store_dwordx4 v[72:75], v0, s[16:19], s49 offen offset:0 sc1
  v_accvgpr_read_b32 v96, a36
  v_accvgpr_read_b32 v97, a37
  v_accvgpr_read_b32 v98, a38
  v_accvgpr_read_b32 v99, a39
  v_accvgpr_read_b32 v100, a52
  v_accvgpr_read_b32 v101, a53
  v_accvgpr_read_b32 v102, a54
  v_accvgpr_read_b32 v103, a55
  v_pk_mul_f32 v[96:97], v[96:97], v[68:69] op_sel:[0,1] op_sel_hi:[1,1]
  v_pk_mul_f32 v[98:99], v[98:99], v[68:69] op_sel:[0,1] op_sel_hi:[1,1]
  v_pk_mul_f32 v[100:101], v[100:101], v[68:69] op_sel:[0,1] op_sel_hi:[1,1]
  v_pk_mul_f32 v[102:103], v[102:103], v[68:69] op_sel:[0,1] op_sel_hi:[1,1]
  v_cvt_pk_bf16_f32 v76, v96, v97
  v_cvt_pk_bf16_f32 v77, v98, v99
  v_cvt_pk_bf16_f32 v78, v100, v101
  v_cvt_pk_bf16_f32 v79, v102, v103
  buffer_store_dwordx4 v[76:79], v0, s[16:19], s49 offen offset:1024 sc1
  v_accvgpr_read_b32 v88, a40
  v_accvgpr_read_b32 v89, a41
  v_accvgpr_read_b32 v90, a42
  v_accvgpr_read_b32 v91, a43
  v_accvgpr_read_b32 v92, a56
  v_accvgpr_read_b32 v93, a57
  v_accvgpr_read_b32 v94, a58
  v_accvgpr_read_b32 v95, a59
  v_pk_mul_f32 v[88:89], v[88:89], v[70:71] op_sel:[0,0] op_sel_hi:[1,0]
  v_pk_mul_f32 v[90:91], v[90:91], v[70:71] op_sel:[0,0] op_sel_hi:[1,0]
  v_pk_mul_f32 v[92:93], v[92:93], v[70:71] op_sel:[0,0] op_sel_hi:[1,0]
  v_pk_mul_f32 v[94:95], v[94:95], v[70:71] op_sel:[0,0] op_sel_hi:[1,0]
  v_cvt_pk_bf16_f32 v80, v88, v89
  v_cvt_pk_bf16_f32 v81, v90, v91
  v_cvt_pk_bf16_f32 v82, v92, v93
  v_cvt_pk_bf16_f32 v83, v94, v95
  buffer_store_dwordx4 v[80:83], v0, s[16:19], s49 offen offset:2048 sc1
  v_accvgpr_read_b32 v96, a44
  v_accvgpr_read_b32 v97, a45
  v_accvgpr_read_b32 v98, a46
  v_accvgpr_read_b32 v99, a47
  v_accvgpr_read_b32 v100, a60
  v_accvgpr_read_b32 v101, a61
  v_accvgpr_read_b32 v102, a62
  v_accvgpr_read_b32 v103, a63
  v_pk_mul_f32 v[96:97], v[96:97], v[70:71] op_sel:[0,1] op_sel_hi:[1,1]
  v_pk_mul_f32 v[98:99], v[98:99], v[70:71] op_sel:[0,1] op_sel_hi:[1,1]
  v_pk_mul_f32 v[100:101], v[100:101], v[70:71] op_sel:[0,1] op_sel_hi:[1,1]
  v_pk_mul_f32 v[102:103], v[102:103], v[70:71] op_sel:[0,1] op_sel_hi:[1,1]
  v_cvt_pk_bf16_f32 v84, v96, v97
  v_cvt_pk_bf16_f32 v85, v98, v99
  v_cvt_pk_bf16_f32 v86, v100, v101
  v_cvt_pk_bf16_f32 v87, v102, v103
  buffer_store_dwordx4 v[84:87], v0, s[16:19], s49 offen offset:3072 sc1
  v_accvgpr_read_b32 v88, a64
  v_accvgpr_read_b32 v89, a65
  v_accvgpr_read_b32 v90, a66
  v_accvgpr_read_b32 v91, a67
  v_accvgpr_read_b32 v92, a80
  v_accvgpr_read_b32 v93, a81
  v_accvgpr_read_b32 v94, a82
  v_accvgpr_read_b32 v95, a83
  v_pk_mul_f32 v[88:89], v[88:89], v[68:69] op_sel:[0,0] op_sel_hi:[1,0]
  v_pk_mul_f32 v[90:91], v[90:91], v[68:69] op_sel:[0,0] op_sel_hi:[1,0]
  v_pk_mul_f32 v[92:93], v[92:93], v[68:69] op_sel:[0,0] op_sel_hi:[1,0]
  v_pk_mul_f32 v[94:95], v[94:95], v[68:69] op_sel:[0,0] op_sel_hi:[1,0]
  v_cvt_pk_bf16_f32 v72, v88, v89
  v_cvt_pk_bf16_f32 v73, v90, v91
  v_cvt_pk_bf16_f32 v74, v92, v93
  v_cvt_pk_bf16_f32 v75, v94, v95
  buffer_store_dwordx4 v[72:75], v0, s[16:19], s50 offen offset:0 sc1
  v_accvgpr_read_b32 v96, a68
  v_accvgpr_read_b32 v97, a69
  v_accvgpr_read_b32 v98, a70
  v_accvgpr_read_b32 v99, a71
  v_accvgpr_read_b32 v100, a84
  v_accvgpr_read_b32 v101, a85
  v_accvgpr_read_b32 v102, a86
  v_accvgpr_read_b32 v103, a87
  v_pk_mul_f32 v[96:97], v[96:97], v[68:69] op_sel:[0,1] op_sel_hi:[1,1]
  v_pk_mul_f32 v[98:99], v[98:99], v[68:69] op_sel:[0,1] op_sel_hi:[1,1]
  v_pk_mul_f32 v[100:101], v[100:101], v[68:69] op_sel:[0,1] op_sel_hi:[1,1]
  v_pk_mul_f32 v[102:103], v[102:103], v[68:69] op_sel:[0,1] op_sel_hi:[1,1]
  v_cvt_pk_bf16_f32 v76, v96, v97
  v_cvt_pk_bf16_f32 v77, v98, v99
  v_cvt_pk_bf16_f32 v78, v100, v101
  v_cvt_pk_bf16_f32 v79, v102, v103
  buffer_store_dwordx4 v[76:79], v0, s[16:19], s50 offen offset:1024 sc1
  s_waitcnt vmcnt(6)
  buffer_store_dwordx2 v[18:19], v55, s[16:19], s47 offen offset:64
  v_accvgpr_read_b32 v88, a72
  v_accvgpr_read_b32 v89, a73
  v_accvgpr_read_b32 v90, a74
  v_accvgpr_read_b32 v91, a75
  v_accvgpr_read_b32 v92, a88
  v_accvgpr_read_b32 v93, a89
  v_accvgpr_read_b32 v94, a90
  v_accvgpr_read_b32 v95, a91
  v_pk_mul_f32 v[88:89], v[88:89], v[70:71] op_sel:[0,0] op_sel_hi:[1,0]
  v_pk_mul_f32 v[90:91], v[90:91], v[70:71] op_sel:[0,0] op_sel_hi:[1,0]
  v_pk_mul_f32 v[92:93], v[92:93], v[70:71] op_sel:[0,0] op_sel_hi:[1,0]
  v_pk_mul_f32 v[94:95], v[94:95], v[70:71] op_sel:[0,0] op_sel_hi:[1,0]
  v_cvt_pk_bf16_f32 v80, v88, v89
  v_cvt_pk_bf16_f32 v81, v90, v91
  v_cvt_pk_bf16_f32 v82, v92, v93
  v_cvt_pk_bf16_f32 v83, v94, v95
  buffer_store_dwordx4 v[80:83], v0, s[16:19], s50 offen offset:2048 sc1
  v_accvgpr_read_b32 v96, a76
  v_accvgpr_read_b32 v97, a77
  v_accvgpr_read_b32 v98, a78
  v_accvgpr_read_b32 v99, a79
  v_accvgpr_read_b32 v100, a92
  v_accvgpr_read_b32 v101, a93
  v_accvgpr_read_b32 v102, a94
  v_accvgpr_read_b32 v103, a95
  v_pk_mul_f32 v[96:97], v[96:97], v[70:71] op_sel:[0,1] op_sel_hi:[1,1]
  v_pk_mul_f32 v[98:99], v[98:99], v[70:71] op_sel:[0,1] op_sel_hi:[1,1]
  v_pk_mul_f32 v[100:101], v[100:101], v[70:71] op_sel:[0,1] op_sel_hi:[1,1]
  v_pk_mul_f32 v[102:103], v[102:103], v[70:71] op_sel:[0,1] op_sel_hi:[1,1]
  v_cvt_pk_bf16_f32 v84, v96, v97
  v_cvt_pk_bf16_f32 v85, v98, v99
  v_cvt_pk_bf16_f32 v86, v100, v101
  v_cvt_pk_bf16_f32 v87, v102, v103
  buffer_store_dwordx4 v[84:87], v0, s[16:19], s50 offen offset:3072 sc1
  v_accvgpr_read_b32 v88, a96
  v_accvgpr_read_b32 v89, a97
  v_accvgpr_read_b32 v90, a98
  v_accvgpr_read_b32 v91, a99
  v_accvgpr_read_b32 v92, a112
  v_accvgpr_read_b32 v93, a113
  v_accvgpr_read_b32 v94, a114
  v_accvgpr_read_b32 v95, a115
  v_pk_mul_f32 v[88:89], v[88:89], v[68:69] op_sel:[0,0] op_sel_hi:[1,0]
  v_pk_mul_f32 v[90:91], v[90:91], v[68:69] op_sel:[0,0] op_sel_hi:[1,0]
  v_pk_mul_f32 v[92:93], v[92:93], v[68:69] op_sel:[0,0] op_sel_hi:[1,0]
  v_pk_mul_f32 v[94:95], v[94:95], v[68:69] op_sel:[0,0] op_sel_hi:[1,0]
  v_cvt_pk_bf16_f32 v72, v88, v89
  v_cvt_pk_bf16_f32 v73, v90, v91
  v_cvt_pk_bf16_f32 v74, v92, v93
  v_cvt_pk_bf16_f32 v75, v94, v95
  buffer_store_dwordx4 v[72:75], v0, s[16:19], s51 offen offset:0 sc1
  v_accvgpr_read_b32 v96, a100
  v_accvgpr_read_b32 v97, a101
  v_accvgpr_read_b32 v98, a102
  v_accvgpr_read_b32 v99, a103
  v_accvgpr_read_b32 v100, a116
  v_accvgpr_read_b32 v101, a117
  v_accvgpr_read_b32 v102, a118
  v_accvgpr_read_b32 v103, a119
  v_pk_mul_f32 v[96:97], v[96:97], v[68:69] op_sel:[0,1] op_sel_hi:[1,1]
  v_pk_mul_f32 v[98:99], v[98:99], v[68:69] op_sel:[0,1] op_sel_hi:[1,1]
  v_pk_mul_f32 v[100:101], v[100:101], v[68:69] op_sel:[0,1] op_sel_hi:[1,1]
  v_pk_mul_f32 v[102:103], v[102:103], v[68:69] op_sel:[0,1] op_sel_hi:[1,1]
  v_cvt_pk_bf16_f32 v76, v96, v97
  v_cvt_pk_bf16_f32 v77, v98, v99
  v_cvt_pk_bf16_f32 v78, v100, v101
  v_cvt_pk_bf16_f32 v79, v102, v103
  buffer_store_dwordx4 v[76:79], v0, s[16:19], s51 offen offset:1024 sc1
  v_accvgpr_read_b32 v88, a104
  v_accvgpr_read_b32 v89, a105
  v_accvgpr_read_b32 v90, a106
  v_accvgpr_read_b32 v91, a107
  v_accvgpr_read_b32 v92, a120
  v_accvgpr_read_b32 v93, a121
  v_accvgpr_read_b32 v94, a122
  v_accvgpr_read_b32 v95, a123
  v_pk_mul_f32 v[88:89], v[88:89], v[70:71] op_sel:[0,0] op_sel_hi:[1,0]
  v_pk_mul_f32 v[90:91], v[90:91], v[70:71] op_sel:[0,0] op_sel_hi:[1,0]
  v_pk_mul_f32 v[92:93], v[92:93], v[70:71] op_sel:[0,0] op_sel_hi:[1,0]
  v_pk_mul_f32 v[94:95], v[94:95], v[70:71] op_sel:[0,0] op_sel_hi:[1,0]
  v_cvt_pk_bf16_f32 v80, v88, v89
  v_cvt_pk_bf16_f32 v81, v90, v91
  v_cvt_pk_bf16_f32 v82, v92, v93
  v_cvt_pk_bf16_f32 v83, v94, v95
  buffer_store_dwordx4 v[80:83], v0, s[16:19], s51 offen offset:2048 sc1
  v_accvgpr_read_b32 v96, a108
  v_accvgpr_read_b32 v97, a109
  v_accvgpr_read_b32 v98, a110
  v_accvgpr_read_b32 v99, a111
  v_accvgpr_read_b32 v100, a124
  v_accvgpr_read_b32 v101, a125
  v_accvgpr_read_b32 v102, a126
  v_accvgpr_read_b32 v103, a127
  v_pk_mul_f32 v[96:97], v[96:97], v[70:71] op_sel:[0,1] op_sel_hi:[1,1]
  v_pk_mul_f32 v[98:99], v[98:99], v[70:71] op_sel:[0,1] op_sel_hi:[1,1]
  v_pk_mul_f32 v[100:101], v[100:101], v[70:71] op_sel:[0,1] op_sel_hi:[1,1]
  v_pk_mul_f32 v[102:103], v[102:103], v[70:71] op_sel:[0,1] op_sel_hi:[1,1]
  v_cvt_pk_bf16_f32 v84, v96, v97
  v_cvt_pk_bf16_f32 v85, v98, v99
  v_cvt_pk_bf16_f32 v86, v100, v101
  v_cvt_pk_bf16_f32 v87, v102, v103
  buffer_store_dwordx4 v[84:87], v0, s[16:19], s51 offen offset:3072 sc1
  buffer_load_dwordx2 v[56:57], v58, s[16:19], s45 offen offset:64 sc1
  s_load_dwordx2 s[8:9], s[0:1], 96
  s_lshl_b32 s33, s20, 2
  s_add_u32 s33, s33, 132032
  v_mov_b32 v104, s46
  v_mov_b32 v105, s33
  ds_write_b32 v105, v104
  v_mov_b32 v106, 0
  v_mov_b32 v107, 0
  v_mov_b32 v105, 131072
  ds_write_b64 v105, v[106:107]
  v_subrev_u32 v24, 65536, v5
  v_subrev_u32 v25, 65536, v6
  v_subrev_u32 v26, 65536, v7
  v_subrev_u32 v27, 65536, v8
  v_subrev_u32 v28, 65536, v9
  v_subrev_u32 v29, 65536, v10
  v_subrev_u32 v30, 65536, v11
  v_subrev_u32 v31, 65536, v12
  v_mov_b32 v20, v18
  v_mov_b32 v21, v19
  v_mov_b32 v22, 0
  v_mov_b32 v23, 0
  s_add_u32 m0, s26, 114688
  s_waitcnt lgkmcnt(0)
  s_barrier
  v_mov_b32 v105, 132032
  ds_read_b128 v[104:107], v105
  buffer_load_dwordx4 v13, s[12:15], s27 offen offset:0 lds
  buffer_load_dwordx4 v14, s[12:15], s27 offen offset:1024 lds
  buffer_load_dwordx4 v15, s[12:15], s27 offen offset:2048 lds
  buffer_load_dwordx4 v16, s[12:15], s27 offen offset:3072 lds
  s_add_u32 s27, s27, 4294213632
  s_mov_b32 s10, 2097152
  s_mov_b32 s11, 0x20000
  ds_read_b64_tr_b16 v[128:129], v24 offset:0
  ds_read_b64_tr_b16 v[130:131], v24 offset:4096
  ds_read_b64_tr_b16 v[132:133], v24 offset:8192
  ds_read_b64_tr_b16 v[134:135], v24 offset:12288
  ds_read_b64_tr_b16 v[136:137], v25 offset:0
  ds_read_b64_tr_b16 v[138:139], v25 offset:4096
  ds_read_b64_tr_b16 v[140:141], v25 offset:8192
  ds_read_b64_tr_b16 v[142:143], v25 offset:12288
  ds_read_b64_tr_b16 v[144:145], v26 offset:0
  ds_read_b64_tr_b16 v[146:147], v26 offset:4096
  ds_read_b64_tr_b16 v[148:149], v26 offset:8192
  ds_read_b64_tr_b16 v[150:151], v26 offset:12288
  ds_read_b64_tr_b16 v[152:153], v27 offset:0
  ds_read_b64_tr_b16 v[154:155], v27 offset:4096
  ds_read_b64_tr_b16 v[156:157], v27 offset:8192
  ds_read_b64_tr_b16 v[158:159], v27 offset:12288
  s_waitcnt lgkmcnt(15)
  v_or_b32 v104, v104, v105
  v_or3_b32 v104, v104, v106, v107
  s_nop 0
  v_readfirstlane_b32 s32, v104
  s_cmp_lg_u32 s32, 0
  s_cbranch_scc1 L_attn_redo
  s_waitcnt vmcnt(4)
  buffer_store_dwordx2 v[18:19], v55, s[16:19], s44 offen
  v_xor_b32 v59, s29, v56
  v_bitop3_b32 v59, v59, v57, s29 bitop3:0xf9
  v_cmp_eq_u32 vcc, 0, v59
  s_mov_b32 s36, 0
  s_cmp_eq_u64 vcc, exec
  s_cbranch_scc0 L_g_w
L_g_b0:
  s_add_u32 s52, s55, 0
  buffer_load_dwordx4 a[0:3], v0, s[16:19], s52 offen offset:0 sc1
  buffer_load_dwordx4 a[4:7], v0, s[16:19], s52 offen offset:1024 sc1
  s_add_u32 s52, s55, 16384
  buffer_load_dwordx4 a[8:11], v0, s[16:19], s52 offen offset:0 sc1
  buffer_load_dwordx4 a[12:15], v0, s[16:19], s52 offen offset:1024 sc1
  s_add_u32 s52, s55, 32768
  buffer_load_dwordx4 a[16:19], v0, s[16:19], s52 offen offset:0 sc1
  buffer_load_dwordx4 a[20:23], v0, s[16:19], s52 offen offset:1024 sc1
  s_add_u32 s52, s55, 49152
  buffer_load_dwordx4 a[24:27], v0, s[16:19], s52 offen offset:0 sc1
  buffer_load_dwordx4 a[28:31], v0, s[16:19], s52 offen offset:1024 sc1
  s_add_u32 s52, s55, 65536
  buffer_load_dwordx4 a[32:35], v0, s[16:19], s52 offen offset:0 sc1
  buffer_load_dwordx4 a[36:39], v0, s[16:19], s52 offen offset:1024 sc1
  s_add_u32 s52, s55, 81920
  buffer_load_dwordx4 a[40:43], v0, s[16:19], s52 offen offset:0 sc1
  buffer_load_dwordx4 a[44:47], v0, s[16:19], s52 offen offset:1024 sc1
  s_add_u32 s52, s55, 98304
  buffer_load_dwordx4 a[48:51], v0, s[16:19], s52 offen offset:0 sc1
  buffer_load_dwordx4 a[52:55], v0, s[16:19], s52 offen offset:1024 sc1
  s_add_u32 s52, s55, 114688
  buffer_load_dwordx4 a[56:59], v0, s[16:19], s52 offen offset:0 sc1
  buffer_load_dwordx4 a[60:63], v0, s[16:19], s52 offen offset:1024 sc1
  s_waitcnt vmcnt(15) lgkmcnt(14)
  v_mfma_f32_16x16x32_bf16 v[64:67], v[128:131], a[0:3], 0
  s_waitcnt vmcnt(13) lgkmcnt(12)
  ds_read_b64_tr_b16 v[160:161], v28 offset:0
  v_mfma_f32_16x16x32_bf16 v[64:67], v[132:135], a[8:11], v[64:67]
  ds_read_b64_tr_b16 v[162:163], v28 offset:4096
  v_mfma_f32_16x16x32_bf16 v[68:71], v[128:131], a[4:7], 0
  s_waitcnt vmcnt(12)
  buffer_load_dwordx2 v[56:57], v58, s[16:19], s45 offen sc1
  v_mfma_f32_16x16x32_bf16 v[68:71], v[132:135], a[12:15], v[68:71]
  s_waitcnt lgkmcnt(12)
  ds_read_b64_tr_b16 v[164:165], v28 offset:8192
  ds_read_b64_tr_b16 v[166:167], v28 offset:12288
  v_mfma_f32_16x16x32_bf16 v[76:79], v[136:139], a[4:7], 0
  s_waitcnt lgkmcnt(12)
  ds_read_b64_tr_b16 v[168:169], v29 offset:0
  v_mfma_f32_16x16x32_bf16 v[76:79], v[140:143], a[12:15], v[76:79]
  ds_read_b64_tr_b16 v[170:171], v29 offset:4096
  v_mfma_f32_16x16x32_bf16 v[72:75], v[136:139], a[0:3], 0
  buffer_store_dwordx4 v[20:23], v17, s[16:19], s53 offen sc1
  v_mfma_f32_16x16x32_bf16 v[72:75], v[140:143], a[8:11], v[72:75]
  s_waitcnt lgkmcnt(12)
  ds_read_b64_tr_b16 v[172:173], v29 offset:8192
  ds_read_b64_tr_b16 v[174:175], v29 offset:12288
  v_mfma_f32_16x16x32_bf16 v[80:83], v[144:147], a[0:3], 0
  s_waitcnt lgkmcnt(12)
  ds_read_b64_tr_b16 v[176:177], v30 offset:0
  v_mfma_f32_16x16x32_bf16 v[80:83], v[148:151], a[8:11], v[80:83]
  ds_read_b64_tr_b16 v[178:179], v30 offset:4096
  v_mfma_f32_16x16x32_bf16 v[84:87], v[144:147], a[4:7], 0
  v_mfma_f32_16x16x32_bf16 v[84:87], v[148:151], a[12:15], v[84:87]
  s_waitcnt lgkmcnt(12)
  ds_read_b64_tr_b16 v[180:181], v30 offset:8192
  ds_read_b64_tr_b16 v[182:183], v30 offset:12288
  v_mfma_f32_16x16x32_bf16 v[92:95], v[152:155], a[4:7], 0
  s_waitcnt lgkmcnt(12)
  ds_read_b64_tr_b16 v[184:185], v31 offset:0
  v_mfma_f32_16x16x32_bf16 v[92:95], v[156:159], a[12:15], v[92:95]
  ds_read_b64_tr_b16 v[186:187], v31 offset:4096
  v_mfma_f32_16x16x32_bf16 v[88:91], v[152:155], a[0:3], 0
  v_mfma_f32_16x16x32_bf16 v[88:91], v[156:159], a[8:11], v[88:91]
  s_waitcnt lgkmcnt(12)
  ds_read_b64_tr_b16 v[188:189], v31 offset:8192
  ds_read_b64_tr_b16 v[190:191], v31 offset:12288
  v_mfma_f32_16x16x32_bf16 v[96:99], v[160:163], a[0:3], 0
  s_waitcnt lgkmcnt(12)
  ds_read_b64_tr_b16 v[128:129], v24 offset:16384
  v_mfma_f32_16x16x32_bf16 v[96:99], v[164:167], a[8:11], v[96:99]
  ds_read_b64_tr_b16 v[130:131], v24 offset:20480
  v_mfma_f32_16x16x32_bf16 v[100:103], v[160:163], a[4:7], 0
  v_mfma_f32_16x16x32_bf16 v[100:103], v[164:167], a[12:15], v[100:103]
  s_waitcnt lgkmcnt(12)
  ds_read_b64_tr_b16 v[132:133], v24 offset:24576
  ds_read_b64_tr_b16 v[134:135], v24 offset:28672
  v_mfma_f32_16x16x32_bf16 v[108:111], v[168:171], a[4:7], 0
  s_waitcnt lgkmcnt(12)
  ds_read_b64_tr_b16 v[136:137], v25 offset:16384
  v_mfma_f32_16x16x32_bf16 v[108:111], v[172:175], a[12:15], v[108:111]
  ds_read_b64_tr_b16 v[138:139], v25 offset:20480
  v_mfma_f32_16x16x32_bf16 v[104:107], v[168:171], a[0:3], 0
  v_mfma_f32_16x16x32_bf16 v[104:107], v[172:175], a[8:11], v[104:107]
  s_waitcnt lgkmcnt(12)
  ds_read_b64_tr_b16 v[140:141], v25 offset:24576
  ds_read_b64_tr_b16 v[142:143], v25 offset:28672
  v_mfma_f32_16x16x32_bf16 v[112:115], v[176:179], a[0:3], 0
  s_waitcnt lgkmcnt(12)
  ds_read_b64_tr_b16 v[144:145], v26 offset:16384
  v_mfma_f32_16x16x32_bf16 v[112:115], v[180:183], a[8:11], v[112:115]
  ds_read_b64_tr_b16 v[146:147], v26 offset:20480
  v_mfma_f32_16x16x32_bf16 v[116:119], v[176:179], a[4:7], 0
  v_mfma_f32_16x16x32_bf16 v[116:119], v[180:183], a[12:15], v[116:119]
  s_waitcnt vmcnt(1) lgkmcnt(12)
  ds_read_b64_tr_b16 v[148:149], v26 offset:24576
  ds_read_b64_tr_b16 v[150:151], v26 offset:28672
  v_xor_b32 v59, s29, v56
  v_mfma_f32_16x16x32_bf16 v[124:127], v[184:187], a[4:7], 0
  s_waitcnt lgkmcnt(12)
  ds_read_b64_tr_b16 v[152:153], v27 offset:16384
  v_bitop3_b32 v59, v59, v57, s29 bitop3:0xf9
  v_mfma_f32_16x16x32_bf16 v[124:127], v[188:191], a[12:15], v[124:127]
  ds_read_b64_tr_b16 v[154:155], v27 offset:20480
  v_cmp_eq_u32 vcc, 0, v59
  v_mfma_f32_16x16x32_bf16 v[120:123], v[184:187], a[0:3], 0
  s_mov_b32 s36, 1
  s_cmp_eq_u64 vcc, exec
  s_cbranch_scc0 L_g_w
L_g_b1:
  s_add_u32 s52, s55, 4096
  buffer_load_dwordx4 a[64:67], v0, s[16:19], s52 offen offset:0 sc1
  v_mfma_f32_16x16x32_bf16 v[120:123], v[188:191], a[8:11], v[120:123]
  s_waitcnt lgkmcnt(12)
  ds_read_b64_tr_b16 v[156:157], v27 offset:24576
  ds_read_b64_tr_b16 v[158:159], v27 offset:28672
  v_mfma_f32_16x16x32_bf16 v[64:67], v[128:131], a[16:19], v[64:67]
  s_waitcnt lgkmcnt(12)
  ds_read_b64_tr_b16 v[160:161], v28 offset:16384
  v_mfma_f32_16x16x32_bf16 v[64:67], v[132:135], a[24:27], v[64:67]
  ds_read_b64_tr_b16 v[162:163], v28 offset:20480
  v_mfma_f32_16x16x32_bf16 v[68:71], v[128:131], a[20:23], v[68:71]
  buffer_load_dwordx4 a[68:71], v0, s[16:19], s52 offen offset:1024 sc1
  v_mfma_f32_16x16x32_bf16 v[68:71], v[132:135], a[28:31], v[68:71]
  s_waitcnt lgkmcnt(12)
  ds_read_b64_tr_b16 v[164:165], v28 offset:24576
  ds_read_b64_tr_b16 v[166:167], v28 offset:28672
  v_mfma_f32_16x16x32_bf16 v[76:79], v[136:139], a[20:23], v[76:79]
  s_waitcnt lgkmcnt(12)
  ds_read_b64_tr_b16 v[168:169], v29 offset:16384
  v_mfma_f32_16x16x32_bf16 v[76:79], v[140:143], a[28:31], v[76:79]
  ds_read_b64_tr_b16 v[170:171], v29 offset:20480
  v_mfma_f32_16x16x32_bf16 v[72:75], v[136:139], a[16:19], v[72:75]
  s_add_u32 s52, s55, 20480
  buffer_load_dwordx4 a[72:75], v0, s[16:19], s52 offen offset:0 sc1
  v_mfma_f32_16x16x32_bf16 v[72:75], v[140:143], a[24:27], v[72:75]
  s_waitcnt lgkmcnt(12)
  ds_read_b64_tr_b16 v[172:173], v29 offset:24576
  ds_read_b64_tr_b16 v[174:175], v29 offset:28672
  v_mfma_f32_16x16x32_bf16 v[80:83], v[144:147], a[16:19], v[80:83]
  s_waitcnt lgkmcnt(12)
  ds_read_b64_tr_b16 v[176:177], v30 offset:16384
  v_mfma_f32_16x16x32_bf16 v[80:83], v[148:151], a[24:27], v[80:83]
  ds_read_b64_tr_b16 v[178:179], v30 offset:20480
  v_mfma_f32_16x16x32_bf16 v[84:87], v[144:147], a[20:23], v[84:87]
  buffer_load_dwordx4 a[76:79], v0, s[16:19], s52 offen offset:1024 sc1
  v_mfma_f32_16x16x32_bf16 v[84:87], v[148:151], a[28:31], v[84:87]
  s_waitcnt lgkmcnt(12)
  ds_read_b64_tr_b16 v[180:181], v30 offset:24576
  ds_read_b64_tr_b16 v[182:183], v30 offset:28672
  v_mfma_f32_16x16x32_bf16 v[92:95], v[152:155], a[20:23], v[92:95]
  s_waitcnt lgkmcnt(12)
  ds_read_b64_tr_b16 v[184:185], v31 offset:16384
  v_mfma_f32_16x16x32_bf16 v[92:95], v[156:159], a[28:31], v[92:95]
  ds_read_b64_tr_b16 v[186:187], v31 offset:20480
  v_mfma_f32_16x16x32_bf16 v[88:91], v[152:155], a[16:19], v[88:91]
  s_add_u32 s52, s55, 36864
  buffer_load_dwordx4 a[80:83], v0, s[16:19], s52 offen offset:0 sc1
  v_mfma_f32_16x16x32_bf16 v[88:91], v[156:159], a[24:27], v[88:91]
  s_waitcnt lgkmcnt(12)
  ds_read_b64_tr_b16 v[188:189], v31 offset:24576
  ds_read_b64_tr_b16 v[190:191], v31 offset:28672
  v_mfma_f32_16x16x32_bf16 v[96:99], v[160:163], a[16:19], v[96:99]
  s_waitcnt lgkmcnt(12)
  ds_read_b64_tr_b16 v[128:129], v5 offset:0
  v_mfma_f32_16x16x32_bf16 v[96:99], v[164:167], a[24:27], v[96:99]
  ds_read_b64_tr_b16 v[130:131], v5 offset:4096
  v_mfma_f32_16x16x32_bf16 v[100:103], v[160:163], a[20:23], v[100:103]
  buffer_load_dwordx4 a[84:87], v0, s[16:19], s52 offen offset:1024 sc1
  v_mfma_f32_16x16x32_bf16 v[100:103], v[164:167], a[28:31], v[100:103]
  s_waitcnt lgkmcnt(12)
  ds_read_b64_tr_b16 v[132:133], v5 offset:8192
  ds_read_b64_tr_b16 v[134:135], v5 offset:12288
  v_mfma_f32_16x16x32_bf16 v[108:111], v[168:171], a[20:23], v[108:111]
  s_waitcnt lgkmcnt(12)
  ds_read_b64_tr_b16 v[136:137], v6 offset:0
  v_mfma_f32_16x16x32_bf16 v[108:111], v[172:175], a[28:31], v[108:111]
  ds_read_b64_tr_b16 v[138:139], v6 offset:4096
  v_mfma_f32_16x16x32_bf16 v[104:107], v[168:171], a[16:19], v[104:107]
  s_add_u32 s52, s55, 53248
  buffer_load_dwordx4 a[88:91], v0, s[16:19], s52 offen offset:0 sc1
  v_mfma_f32_16x16x32_bf16 v[104:107], v[172:175], a[24:27], v[104:107]
  s_waitcnt lgkmcnt(12)
  ds_read_b64_tr_b16 v[140:141], v6 offset:8192
  ds_read_b64_tr_b16 v[142:143], v6 offset:12288
  v_mfma_f32_16x16x32_bf16 v[112:115], v[176:179], a[16:19], v[112:115]
  s_waitcnt lgkmcnt(12)
  ds_read_b64_tr_b16 v[144:145], v7 offset:0
  v_mfma_f32_16x16x32_bf16 v[112:115], v[180:183], a[24:27], v[112:115]
  ds_read_b64_tr_b16 v[146:147], v7 offset:4096
  v_mfma_f32_16x16x32_bf16 v[116:119], v[176:179], a[20:23], v[116:119]
  buffer_load_dwordx4 a[92:95], v0, s[16:19], s52 offen offset:1024 sc1
  v_mfma_f32_16x16x32_bf16 v[116:119], v[180:183], a[28:31], v[116:119]
  s_waitcnt lgkmcnt(12)
  ds_read_b64_tr_b16 v[148:149], v7 offset:8192
  ds_read_b64_tr_b16 v[150:151], v7 offset:12288
  v_mfma_f32_16x16x32_bf16 v[124:127], v[184:187], a[20:23], v[124:127]
  s_waitcnt lgkmcnt(12)
  ds_read_b64_tr_b16 v[152:153], v8 offset:0
  v_mfma_f32_16x16x32_bf16 v[124:127], v[188:191], a[28:31], v[124:127]
  ds_read_b64_tr_b16 v[154:155], v8 offset:4096
  v_mfma_f32_16x16x32_bf16 v[120:123], v[184:187], a[16:19], v[120:123]
  s_add_u32 s52, s55, 69632
  buffer_load_dwordx4 a[96:99], v0, s[16:19], s52 offen offset:0 sc1
  v_mfma_f32_16x16x32_bf16 v[120:123], v[188:191], a[24:27], v[120:123]
  s_waitcnt lgkmcnt(12)
  s_barrier
  ds_read_b64_tr_b16 v[156:157], v8 offset:8192
  ds_read_b64_tr_b16 v[158:159], v8 offset:12288
  v_mfma_f32_16x16x32_bf16 v[64:67], v[128:131], a[32:35], v[64:67]
  s_waitcnt lgkmcnt(12)
  ds_read_b64_tr_b16 v[160:161], v9 offset:0
  v_mfma_f32_16x16x32_bf16 v[64:67], v[132:135], a[40:43], v[64:67]
  s_add_u32 m0, s26, 0
  ds_read_b64_tr_b16 v[162:163], v9 offset:4096
  v_mfma_f32_16x16x32_bf16 v[68:71], v[128:131], a[36:39], v[68:71]
  buffer_load_dwordx4 v13, s[12:15], s27 offen offset:0 lds
  v_mfma_f32_16x16x32_bf16 v[68:71], v[132:135], a[44:47], v[68:71]
  s_waitcnt lgkmcnt(12)
  ds_read_b64_tr_b16 v[164:165], v9 offset:8192
  ds_read_b64_tr_b16 v[166:167], v9 offset:12288
  v_mfma_f32_16x16x32_bf16 v[76:79], v[136:139], a[36:39], v[76:79]
  s_waitcnt lgkmcnt(12)
  ds_read_b64_tr_b16 v[168:169], v10 offset:0
  v_mfma_f32_16x16x32_bf16 v[76:79], v[140:143], a[44:47], v[76:79]
  ds_read_b64_tr_b16 v[170:171], v10 offset:4096
  v_mfma_f32_16x16x32_bf16 v[72:75], v[136:139], a[32:35], v[72:75]
  buffer_load_dwordx4 v14, s[12:15], s27 offen offset:1024 lds
  v_mfma_f32_16x16x32_bf16 v[72:75], v[140:143], a[40:43], v[72:75]
  s_waitcnt lgkmcnt(12)
  ds_read_b64_tr_b16 v[172:173], v10 offset:8192
  ds_read_b64_tr_b16 v[174:175], v10 offset:12288
  v_mfma_f32_16x16x32_bf16 v[80:83], v[144:147], a[32:35], v[80:83]
  s_waitcnt lgkmcnt(12)
  ds_read_b64_tr_b16 v[176:177], v11 offset:0
  v_mfma_f32_16x16x32_bf16 v[80:83], v[148:151], a[40:43], v[80:83]
  ds_read_b64_tr_b16 v[178:179], v11 offset:4096
  v_mfma_f32_16x16x32_bf16 v[84:87], v[144:147], a[36:39], v[84:87]
  buffer_load_dwordx4 v15, s[12:15], s27 offen offset:2048 lds
  v_mfma_f32_16x16x32_bf16 v[84:87], v[148:151], a[44:47], v[84:87]
  s_waitcnt lgkmcnt(12)
  ds_read_b64_tr_b16 v[180:181], v11 offset:8192
  ds_read_b64_tr_b16 v[182:183], v11 offset:12288
  v_mfma_f32_16x16x32_bf16 v[92:95], v[152:155], a[36:39], v[92:95]
  s_waitcnt lgkmcnt(12)
  ds_read_b64_tr_b16 v[184:185], v12 offset:0
  v_mfma_f32_16x16x32_bf16 v[92:95], v[156:159], a[44:47], v[92:95]
  ds_read_b64_tr_b16 v[186:187], v12 offset:4096
  v_mfma_f32_16x16x32_bf16 v[88:91], v[152:155], a[32:35], v[88:91]
  buffer_load_dwordx4 v16, s[12:15], s27 offen offset:3072 lds
  v_mfma_f32_16x16x32_bf16 v[88:91], v[156:159], a[40:43], v[88:91]
  s_waitcnt lgkmcnt(12)
  s_add_u32 s27, s27, 262144
  ds_read_b64_tr_b16 v[188:189], v12 offset:8192
  ds_read_b64_tr_b16 v[190:191], v12 offset:12288
  v_mfma_f32_16x16x32_bf16 v[96:99], v[160:163], a[32:35], v[96:99]
  s_waitcnt lgkmcnt(12)
  ds_read_b64_tr_b16 v[128:129], v24 offset:32768
  v_mfma_f32_16x16x32_bf16 v[96:99], v[164:167], a[40:43], v[96:99]
  ds_read_b64_tr_b16 v[130:131], v24 offset:36864
  v_mfma_f32_16x16x32_bf16 v[100:103], v[160:163], a[36:39], v[100:103]
  buffer_load_dwordx4 a[100:103], v0, s[16:19], s52 offen offset:1024 sc1
  v_mfma_f32_16x16x32_bf16 v[100:103], v[164:167], a[44:47], v[100:103]
  s_waitcnt lgkmcnt(12)
  ds_read_b64_tr_b16 v[132:133], v24 offset:40960
  ds_read_b64_tr_b16 v[134:135], v24 offset:45056
  v_mfma_f32_16x16x32_bf16 v[108:111], v[168:171], a[36:39], v[108:111]
  s_waitcnt lgkmcnt(12)
  ds_read_b64_tr_b16 v[136:137], v25 offset:32768
  v_mfma_f32_16x16x32_bf16 v[108:111], v[172:175], a[44:47], v[108:111]
  ds_read_b64_tr_b16 v[138:139], v25 offset:36864
  v_mfma_f32_16x16x32_bf16 v[104:107], v[168:171], a[32:35], v[104:107]
  s_add_u32 s52, s55, 86016
  buffer_load_dwordx4 a[104:107], v0, s[16:19], s52 offen offset:0 sc1
  v_mfma_f32_16x16x32_bf16 v[104:107], v[172:175], a[40:43], v[104:107]
  s_waitcnt lgkmcnt(12)
  ds_read_b64_tr_b16 v[140:141], v25 offset:40960
  ds_read_b64_tr_b16 v[142:143], v25 offset:45056
  v_mfma_f32_16x16x32_bf16 v[112:115], v[176:179], a[32:35], v[112:115]
  s_waitcnt lgkmcnt(12)
  ds_read_b64_tr_b16 v[144:145], v26 offset:32768
  v_mfma_f32_16x16x32_bf16 v[112:115], v[180:183], a[40:43], v[112:115]
  ds_read_b64_tr_b16 v[146:147], v26 offset:36864
  v_mfma_f32_16x16x32_bf16 v[116:119], v[176:179], a[36:39], v[116:119]
  buffer_load_dwordx4 a[108:111], v0, s[16:19], s52 offen offset:1024 sc1
  v_mfma_f32_16x16x32_bf16 v[116:119], v[180:183], a[44:47], v[116:119]
  s_waitcnt lgkmcnt(12)
  ds_read_b64_tr_b16 v[148:149], v26 offset:40960
  ds_read_b64_tr_b16 v[150:151], v26 offset:45056
  v_mfma_f32_16x16x32_bf16 v[124:127], v[184:187], a[36:39], v[124:127]
  s_waitcnt lgkmcnt(12)
  ds_read_b64_tr_b16 v[152:153], v27 offset:32768
  v_mfma_f32_16x16x32_bf16 v[124:127], v[188:191], a[44:47], v[124:127]
  s_add_u32 m0, s26, 16384
  ds_read_b64_tr_b16 v[154:155], v27 offset:36864
  v_mfma_f32_16x16x32_bf16 v[120:123], v[184:187], a[32:35], v[120:123]
  buffer_load_dwordx4 v13, s[12:15], s27 offen offset:0 lds
  v_mfma_f32_16x16x32_bf16 v[120:123], v[188:191], a[40:43], v[120:123]
  s_waitcnt lgkmcnt(12)
  ds_read_b64_tr_b16 v[156:157], v27 offset:40960
  ds_read_b64_tr_b16 v[158:159], v27 offset:45056
  v_mfma_f32_16x16x32_bf16 v[64:67], v[128:131], a[48:51], v[64:67]
  s_waitcnt lgkmcnt(12)
  ds_read_b64_tr_b16 v[160:161], v28 offset:32768
  v_mfma_f32_16x16x32_bf16 v[64:67], v[132:135], a[56:59], v[64:67]
  ds_read_b64_tr_b16 v[162:163], v28 offset:36864
  v_mfma_f32_16x16x32_bf16 v[68:71], v[128:131], a[52:55], v[68:71]
  buffer_load_dwordx4 v14, s[12:15], s27 offen offset:1024 lds
  v_mfma_f32_16x16x32_bf16 v[68:71], v[132:135], a[60:63], v[68:71]
  s_waitcnt lgkmcnt(12)
  ds_read_b64_tr_b16 v[164:165], v28 offset:40960
  ds_read_b64_tr_b16 v[166:167], v28 offset:45056
  v_mfma_f32_16x16x32_bf16 v[76:79], v[136:139], a[52:55], v[76:79]
  s_waitcnt lgkmcnt(12)
  ds_read_b64_tr_b16 v[168:169], v29 offset:32768
  v_mfma_f32_16x16x32_bf16 v[76:79], v[140:143], a[60:63], v[76:79]
  ds_read_b64_tr_b16 v[170:171], v29 offset:36864
  v_mfma_f32_16x16x32_bf16 v[72:75], v[136:139], a[48:51], v[72:75]
  buffer_load_dwordx4 v15, s[12:15], s27 offen offset:2048 lds
  v_mfma_f32_16x16x32_bf16 v[72:75], v[140:143], a[56:59], v[72:75]
  s_waitcnt lgkmcnt(12)
  ds_read_b64_tr_b16 v[172:173], v29 offset:40960
  ds_read_b64_tr_b16 v[174:175], v29 offset:45056
  v_mfma_f32_16x16x32_bf16 v[80:83], v[144:147], a[48:51], v[80:83]
  s_waitcnt lgkmcnt(12)
  ds_read_b64_tr_b16 v[176:177], v30 offset:32768
  v_mfma_f32_16x16x32_bf16 v[80:83], v[148:151], a[56:59], v[80:83]
  ds_read_b64_tr_b16 v[178:179], v30 offset:36864
  v_mfma_f32_16x16x32_bf16 v[84:87], v[144:147], a[52:55], v[84:87]
  buffer_load_dwordx4 v16, s[12:15], s27 offen offset:3072 lds
  v_mfma_f32_16x16x32_bf16 v[84:87], v[148:151], a[60:63], v[84:87]
  s_waitcnt lgkmcnt(12)
  s_add_u32 s27, s27, 262144
  ds_read_b64_tr_b16 v[180:181], v30 offset:40960
  ds_read_b64_tr_b16 v[182:183], v30 offset:45056
  v_mfma_f32_16x16x32_bf16 v[92:95], v[152:155], a[52:55], v[92:95]
  s_waitcnt lgkmcnt(12)
  ds_read_b64_tr_b16 v[184:185], v31 offset:32768
  v_mfma_f32_16x16x32_bf16 v[92:95], v[156:159], a[60:63], v[92:95]
  ds_read_b64_tr_b16 v[186:187], v31 offset:36864
  v_mfma_f32_16x16x32_bf16 v[88:91], v[152:155], a[48:51], v[88:91]
  s_add_u32 s52, s55, 102400
  buffer_load_dwordx4 a[112:115], v0, s[16:19], s52 offen offset:0 sc1
  v_mfma_f32_16x16x32_bf16 v[88:91], v[156:159], a[56:59], v[88:91]
  s_waitcnt lgkmcnt(12)
  ds_read_b64_tr_b16 v[188:189], v31 offset:40960
  ds_read_b64_tr_b16 v[190:191], v31 offset:45056
  v_mfma_f32_16x16x32_bf16 v[96:99], v[160:163], a[48:51], v[96:99]
  s_waitcnt lgkmcnt(12)
  ds_read_b64_tr_b16 v[128:129], v5 offset:16384
  v_mfma_f32_16x16x32_bf16 v[96:99], v[164:167], a[56:59], v[96:99]
  ds_read_b64_tr_b16 v[130:131], v5 offset:20480
  v_mfma_f32_16x16x32_bf16 v[100:103], v[160:163], a[52:55], v[100:103]
  buffer_load_dwordx4 a[116:119], v0, s[16:19], s52 offen offset:1024 sc1
  v_mfma_f32_16x16x32_bf16 v[100:103], v[164:167], a[60:63], v[100:103]
  s_waitcnt lgkmcnt(12)
  ds_read_b64_tr_b16 v[132:133], v5 offset:24576
  ds_read_b64_tr_b16 v[134:135], v5 offset:28672
  v_mfma_f32_16x16x32_bf16 v[108:111], v[168:171], a[52:55], v[108:111]
  s_waitcnt lgkmcnt(12)
  ds_read_b64_tr_b16 v[136:137], v6 offset:16384
  v_mfma_f32_16x16x32_bf16 v[108:111], v[172:175], a[60:63], v[108:111]
  ds_read_b64_tr_b16 v[138:139], v6 offset:20480
  v_mfma_f32_16x16x32_bf16 v[104:107], v[168:171], a[48:51], v[104:107]
  s_add_u32 s52, s55, 118784
  buffer_load_dwordx4 a[120:123], v0, s[16:19], s52 offen offset:0 sc1
  v_mfma_f32_16x16x32_bf16 v[104:107], v[172:175], a[56:59], v[104:107]
  s_waitcnt lgkmcnt(12)
  ds_read_b64_tr_b16 v[140:141], v6 offset:24576
  ds_read_b64_tr_b16 v[142:143], v6 offset:28672
  v_mfma_f32_16x16x32_bf16 v[112:115], v[176:179], a[48:51], v[112:115]
  s_waitcnt lgkmcnt(12)
  ds_read_b64_tr_b16 v[144:145], v7 offset:16384
  v_mfma_f32_16x16x32_bf16 v[112:115], v[180:183], a[56:59], v[112:115]
  ds_read_b64_tr_b16 v[146:147], v7 offset:20480
  v_mfma_f32_16x16x32_bf16 v[116:119], v[176:179], a[52:55], v[116:119]
  buffer_load_dwordx4 a[124:127], v0, s[16:19], s52 offen offset:1024 sc1
  v_mfma_f32_16x16x32_bf16 v[116:119], v[180:183], a[60:63], v[116:119]
  s_waitcnt lgkmcnt(12)
  ds_read_b64_tr_b16 v[148:149], v7 offset:24576
  ds_read_b64_tr_b16 v[150:151], v7 offset:28672
  v_mfma_f32_16x16x32_bf16 v[124:127], v[184:187], a[52:55], v[124:127]
  s_waitcnt lgkmcnt(12)
  ds_read_b64_tr_b16 v[152:153], v8 offset:16384
  v_mfma_f32_16x16x32_bf16 v[124:127], v[188:191], a[60:63], v[124:127]
  ds_read_b64_tr_b16 v[154:155], v8 offset:20480
  v_mfma_f32_16x16x32_bf16 v[120:123], v[184:187], a[48:51], v[120:123]
  s_add_u32 s52, s55, 8192
  buffer_load_dwordx4 a[128:131], v0, s[16:19], s52 offen offset:0 sc1
  v_mfma_f32_16x16x32_bf16 v[120:123], v[188:191], a[56:59], v[120:123]
  s_waitcnt vmcnt(24) lgkmcnt(12)
  s_barrier
  ds_read_b64_tr_b16 v[156:157], v8 offset:24576
  ds_read_b64_tr_b16 v[158:159], v8 offset:28672
  v_mfma_f32_16x16x32_bf16 v[64:67], v[128:131], a[64:67], v[64:67]
  s_waitcnt vmcnt(22) lgkmcnt(12)
  ds_read_b64_tr_b16 v[160:161], v9 offset:16384
  v_mfma_f32_16x16x32_bf16 v[64:67], v[132:135], a[72:75], v[64:67]
  s_add_u32 m0, s26, 65536
  ds_read_b64_tr_b16 v[162:163], v9 offset:20480
  v_mfma_f32_16x16x32_bf16 v[68:71], v[128:131], a[68:71], v[68:71]
  s_waitcnt vmcnt(21)
  buffer_load_dwordx4 v13, s[12:15], s27 offen offset:0 lds
  v_mfma_f32_16x16x32_bf16 v[68:71], v[132:135], a[76:79], v[68:71]
  s_waitcnt lgkmcnt(12)
  ds_read_b64_tr_b16 v[164:165], v9 offset:24576
  ds_read_b64_tr_b16 v[166:167], v9 offset:28672
  v_mfma_f32_16x16x32_bf16 v[76:79], v[136:139], a[68:71], v[76:79]
  s_waitcnt lgkmcnt(12)
  ds_read_b64_tr_b16 v[168:169], v10 offset:16384
  v_mfma_f32_16x16x32_bf16 v[76:79], v[140:143], a[76:79], v[76:79]
  ds_read_b64_tr_b16 v[170:171], v10 offset:20480
  v_mfma_f32_16x16x32_bf16 v[72:75], v[136:139], a[64:67], v[72:75]
  buffer_load_dwordx4 v14, s[12:15], s27 offen offset:1024 lds
  v_mfma_f32_16x16x32_bf16 v[72:75], v[140:143], a[72:75], v[72:75]
  s_waitcnt lgkmcnt(12)
  ds_read_b64_tr_b16 v[172:173], v10 offset:24576
  ds_read_b64_tr_b16 v[174:175], v10 offset:28672
  v_mfma_f32_16x16x32_bf16 v[80:83], v[144:147], a[64:67], v[80:83]
  s_waitcnt lgkmcnt(12)
  ds_read_b64_tr_b16 v[176:177], v11 offset:16384
  v_mfma_f32_16x16x32_bf16 v[80:83], v[148:151], a[72:75], v[80:83]
  ds_read_b64_tr_b16 v[178:179], v11 offset:20480
  v_mfma_f32_16x16x32_bf16 v[84:87], v[144:147], a[68:71], v[84:87]
  buffer_load_dwordx4 v15, s[12:15], s27 offen offset:2048 lds
  v_mfma_f32_16x16x32_bf16 v[84:87], v[148:151], a[76:79], v[84:87]
  s_waitcnt lgkmcnt(12)
  ds_read_b64_tr_b16 v[180:181], v11 offset:24576
  ds_read_b64_tr_b16 v[182:183], v11 offset:28672
  v_mfma_f32_16x16x32_bf16 v[92:95], v[152:155], a[68:71], v[92:95]
  s_waitcnt lgkmcnt(12)
  ds_read_b64_tr_b16 v[184:185], v12 offset:16384
  v_mfma_f32_16x16x32_bf16 v[92:95], v[156:159], a[76:79], v[92:95]
  ds_read_b64_tr_b16 v[186:187], v12 offset:20480
  v_mfma_f32_16x16x32_bf16 v[88:91], v[152:155], a[64:67], v[88:91]
  buffer_load_dwordx4 v16, s[12:15], s27 offen offset:3072 lds
  v_mfma_f32_16x16x32_bf16 v[88:91], v[156:159], a[72:75], v[88:91]
  s_waitcnt lgkmcnt(12)
  s_add_u32 s27, s27, 262144
  ds_read_b64_tr_b16 v[188:189], v12 offset:24576
  ds_read_b64_tr_b16 v[190:191], v12 offset:28672
  v_mfma_f32_16x16x32_bf16 v[96:99], v[160:163], a[64:67], v[96:99]
  s_waitcnt lgkmcnt(12)
  ds_read_b64_tr_b16 v[128:129], v24 offset:49152
  v_mfma_f32_16x16x32_bf16 v[96:99], v[164:167], a[72:75], v[96:99]
  s_add_u32 m0, s26, 32768
  ds_read_b64_tr_b16 v[130:131], v24 offset:53248
  v_mfma_f32_16x16x32_bf16 v[100:103], v[160:163], a[68:71], v[100:103]
  buffer_load_dwordx4 v13, s[12:15], s27 offen offset:0 lds
  v_mfma_f32_16x16x32_bf16 v[100:103], v[164:167], a[76:79], v[100:103]
  s_waitcnt lgkmcnt(12)
  ds_read_b64_tr_b16 v[132:133], v24 offset:57344
  ds_read_b64_tr_b16 v[134:135], v24 offset:61440
  v_mfma_f32_16x16x32_bf16 v[108:111], v[168:171], a[68:71], v[108:111]
  s_waitcnt lgkmcnt(12)
  ds_read_b64_tr_b16 v[136:137], v25 offset:49152
  v_mfma_f32_16x16x32_bf16 v[108:111], v[172:175], a[76:79], v[108:111]
  ds_read_b64_tr_b16 v[138:139], v25 offset:53248
  v_mfma_f32_16x16x32_bf16 v[104:107], v[168:171], a[64:67], v[104:107]
  buffer_load_dwordx4 v14, s[12:15], s27 offen offset:1024 lds
  v_mfma_f32_16x16x32_bf16 v[104:107], v[172:175], a[72:75], v[104:107]
  s_waitcnt lgkmcnt(12)
  ds_read_b64_tr_b16 v[140:141], v25 offset:57344
  ds_read_b64_tr_b16 v[142:143], v25 offset:61440
  v_mfma_f32_16x16x32_bf16 v[112:115], v[176:179], a[64:67], v[112:115]
  s_waitcnt lgkmcnt(12)
  ds_read_b64_tr_b16 v[144:145], v26 offset:49152
  v_mfma_f32_16x16x32_bf16 v[112:115], v[180:183], a[72:75], v[112:115]
  ds_read_b64_tr_b16 v[146:147], v26 offset:53248
  v_mfma_f32_16x16x32_bf16 v[116:119], v[176:179], a[68:71], v[116:119]
  buffer_load_dwordx4 v15, s[12:15], s27 offen offset:2048 lds
  v_mfma_f32_16x16x32_bf16 v[116:119], v[180:183], a[76:79], v[116:119]
  s_waitcnt lgkmcnt(12)
  ds_read_b64_tr_b16 v[148:149], v26 offset:57344
  ds_read_b64_tr_b16 v[150:151], v26 offset:61440
  v_mfma_f32_16x16x32_bf16 v[124:127], v[184:187], a[68:71], v[124:127]
  s_waitcnt lgkmcnt(12)
  ds_read_b64_tr_b16 v[152:153], v27 offset:49152
  v_mfma_f32_16x16x32_bf16 v[124:127], v[188:191], a[76:79], v[124:127]
  ds_read_b64_tr_b16 v[154:155], v27 offset:53248
  v_mfma_f32_16x16x32_bf16 v[120:123], v[184:187], a[64:67], v[120:123]
  buffer_load_dwordx4 v16, s[12:15], s27 offen offset:3072 lds
  v_mfma_f32_16x16x32_bf16 v[120:123], v[188:191], a[72:75], v[120:123]
  s_waitcnt vmcnt(28) lgkmcnt(12)
  s_add_u32 s27, s27, 4294213632
  ds_read_b64_tr_b16 v[156:157], v27 offset:57344
  ds_read_b64_tr_b16 v[158:159], v27 offset:61440
  v_mfma_f32_16x16x32_bf16 v[64:67], v[128:131], a[80:83], v[64:67]
  s_waitcnt vmcnt(26) lgkmcnt(12)
  ds_read_b64_tr_b16 v[160:161], v28 offset:49152
  v_mfma_f32_16x16x32_bf16 v[64:67], v[132:135], a[88:91], v[64:67]
  ds_read_b64_tr_b16 v[162:163], v28 offset:53248
  v_mfma_f32_16x16x32_bf16 v[68:71], v[128:131], a[84:87], v[68:71]
  s_waitcnt vmcnt(25)
  buffer_load_dwordx4 a[132:135], v0, s[16:19], s52 offen offset:1024 sc1
  v_mfma_f32_16x16x32_bf16 v[68:71], v[132:135], a[92:95], v[68:71]
  s_waitcnt lgkmcnt(12)
  ds_read_b64_tr_b16 v[164:165], v28 offset:57344
  ds_read_b64_tr_b16 v[166:167], v28 offset:61440
  v_mfma_f32_16x16x32_bf16 v[76:79], v[136:139], a[84:87], v[76:79]
  s_waitcnt lgkmcnt(12)
  ds_read_b64_tr_b16 v[168:169], v29 offset:49152
  v_mfma_f32_16x16x32_bf16 v[76:79], v[140:143], a[92:95], v[76:79]
  ds_read_b64_tr_b16 v[170:171], v29 offset:53248
  v_mfma_f32_16x16x32_bf16 v[72:75], v[136:139], a[80:83], v[72:75]
  s_add_u32 s52, s55, 24576
  buffer_load_dwordx4 a[136:139], v0, s[16:19], s52 offen offset:0 sc1
  v_mfma_f32_16x16x32_bf16 v[72:75], v[140:143], a[88:91], v[72:75]
  s_waitcnt lgkmcnt(12)
  ds_read_b64_tr_b16 v[172:173], v29 offset:57344
  ds_read_b64_tr_b16 v[174:175], v29 offset:61440
  v_mfma_f32_16x16x32_bf16 v[80:83], v[144:147], a[80:83], v[80:83]
  s_waitcnt lgkmcnt(12)
  ds_read_b64_tr_b16 v[176:177], v30 offset:49152
  v_mfma_f32_16x16x32_bf16 v[80:83], v[148:151], a[88:91], v[80:83]
  ds_read_b64_tr_b16 v[178:179], v30 offset:53248
  v_mfma_f32_16x16x32_bf16 v[84:87], v[144:147], a[84:87], v[84:87]
  buffer_load_dwordx4 a[140:143], v0, s[16:19], s52 offen offset:1024 sc1
  v_mfma_f32_16x16x32_bf16 v[84:87], v[148:151], a[92:95], v[84:87]
  s_waitcnt lgkmcnt(12)
  ds_read_b64_tr_b16 v[180:181], v30 offset:57344
  ds_read_b64_tr_b16 v[182:183], v30 offset:61440
  v_mfma_f32_16x16x32_bf16 v[92:95], v[152:155], a[84:87], v[92:95]
  s_waitcnt lgkmcnt(12)
  ds_read_b64_tr_b16 v[184:185], v31 offset:49152
  v_mfma_f32_16x16x32_bf16 v[92:95], v[156:159], a[92:95], v[92:95]
  ds_read_b64_tr_b16 v[186:187], v31 offset:53248
  v_mfma_f32_16x16x32_bf16 v[88:91], v[152:155], a[80:83], v[88:91]
  s_add_u32 s52, s55, 40960
  buffer_load_dwordx4 a[144:147], v0, s[16:19], s52 offen offset:0 sc1
  v_mfma_f32_16x16x32_bf16 v[88:91], v[156:159], a[88:91], v[88:91]
  s_waitcnt lgkmcnt(12)
  ds_read_b64_tr_b16 v[188:189], v31 offset:57344
  ds_read_b64_tr_b16 v[190:191], v31 offset:61440
  v_mfma_f32_16x16x32_bf16 v[96:99], v[160:163], a[80:83], v[96:99]
  s_waitcnt lgkmcnt(12)
  ds_read_b64_tr_b16 v[128:129], v5 offset:32768
  v_mfma_f32_16x16x32_bf16 v[96:99], v[164:167], a[88:91], v[96:99]
  ds_read_b64_tr_b16 v[130:131], v5 offset:36864
  v_mfma_f32_16x16x32_bf16 v[100:103], v[160:163], a[84:87], v[100:103]
  buffer_load_dwordx4 a[148:151], v0, s[16:19], s52 offen offset:1024 sc1
  v_mfma_f32_16x16x32_bf16 v[100:103], v[164:167], a[92:95], v[100:103]
  s_waitcnt lgkmcnt(12)
  ds_read_b64_tr_b16 v[132:133], v5 offset:40960
  ds_read_b64_tr_b16 v[134:135], v5 offset:45056
  v_mfma_f32_16x16x32_bf16 v[108:111], v[168:171], a[84:87], v[108:111]
  s_waitcnt lgkmcnt(12)
  ds_read_b64_tr_b16 v[136:137], v6 offset:32768
  v_mfma_f32_16x16x32_bf16 v[108:111], v[172:175], a[92:95], v[108:111]
  ds_read_b64_tr_b16 v[138:139], v6 offset:36864
  v_mfma_f32_16x16x32_bf16 v[104:107], v[168:171], a[80:83], v[104:107]
  s_add_u32 s52, s55, 57344
  buffer_load_dwordx4 a[152:155], v0, s[16:19], s52 offen offset:0 sc1
  v_mfma_f32_16x16x32_bf16 v[104:107], v[172:175], a[88:91], v[104:107]
  s_waitcnt lgkmcnt(12)
  ds_read_b64_tr_b16 v[140:141], v6 offset:40960
  ds_read_b64_tr_b16 v[142:143], v6 offset:45056
  v_mfma_f32_16x16x32_bf16 v[112:115], v[176:179], a[80:83], v[112:115]
  s_waitcnt lgkmcnt(12)
  ds_read_b64_tr_b16 v[144:145], v7 offset:32768
  v_mfma_f32_16x16x32_bf16 v[112:115], v[180:183], a[88:91], v[112:115]
  ds_read_b64_tr_b16 v[146:147], v7 offset:36864
  v_mfma_f32_16x16x32_bf16 v[116:119], v[176:179], a[84:87], v[116:119]
  buffer_load_dwordx4 a[156:159], v0, s[16:19], s52 offen offset:1024 sc1
  v_mfma_f32_16x16x32_bf16 v[116:119], v[180:183], a[92:95], v[116:119]
  s_waitcnt lgkmcnt(12)
  ds_read_b64_tr_b16 v[148:149], v7 offset:40960
  ds_read_b64_tr_b16 v[150:151], v7 offset:45056
  v_mfma_f32_16x16x32_bf16 v[124:127], v[184:187], a[84:87], v[124:127]
  s_waitcnt lgkmcnt(12)
  ds_read_b64_tr_b16 v[152:153], v8 offset:32768
  v_mfma_f32_16x16x32_bf16 v[124:127], v[188:191], a[92:95], v[124:127]
  ds_read_b64_tr_b16 v[154:155], v8 offset:36864
  v_mfma_f32_16x16x32_bf16 v[120:123], v[184:187], a[80:83], v[120:123]
  s_add_u32 s52, s55, 73728
  buffer_load_dwordx4 a[160:163], v0, s[16:19], s52 offen offset:0 sc1
  v_mfma_f32_16x16x32_bf16 v[120:123], v[188:191], a[88:91], v[120:123]
  s_waitcnt vmcnt(28) lgkmcnt(12)
  s_barrier
  ds_read_b64_tr_b16 v[156:157], v8 offset:40960
  ds_read_b64_tr_b16 v[158:159], v8 offset:45056
  v_mfma_f32_16x16x32_bf16 v[64:67], v[128:131], a[96:99], v[64:67]
  s_waitcnt vmcnt(26) lgkmcnt(12)
  ds_read_b64_tr_b16 v[160:161], v9 offset:32768
  v_mfma_f32_16x16x32_bf16 v[64:67], v[132:135], a[104:107], v[64:67]
  ds_read_b64_tr_b16 v[162:163], v9 offset:36864
  v_mfma_f32_16x16x32_bf16 v[68:71], v[128:131], a[100:103], v[68:71]
  s_waitcnt vmcnt(25)
  buffer_load_dwordx4 a[164:167], v0, s[16:19], s52 offen offset:1024 sc1
  v_mfma_f32_16x16x32_bf16 v[68:71], v[132:135], a[108:111], v[68:71]
  s_waitcnt lgkmcnt(12)
  ds_read_b64_tr_b16 v[164:165], v9 offset:40960
  ds_read_b64_tr_b16 v[166:167], v9 offset:45056
  v_mfma_f32_16x16x32_bf16 v[76:79], v[136:139], a[100:103], v[76:79]
  s_waitcnt lgkmcnt(12)
  ds_read_b64_tr_b16 v[168:169], v10 offset:32768
  v_mfma_f32_16x16x32_bf16 v[76:79], v[140:143], a[108:111], v[76:79]
  ds_read_b64_tr_b16 v[170:171], v10 offset:36864
  v_mfma_f32_16x16x32_bf16 v[72:75], v[136:139], a[96:99], v[72:75]
  s_add_u32 s52, s55, 90112
  buffer_load_dwordx4 a[168:171], v0, s[16:19], s52 offen offset:0 sc1
  v_mfma_f32_16x16x32_bf16 v[72:75], v[140:143], a[104:107], v[72:75]
  s_waitcnt lgkmcnt(12)
  ds_read_b64_tr_b16 v[172:173], v10 offset:40960
  ds_read_b64_tr_b16 v[174:175], v10 offset:45056
  v_mfma_f32_16x16x32_bf16 v[80:83], v[144:147], a[96:99], v[80:83]
  s_waitcnt lgkmcnt(12)
  ds_read_b64_tr_b16 v[176:177], v11 offset:32768
  v_mfma_f32_16x16x32_bf16 v[80:83], v[148:151], a[104:107], v[80:83]
  ds_read_b64_tr_b16 v[178:179], v11 offset:36864
  v_mfma_f32_16x16x32_bf16 v[84:87], v[144:147], a[100:103], v[84:87]
  buffer_load_dwordx4 a[172:175], v0, s[16:19], s52 offen offset:1024 sc1
  v_mfma_f32_16x16x32_bf16 v[84:87], v[148:151], a[108:111], v[84:87]
  s_waitcnt lgkmcnt(12)
  ds_read_b64_tr_b16 v[180:181], v11 offset:40960
  ds_read_b64_tr_b16 v[182:183], v11 offset:45056
  v_mfma_f32_16x16x32_bf16 v[92:95], v[152:155], a[100:103], v[92:95]
  s_waitcnt lgkmcnt(12)
  ds_read_b64_tr_b16 v[184:185], v12 offset:32768
  v_mfma_f32_16x16x32_bf16 v[92:95], v[156:159], a[108:111], v[92:95]
  s_add_u32 m0, s26, 81920
  ds_read_b64_tr_b16 v[186:187], v12 offset:36864
  v_mfma_f32_16x16x32_bf16 v[88:91], v[152:155], a[96:99], v[88:91]
  buffer_load_dwordx4 v13, s[12:15], s27 offen offset:0 lds
  v_mfma_f32_16x16x32_bf16 v[88:91], v[156:159], a[104:107], v[88:91]
  s_waitcnt lgkmcnt(12)
  ds_read_b64_tr_b16 v[188:189], v12 offset:40960
  ds_read_b64_tr_b16 v[190:191], v12 offset:45056
  v_mfma_f32_16x16x32_bf16 v[96:99], v[160:163], a[96:99], v[96:99]
  s_waitcnt lgkmcnt(12)
  ds_read_b64_tr_b16 v[128:129], v5 offset:49152
  v_mfma_f32_16x16x32_bf16 v[96:99], v[164:167], a[104:107], v[96:99]
  ds_read_b64_tr_b16 v[130:131], v5 offset:53248
  v_mfma_f32_16x16x32_bf16 v[100:103], v[160:163], a[100:103], v[100:103]
  buffer_load_dwordx4 v14, s[12:15], s27 offen offset:1024 lds
  v_mfma_f32_16x16x32_bf16 v[100:103], v[164:167], a[108:111], v[100:103]
  s_waitcnt lgkmcnt(12)
  ds_read_b64_tr_b16 v[132:133], v5 offset:57344
  ds_read_b64_tr_b16 v[134:135], v5 offset:61440
  v_mfma_f32_16x16x32_bf16 v[108:111], v[168:171], a[100:103], v[108:111]
  s_waitcnt lgkmcnt(12)
  ds_read_b64_tr_b16 v[136:137], v6 offset:49152
  v_mfma_f32_16x16x32_bf16 v[108:111], v[172:175], a[108:111], v[108:111]
  ds_read_b64_tr_b16 v[138:139], v6 offset:53248
  v_mfma_f32_16x16x32_bf16 v[104:107], v[168:171], a[96:99], v[104:107]
  buffer_load_dwordx4 v15, s[12:15], s27 offen offset:2048 lds
  v_mfma_f32_16x16x32_bf16 v[104:107], v[172:175], a[104:107], v[104:107]
  s_waitcnt lgkmcnt(12)
  ds_read_b64_tr_b16 v[140:141], v6 offset:57344
  ds_read_b64_tr_b16 v[142:143], v6 offset:61440
  v_mfma_f32_16x16x32_bf16 v[112:115], v[176:179], a[96:99], v[112:115]
  s_waitcnt lgkmcnt(12)
  ds_read_b64_tr_b16 v[144:145], v7 offset:49152
  v_mfma_f32_16x16x32_bf16 v[112:115], v[180:183], a[104:107], v[112:115]
  ds_read_b64_tr_b16 v[146:147], v7 offset:53248
  v_mfma_f32_16x16x32_bf16 v[116:119], v[176:179], a[100:103], v[116:119]
  buffer_load_dwordx4 v16, s[12:15], s27 offen offset:3072 lds
  v_mfma_f32_16x16x32_bf16 v[116:119], v[180:183], a[108:111], v[116:119]
  s_waitcnt lgkmcnt(12)
  s_add_u32 s27, s27, 262144
  ds_read_b64_tr_b16 v[148:149], v7 offset:57344
  ds_read_b64_tr_b16 v[150:151], v7 offset:61440
  v_mfma_f32_16x16x32_bf16 v[124:127], v[184:187], a[100:103], v[124:127]
  s_waitcnt lgkmcnt(12)
  ds_read_b64_tr_b16 v[152:153], v8 offset:49152
  v_mfma_f32_16x16x32_bf16 v[124:127], v[188:191], a[108:111], v[124:127]
  s_add_u32 m0, s26, 49152
  ds_read_b64_tr_b16 v[154:155], v8 offset:53248
  v_mfma_f32_16x16x32_bf16 v[120:123], v[184:187], a[96:99], v[120:123]
  buffer_load_dwordx4 v13, s[12:15], s27 offen offset:0 lds
  v_mfma_f32_16x16x32_bf16 v[120:123], v[188:191], a[104:107], v[120:123]
  s_waitcnt vmcnt(28) lgkmcnt(12)
  ds_read_b64_tr_b16 v[156:157], v8 offset:57344
  ds_read_b64_tr_b16 v[158:159], v8 offset:61440
  v_mfma_f32_16x16x32_bf16 v[64:67], v[128:131], a[112:115], v[64:67]
  s_waitcnt vmcnt(26) lgkmcnt(12)
  ds_read_b64_tr_b16 v[160:161], v9 offset:49152
  v_mfma_f32_16x16x32_bf16 v[64:67], v[132:135], a[120:123], v[64:67]
  ds_read_b64_tr_b16 v[162:163], v9 offset:53248
  v_mfma_f32_16x16x32_bf16 v[68:71], v[128:131], a[116:119], v[68:71]
  s_waitcnt vmcnt(25)
  buffer_load_dwordx4 v14, s[12:15], s27 offen offset:1024 lds
  v_mfma_f32_16x16x32_bf16 v[68:71], v[132:135], a[124:127], v[68:71]
  s_waitcnt lgkmcnt(12)
  ds_read_b64_tr_b16 v[164:165], v9 offset:57344
  ds_read_b64_tr_b16 v[166:167], v9 offset:61440
  v_mfma_f32_16x16x32_bf16 v[76:79], v[136:139], a[116:119], v[76:79]
  s_waitcnt lgkmcnt(12)
  ds_read_b64_tr_b16 v[168:169], v10 offset:49152
  v_mfma_f32_16x16x32_bf16 v[76:79], v[140:143], a[124:127], v[76:79]
  ds_read_b64_tr_b16 v[170:171], v10 offset:53248
  v_mfma_f32_16x16x32_bf16 v[72:75], v[136:139], a[112:115], v[72:75]
  buffer_load_dwordx4 v15, s[12:15], s27 offen offset:2048 lds
  v_mfma_f32_16x16x32_bf16 v[72:75], v[140:143], a[120:123], v[72:75]
  s_waitcnt lgkmcnt(12)
  ds_read_b64_tr_b16 v[172:173], v10 offset:57344
  ds_read_b64_tr_b16 v[174:175], v10 offset:61440
  v_mfma_f32_16x16x32_bf16 v[80:83], v[144:147], a[112:115], v[80:83]
  s_waitcnt lgkmcnt(12)
  ds_read_b64_tr_b16 v[176:177], v11 offset:49152
  v_mfma_f32_16x16x32_bf16 v[80:83], v[148:151], a[120:123], v[80:83]
  ds_read_b64_tr_b16 v[178:179], v11 offset:53248
  v_mfma_f32_16x16x32_bf16 v[84:87], v[144:147], a[116:119], v[84:87]
  buffer_load_dwordx4 v16, s[12:15], s27 offen offset:3072 lds
  v_mfma_f32_16x16x32_bf16 v[84:87], v[148:151], a[124:127], v[84:87]
  s_waitcnt lgkmcnt(12)
  s_add_u32 s27, s27, 262144
  ds_read_b64_tr_b16 v[180:181], v11 offset:57344
  ds_read_b64_tr_b16 v[182:183], v11 offset:61440
  v_mfma_f32_16x16x32_bf16 v[92:95], v[152:155], a[116:119], v[92:95]
  s_waitcnt lgkmcnt(12)
  ds_read_b64_tr_b16 v[184:185], v12 offset:49152
  v_mfma_f32_16x16x32_bf16 v[92:95], v[156:159], a[124:127], v[92:95]
  ds_read_b64_tr_b16 v[186:187], v12 offset:53248
  v_mfma_f32_16x16x32_bf16 v[88:91], v[152:155], a[112:115], v[88:91]
  s_add_u32 s52, s55, 106496
  buffer_load_dwordx4 a[176:179], v0, s[16:19], s52 offen offset:0 sc1
  v_mfma_f32_16x16x32_bf16 v[88:91], v[156:159], a[120:123], v[88:91]
  s_waitcnt lgkmcnt(12)
  ds_read_b64_tr_b16 v[188:189], v12 offset:57344
  ds_read_b64_tr_b16 v[190:191], v12 offset:61440
  v_mfma_f32_16x16x32_bf16 v[96:99], v[160:163], a[112:115], v[96:99]
  s_waitcnt lgkmcnt(12)
  ds_read_b64_tr_b16 v[128:129], v24 offset:0
  v_mfma_f32_16x16x32_bf16 v[96:99], v[164:167], a[120:123], v[96:99]
  ds_read_b64_tr_b16 v[130:131], v24 offset:4096
  v_mfma_f32_16x16x32_bf16 v[100:103], v[160:163], a[116:119], v[100:103]
  buffer_load_dwordx4 a[180:183], v0, s[16:19], s52 offen offset:1024 sc1
  v_mfma_f32_16x16x32_bf16 v[100:103], v[164:167], a[124:127], v[100:103]
  s_waitcnt lgkmcnt(12)
  ds_read_b64_tr_b16 v[132:133], v24 offset:8192
  ds_read_b64_tr_b16 v[134:135], v24 offset:12288
  v_mfma_f32_16x16x32_bf16 v[108:111], v[168:171], a[116:119], v[108:111]
  s_waitcnt lgkmcnt(12)
  ds_read_b64_tr_b16 v[136:137], v25 offset:0
  v_mfma_f32_16x16x32_bf16 v[108:111], v[172:175], a[124:127], v[108:111]
  ds_read_b64_tr_b16 v[138:139], v25 offset:4096
  v_mfma_f32_16x16x32_bf16 v[104:107], v[168:171], a[112:115], v[104:107]
  s_add_u32 s52, s55, 122880
  buffer_load_dwordx4 a[184:187], v0, s[16:19], s52 offen offset:0 sc1
  v_mfma_f32_16x16x32_bf16 v[104:107], v[172:175], a[120:123], v[104:107]
  s_waitcnt lgkmcnt(12)
  ds_read_b64_tr_b16 v[140:141], v25 offset:8192
  ds_read_b64_tr_b16 v[142:143], v25 offset:12288
  v_mfma_f32_16x16x32_bf16 v[112:115], v[176:179], a[112:115], v[112:115]
  s_waitcnt lgkmcnt(12)
  ds_read_b64_tr_b16 v[144:145], v26 offset:0
  v_mfma_f32_16x16x32_bf16 v[112:115], v[180:183], a[120:123], v[112:115]
  ds_read_b64_tr_b16 v[146:147], v26 offset:4096
  v_mfma_f32_16x16x32_bf16 v[116:119], v[176:179], a[116:119], v[116:119]
  buffer_load_dwordx4 a[188:191], v0, s[16:19], s52 offen offset:1024 sc1
  v_mfma_f32_16x16x32_bf16 v[116:119], v[180:183], a[124:127], v[116:119]
  s_waitcnt lgkmcnt(12)
  ds_read_b64_tr_b16 v[148:149], v26 offset:8192
  ds_read_b64_tr_b16 v[150:151], v26 offset:12288
  v_mfma_f32_16x16x32_bf16 v[124:127], v[184:187], a[116:119], v[124:127]
  s_waitcnt lgkmcnt(12)
  ds_read_b64_tr_b16 v[152:153], v27 offset:0
  v_mfma_f32_16x16x32_bf16 v[124:127], v[188:191], a[124:127], v[124:127]
  ds_read_b64_tr_b16 v[154:155], v27 offset:4096
  v_mfma_f32_16x16x32_bf16 v[120:123], v[184:187], a[112:115], v[120:123]
  s_add_u32 s52, s55, 12288
  buffer_load_dwordx4 a[192:195], v0, s[16:19], s52 offen offset:0 sc1
  v_mfma_f32_16x16x32_bf16 v[120:123], v[188:191], a[120:123], v[120:123]
  s_waitcnt vmcnt(24) lgkmcnt(12)
  s_barrier
  ds_read_b64_tr_b16 v[156:157], v27 offset:8192
  ds_read_b64_tr_b16 v[158:159], v27 offset:12288
  v_mfma_f32_16x16x32_bf16 v[64:67], v[128:131], a[128:131], v[64:67]
  s_waitcnt vmcnt(22) lgkmcnt(12)
  ds_read_b64_tr_b16 v[160:161], v28 offset:0
  v_mfma_f32_16x16x32_bf16 v[64:67], v[132:135], a[136:139], v[64:67]
  ds_read_b64_tr_b16 v[162:163], v28 offset:4096
  v_mfma_f32_16x16x32_bf16 v[68:71], v[128:131], a[132:135], v[68:71]
  s_waitcnt vmcnt(21)
  buffer_load_dwordx4 a[196:199], v0, s[16:19], s52 offen offset:1024 sc1
  v_mfma_f32_16x16x32_bf16 v[68:71], v[132:135], a[140:143], v[68:71]
  s_waitcnt lgkmcnt(12)
  ds_read_b64_tr_b16 v[164:165], v28 offset:8192
  ds_read_b64_tr_b16 v[166:167], v28 offset:12288
  v_mfma_f32_16x16x32_bf16 v[76:79], v[136:139], a[132:135], v[76:79]
  s_waitcnt lgkmcnt(12)
  ds_read_b64_tr_b16 v[168:169], v29 offset:0
  v_mfma_f32_16x16x32_bf16 v[76:79], v[140:143], a[140:143], v[76:79]
  ds_read_b64_tr_b16 v[170:171], v29 offset:4096
  v_mfma_f32_16x16x32_bf16 v[72:75], v[136:139], a[128:131], v[72:75]
  s_add_u32 s52, s55, 28672
  buffer_load_dwordx4 a[200:203], v0, s[16:19], s52 offen offset:0 sc1
  v_mfma_f32_16x16x32_bf16 v[72:75], v[140:143], a[136:139], v[72:75]
  s_waitcnt lgkmcnt(12)
  ds_read_b64_tr_b16 v[172:173], v29 offset:8192
  ds_read_b64_tr_b16 v[174:175], v29 offset:12288
  v_mfma_f32_16x16x32_bf16 v[80:83], v[144:147], a[128:131], v[80:83]
  s_waitcnt lgkmcnt(12)
  ds_read_b64_tr_b16 v[176:177], v30 offset:0
  v_mfma_f32_16x16x32_bf16 v[80:83], v[148:151], a[136:139], v[80:83]
  ds_read_b64_tr_b16 v[178:179], v30 offset:4096
  v_mfma_f32_16x16x32_bf16 v[84:87], v[144:147], a[132:135], v[84:87]
  buffer_load_dwordx4 a[204:207], v0, s[16:19], s52 offen offset:1024 sc1
  v_mfma_f32_16x16x32_bf16 v[84:87], v[148:151], a[140:143], v[84:87]
  s_waitcnt lgkmcnt(12)
  ds_read_b64_tr_b16 v[180:181], v30 offset:8192
  ds_read_b64_tr_b16 v[182:183], v30 offset:12288
  v_mfma_f32_16x16x32_bf16 v[92:95], v[152:155], a[132:135], v[92:95]
  s_waitcnt lgkmcnt(12)
  ds_read_b64_tr_b16 v[184:185], v31 offset:0
  v_mfma_f32_16x16x32_bf16 v[92:95], v[156:159], a[140:143], v[92:95]
  s_add_u32 m0, s26, 98304
  ds_read_b64_tr_b16 v[186:187], v31 offset:4096
  v_mfma_f32_16x16x32_bf16 v[88:91], v[152:155], a[128:131], v[88:91]
  buffer_load_dwordx4 v13, s[12:15], s27 offen offset:0 lds
  v_mfma_f32_16x16x32_bf16 v[88:91], v[156:159], a[136:139], v[88:91]
  s_waitcnt lgkmcnt(12)
  ds_read_b64_tr_b16 v[188:189], v31 offset:8192
  ds_read_b64_tr_b16 v[190:191], v31 offset:12288
  v_mfma_f32_16x16x32_bf16 v[96:99], v[160:163], a[128:131], v[96:99]
  s_waitcnt lgkmcnt(12)
  ds_read_b64_tr_b16 v[128:129], v24 offset:16384
  v_mfma_f32_16x16x32_bf16 v[96:99], v[164:167], a[136:139], v[96:99]
  ds_read_b64_tr_b16 v[130:131], v24 offset:20480
  v_mfma_f32_16x16x32_bf16 v[100:103], v[160:163], a[132:135], v[100:103]
  buffer_load_dwordx4 v14, s[12:15], s27 offen offset:1024 lds
  v_mfma_f32_16x16x32_bf16 v[100:103], v[164:167], a[140:143], v[100:103]
  s_waitcnt lgkmcnt(12)
  ds_read_b64_tr_b16 v[132:133], v24 offset:24576
  ds_read_b64_tr_b16 v[134:135], v24 offset:28672
  v_mfma_f32_16x16x32_bf16 v[108:111], v[168:171], a[132:135], v[108:111]
  s_waitcnt lgkmcnt(12)
  ds_read_b64_tr_b16 v[136:137], v25 offset:16384
  v_mfma_f32_16x16x32_bf16 v[108:111], v[172:175], a[140:143], v[108:111]
  ds_read_b64_tr_b16 v[138:139], v25 offset:20480
  v_mfma_f32_16x16x32_bf16 v[104:107], v[168:171], a[128:131], v[104:107]
  buffer_load_dwordx4 v15, s[12:15], s27 offen offset:2048 lds
  v_mfma_f32_16x16x32_bf16 v[104:107], v[172:175], a[136:139], v[104:107]
  s_waitcnt lgkmcnt(12)
  ds_read_b64_tr_b16 v[140:141], v25 offset:24576
  ds_read_b64_tr_b16 v[142:143], v25 offset:28672
  v_mfma_f32_16x16x32_bf16 v[112:115], v[176:179], a[128:131], v[112:115]
  s_waitcnt lgkmcnt(12)
  ds_read_b64_tr_b16 v[144:145], v26 offset:16384
  v_mfma_f32_16x16x32_bf16 v[112:115], v[180:183], a[136:139], v[112:115]
  ds_read_b64_tr_b16 v[146:147], v26 offset:20480
  v_mfma_f32_16x16x32_bf16 v[116:119], v[176:179], a[132:135], v[116:119]
  buffer_load_dwordx4 v16, s[12:15], s27 offen offset:3072 lds
  v_mfma_f32_16x16x32_bf16 v[116:119], v[180:183], a[140:143], v[116:119]
  s_waitcnt lgkmcnt(12)
  s_add_u32 s27, s27, 262144
  ds_read_b64_tr_b16 v[148:149], v26 offset:24576
  ds_read_b64_tr_b16 v[150:151], v26 offset:28672
  v_mfma_f32_16x16x32_bf16 v[124:127], v[184:187], a[132:135], v[124:127]
  s_waitcnt lgkmcnt(12)
  ds_read_b64_tr_b16 v[152:153], v27 offset:16384
  v_mfma_f32_16x16x32_bf16 v[124:127], v[188:191], a[140:143], v[124:127]
  s_add_u32 m0, s26, 114688
  ds_read_b64_tr_b16 v[154:155], v27 offset:20480
  v_mfma_f32_16x16x32_bf16 v[120:123], v[184:187], a[128:131], v[120:123]
  buffer_load_dwordx4 v13, s[12:15], s27 offen offset:0 lds
  v_mfma_f32_16x16x32_bf16 v[120:123], v[188:191], a[136:139], v[120:123]
  s_waitcnt vmcnt(28) lgkmcnt(12)
  ds_read_b64_tr_b16 v[156:157], v27 offset:24576
  ds_read_b64_tr_b16 v[158:159], v27 offset:28672
  v_mfma_f32_16x16x32_bf16 v[64:67], v[128:131], a[144:147], v[64:67]
  s_waitcnt vmcnt(26) lgkmcnt(12)
  ds_read_b64_tr_b16 v[160:161], v28 offset:16384
  v_mfma_f32_16x16x32_bf16 v[64:67], v[132:135], a[152:155], v[64:67]
  ds_read_b64_tr_b16 v[162:163], v28 offset:20480
  v_mfma_f32_16x16x32_bf16 v[68:71], v[128:131], a[148:151], v[68:71]
  s_waitcnt vmcnt(25)
  buffer_load_dwordx4 v14, s[12:15], s27 offen offset:1024 lds
  v_mfma_f32_16x16x32_bf16 v[68:71], v[132:135], a[156:159], v[68:71]
  s_waitcnt lgkmcnt(12)
  ds_read_b64_tr_b16 v[164:165], v28 offset:24576
  ds_read_b64_tr_b16 v[166:167], v28 offset:28672
  v_mfma_f32_16x16x32_bf16 v[76:79], v[136:139], a[148:151], v[76:79]
  s_waitcnt lgkmcnt(12)
  ds_read_b64_tr_b16 v[168:169], v29 offset:16384
  v_mfma_f32_16x16x32_bf16 v[76:79], v[140:143], a[156:159], v[76:79]
  ds_read_b64_tr_b16 v[170:171], v29 offset:20480
  v_mfma_f32_16x16x32_bf16 v[72:75], v[136:139], a[144:147], v[72:75]
  buffer_load_dwordx4 v15, s[12:15], s27 offen offset:2048 lds
  v_mfma_f32_16x16x32_bf16 v[72:75], v[140:143], a[152:155], v[72:75]
  s_waitcnt lgkmcnt(12)
  ds_read_b64_tr_b16 v[172:173], v29 offset:24576
  ds_read_b64_tr_b16 v[174:175], v29 offset:28672
  v_mfma_f32_16x16x32_bf16 v[80:83], v[144:147], a[144:147], v[80:83]
  s_waitcnt lgkmcnt(12)
  ds_read_b64_tr_b16 v[176:177], v30 offset:16384
  v_mfma_f32_16x16x32_bf16 v[80:83], v[148:151], a[152:155], v[80:83]
  ds_read_b64_tr_b16 v[178:179], v30 offset:20480
  v_mfma_f32_16x16x32_bf16 v[84:87], v[144:147], a[148:151], v[84:87]
  buffer_load_dwordx4 v16, s[12:15], s27 offen offset:3072 lds
  v_mfma_f32_16x16x32_bf16 v[84:87], v[148:151], a[156:159], v[84:87]
  s_waitcnt lgkmcnt(12)
  s_add_u32 s27, s27, 4294213632
  ds_read_b64_tr_b16 v[180:181], v30 offset:24576
  ds_read_b64_tr_b16 v[182:183], v30 offset:28672
  v_mfma_f32_16x16x32_bf16 v[92:95], v[152:155], a[148:151], v[92:95]
  s_waitcnt lgkmcnt(12)
  ds_read_b64_tr_b16 v[184:185], v31 offset:16384
  v_mfma_f32_16x16x32_bf16 v[92:95], v[156:159], a[156:159], v[92:95]
  ds_read_b64_tr_b16 v[186:187], v31 offset:20480
  v_mfma_f32_16x16x32_bf16 v[88:91], v[152:155], a[144:147], v[88:91]
  s_add_u32 s52, s55, 45056
  buffer_load_dwordx4 a[208:211], v0, s[16:19], s52 offen offset:0 sc1
  v_mfma_f32_16x16x32_bf16 v[88:91], v[156:159], a[152:155], v[88:91]
  s_waitcnt lgkmcnt(12)
  ds_read_b64_tr_b16 v[188:189], v31 offset:24576
  ds_read_b64_tr_b16 v[190:191], v31 offset:28672
  v_mfma_f32_16x16x32_bf16 v[96:99], v[160:163], a[144:147], v[96:99]
  s_waitcnt lgkmcnt(12)
  ds_read_b64_tr_b16 v[128:129], v5 offset:0
  v_mfma_f32_16x16x32_bf16 v[96:99], v[164:167], a[152:155], v[96:99]
  ds_read_b64_tr_b16 v[130:131], v5 offset:4096
  v_mfma_f32_16x16x32_bf16 v[100:103], v[160:163], a[148:151], v[100:103]
  buffer_load_dwordx4 a[212:215], v0, s[16:19], s52 offen offset:1024 sc1
  v_mfma_f32_16x16x32_bf16 v[100:103], v[164:167], a[156:159], v[100:103]
  s_waitcnt lgkmcnt(12)
  ds_read_b64_tr_b16 v[132:133], v5 offset:8192
  ds_read_b64_tr_b16 v[134:135], v5 offset:12288
  v_mfma_f32_16x16x32_bf16 v[108:111], v[168:171], a[148:151], v[108:111]
  s_waitcnt lgkmcnt(12)
  ds_read_b64_tr_b16 v[136:137], v6 offset:0
  v_mfma_f32_16x16x32_bf16 v[108:111], v[172:175], a[156:159], v[108:111]
  ds_read_b64_tr_b16 v[138:139], v6 offset:4096
  v_mfma_f32_16x16x32_bf16 v[104:107], v[168:171], a[144:147], v[104:107]
  s_add_u32 s52, s55, 61440
  buffer_load_dwordx4 a[216:219], v0, s[16:19], s52 offen offset:0 sc1
  v_mfma_f32_16x16x32_bf16 v[104:107], v[172:175], a[152:155], v[104:107]
  s_waitcnt lgkmcnt(12)
  ds_read_b64_tr_b16 v[140:141], v6 offset:8192
  ds_read_b64_tr_b16 v[142:143], v6 offset:12288
  v_mfma_f32_16x16x32_bf16 v[112:115], v[176:179], a[144:147], v[112:115]
  s_waitcnt lgkmcnt(12)
  ds_read_b64_tr_b16 v[144:145], v7 offset:0
  v_mfma_f32_16x16x32_bf16 v[112:115], v[180:183], a[152:155], v[112:115]
  ds_read_b64_tr_b16 v[146:147], v7 offset:4096
  v_mfma_f32_16x16x32_bf16 v[116:119], v[176:179], a[148:151], v[116:119]
  buffer_load_dwordx4 a[220:223], v0, s[16:19], s52 offen offset:1024 sc1
  v_mfma_f32_16x16x32_bf16 v[116:119], v[180:183], a[156:159], v[116:119]
  s_waitcnt lgkmcnt(12)
  ds_read_b64_tr_b16 v[148:149], v7 offset:8192
  ds_read_b64_tr_b16 v[150:151], v7 offset:12288
  v_mfma_f32_16x16x32_bf16 v[124:127], v[184:187], a[148:151], v[124:127]
  s_waitcnt lgkmcnt(12)
  ds_read_b64_tr_b16 v[152:153], v8 offset:0
  v_mfma_f32_16x16x32_bf16 v[124:127], v[188:191], a[156:159], v[124:127]
  ds_read_b64_tr_b16 v[154:155], v8 offset:4096
  v_mfma_f32_16x16x32_bf16 v[120:123], v[184:187], a[144:147], v[120:123]
  s_add_u32 s52, s55, 77824
  buffer_load_dwordx4 a[224:227], v0, s[16:19], s52 offen offset:0 sc1
  v_mfma_f32_16x16x32_bf16 v[120:123], v[188:191], a[152:155], v[120:123]
  s_waitcnt vmcnt(32) lgkmcnt(12)
  ds_read_b64_tr_b16 v[156:157], v8 offset:8192
  ds_read_b64_tr_b16 v[158:159], v8 offset:12288
  v_mfma_f32_16x16x32_bf16 v[64:67], v[128:131], a[160:163], v[64:67]
  s_waitcnt vmcnt(30) lgkmcnt(12)
  ds_read_b64_tr_b16 v[160:161], v9 offset:0
  v_mfma_f32_16x16x32_bf16 v[64:67], v[132:135], a[168:171], v[64:67]
  ds_read_b64_tr_b16 v[162:163], v9 offset:4096
  v_mfma_f32_16x16x32_bf16 v[68:71], v[128:131], a[164:167], v[68:71]
  s_waitcnt vmcnt(29)
  buffer_load_dwordx4 a[228:231], v0, s[16:19], s52 offen offset:1024 sc1
  v_mfma_f32_16x16x32_bf16 v[68:71], v[132:135], a[172:175], v[68:71]
  s_waitcnt lgkmcnt(12)
  ds_read_b64_tr_b16 v[164:165], v9 offset:8192
  ds_read_b64_tr_b16 v[166:167], v9 offset:12288
  v_mfma_f32_16x16x32_bf16 v[76:79], v[136:139], a[164:167], v[76:79]
  s_waitcnt lgkmcnt(12)
  ds_read_b64_tr_b16 v[168:169], v10 offset:0
  v_mfma_f32_16x16x32_bf16 v[76:79], v[140:143], a[172:175], v[76:79]
  ds_read_b64_tr_b16 v[170:171], v10 offset:4096
  v_mfma_f32_16x16x32_bf16 v[72:75], v[136:139], a[160:163], v[72:75]
  s_add_u32 s52, s55, 94208
  buffer_load_dwordx4 a[232:235], v0, s[16:19], s52 offen offset:0 sc1
  v_mfma_f32_16x16x32_bf16 v[72:75], v[140:143], a[168:171], v[72:75]
  s_waitcnt lgkmcnt(12)
  ds_read_b64_tr_b16 v[172:173], v10 offset:8192
  ds_read_b64_tr_b16 v[174:175], v10 offset:12288
  v_mfma_f32_16x16x32_bf16 v[80:83], v[144:147], a[160:163], v[80:83]
  s_waitcnt lgkmcnt(12)
  ds_read_b64_tr_b16 v[176:177], v11 offset:0
  v_mfma_f32_16x16x32_bf16 v[80:83], v[148:151], a[168:171], v[80:83]
  ds_read_b64_tr_b16 v[178:179], v11 offset:4096
  v_mfma_f32_16x16x32_bf16 v[84:87], v[144:147], a[164:167], v[84:87]
  buffer_load_dwordx4 a[236:239], v0, s[16:19], s52 offen offset:1024 sc1
  v_mfma_f32_16x16x32_bf16 v[84:87], v[148:151], a[172:175], v[84:87]
  s_waitcnt lgkmcnt(12)
  ds_read_b64_tr_b16 v[180:181], v11 offset:8192
  ds_read_b64_tr_b16 v[182:183], v11 offset:12288
  v_mfma_f32_16x16x32_bf16 v[92:95], v[152:155], a[164:167], v[92:95]
  s_waitcnt lgkmcnt(12)
  ds_read_b64_tr_b16 v[184:185], v12 offset:0
  v_mfma_f32_16x16x32_bf16 v[92:95], v[156:159], a[172:175], v[92:95]
  ds_read_b64_tr_b16 v[186:187], v12 offset:4096
  v_mfma_f32_16x16x32_bf16 v[88:91], v[152:155], a[160:163], v[88:91]
  s_add_u32 s52, s55, 110592
  buffer_load_dwordx4 a[240:243], v0, s[16:19], s52 offen offset:0 sc1
  v_mfma_f32_16x16x32_bf16 v[88:91], v[156:159], a[168:171], v[88:91]
  s_waitcnt lgkmcnt(12)
  ds_read_b64_tr_b16 v[188:189], v12 offset:8192
  ds_read_b64_tr_b16 v[190:191], v12 offset:12288
  v_mfma_f32_16x16x32_bf16 v[96:99], v[160:163], a[160:163], v[96:99]
  s_waitcnt lgkmcnt(12)
  ds_read_b64_tr_b16 v[128:129], v24 offset:32768
  v_mfma_f32_16x16x32_bf16 v[96:99], v[164:167], a[168:171], v[96:99]
  ds_read_b64_tr_b16 v[130:131], v24 offset:36864
  v_mfma_f32_16x16x32_bf16 v[100:103], v[160:163], a[164:167], v[100:103]
  buffer_load_dwordx4 a[244:247], v0, s[16:19], s52 offen offset:1024 sc1
  v_mfma_f32_16x16x32_bf16 v[100:103], v[164:167], a[172:175], v[100:103]
  s_waitcnt lgkmcnt(12)
  ds_read_b64_tr_b16 v[132:133], v24 offset:40960
  ds_read_b64_tr_b16 v[134:135], v24 offset:45056
  v_mfma_f32_16x16x32_bf16 v[108:111], v[168:171], a[164:167], v[108:111]
  s_waitcnt lgkmcnt(12)
  ds_read_b64_tr_b16 v[136:137], v25 offset:32768
  v_mfma_f32_16x16x32_bf16 v[108:111], v[172:175], a[172:175], v[108:111]
  ds_read_b64_tr_b16 v[138:139], v25 offset:36864
  v_mfma_f32_16x16x32_bf16 v[104:107], v[168:171], a[160:163], v[104:107]
  s_add_u32 s52, s55, 126976
  buffer_load_dwordx4 a[248:251], v0, s[16:19], s52 offen offset:0 sc1
  v_mfma_f32_16x16x32_bf16 v[104:107], v[172:175], a[168:171], v[104:107]
  s_waitcnt lgkmcnt(12)
  ds_read_b64_tr_b16 v[140:141], v25 offset:40960
  ds_read_b64_tr_b16 v[142:143], v25 offset:45056
  v_mfma_f32_16x16x32_bf16 v[112:115], v[176:179], a[160:163], v[112:115]
  s_waitcnt lgkmcnt(12)
  ds_read_b64_tr_b16 v[144:145], v26 offset:32768
  v_mfma_f32_16x16x32_bf16 v[112:115], v[180:183], a[168:171], v[112:115]
  ds_read_b64_tr_b16 v[146:147], v26 offset:36864
  v_mfma_f32_16x16x32_bf16 v[116:119], v[176:179], a[164:167], v[116:119]
  buffer_load_dwordx4 a[252:255], v0, s[16:19], s52 offen offset:1024 sc1
  v_mfma_f32_16x16x32_bf16 v[116:119], v[180:183], a[172:175], v[116:119]
  s_waitcnt lgkmcnt(12)
  ds_read_b64_tr_b16 v[148:149], v26 offset:40960
  ds_read_b64_tr_b16 v[150:151], v26 offset:45056
  v_mfma_f32_16x16x32_bf16 v[124:127], v[184:187], a[164:167], v[124:127]
  s_waitcnt lgkmcnt(12)
  ds_read_b64_tr_b16 v[152:153], v27 offset:32768
  v_mfma_f32_16x16x32_bf16 v[124:127], v[188:191], a[172:175], v[124:127]
  ds_read_b64_tr_b16 v[154:155], v27 offset:36864
  v_mfma_f32_16x16x32_bf16 v[120:123], v[184:187], a[160:163], v[120:123]
  buffer_load_dwordx4 v[192:195], v2, s[16:19], s34 offen offset:0 sc1
  v_mfma_f32_16x16x32_bf16 v[120:123], v[188:191], a[168:171], v[120:123]
  s_waitcnt vmcnt(28) lgkmcnt(12)
  ds_read_b64_tr_b16 v[156:157], v27 offset:40960
  ds_read_b64_tr_b16 v[158:159], v27 offset:45056
  v_mfma_f32_16x16x32_bf16 v[64:67], v[128:131], a[176:179], v[64:67]
  s_waitcnt vmcnt(26) lgkmcnt(12)
  ds_read_b64_tr_b16 v[160:161], v28 offset:32768
  v_mfma_f32_16x16x32_bf16 v[64:67], v[132:135], a[184:187], v[64:67]
  ds_read_b64_tr_b16 v[162:163], v28 offset:36864
  v_mfma_f32_16x16x32_bf16 v[68:71], v[128:131], a[180:183], v[68:71]
  s_waitcnt vmcnt(25)
  buffer_load_dwordx4 v[196:199], v2, s[16:19], s34 offen offset:64 sc1
  v_mfma_f32_16x16x32_bf16 v[68:71], v[132:135], a[188:191], v[68:71]
  s_waitcnt lgkmcnt(12)
  ds_read_b64_tr_b16 v[164:165], v28 offset:40960
  ds_read_b64_tr_b16 v[166:167], v28 offset:45056
  v_mfma_f32_16x16x32_bf16 v[76:79], v[136:139], a[180:183], v[76:79]
  s_waitcnt lgkmcnt(12)
  ds_read_b64_tr_b16 v[168:169], v29 offset:32768
  v_mfma_f32_16x16x32_bf16 v[76:79], v[140:143], a[188:191], v[76:79]
  ds_read_b64_tr_b16 v[170:171], v29 offset:36864
  v_mfma_f32_16x16x32_bf16 v[72:75], v[136:139], a[176:179], v[72:75]
  buffer_load_dwordx4 v[200:203], v2, s[16:19], s34 offen offset:256 sc1
  v_mfma_f32_16x16x32_bf16 v[72:75], v[140:143], a[184:187], v[72:75]
  s_waitcnt lgkmcnt(12)
  ds_read_b64_tr_b16 v[172:173], v29 offset:40960
  ds_read_b64_tr_b16 v[174:175], v29 offset:45056
  v_mfma_f32_16x16x32_bf16 v[80:83], v[144:147], a[176:179], v[80:83]
  s_waitcnt lgkmcnt(12)
  ds_read_b64_tr_b16 v[176:177], v30 offset:32768
  v_mfma_f32_16x16x32_bf16 v[80:83], v[148:151], a[184:187], v[80:83]
  ds_read_b64_tr_b16 v[178:179], v30 offset:36864
  v_mfma_f32_16x16x32_bf16 v[84:87], v[144:147], a[180:183], v[84:87]
  buffer_load_dwordx4 v[204:207], v2, s[16:19], s34 offen offset:320 sc1
  v_mfma_f32_16x16x32_bf16 v[84:87], v[148:151], a[188:191], v[84:87]
  s_waitcnt lgkmcnt(12)
  ds_read_b64_tr_b16 v[180:181], v30 offset:40960
  ds_read_b64_tr_b16 v[182:183], v30 offset:45056
  v_mfma_f32_16x16x32_bf16 v[92:95], v[152:155], a[180:183], v[92:95]
  s_waitcnt lgkmcnt(12)
  ds_read_b64_tr_b16 v[184:185], v31 offset:32768
  v_mfma_f32_16x16x32_bf16 v[92:95], v[156:159], a[188:191], v[92:95]
  ds_read_b64_tr_b16 v[186:187], v31 offset:36864
  v_mfma_f32_16x16x32_bf16 v[88:91], v[152:155], a[176:179], v[88:91]
  buffer_load_dwordx4 v[224:227], v2, s[16:19], s34 offen offset:2048 sc1
  v_mfma_f32_16x16x32_bf16 v[88:91], v[156:159], a[184:187], v[88:91]
  s_waitcnt lgkmcnt(12)
  s_barrier
  ds_read_b64_tr_b16 v[188:189], v31 offset:40960
  ds_read_b64_tr_b16 v[190:191], v31 offset:45056
  v_mfma_f32_16x16x32_bf16 v[96:99], v[160:163], a[176:179], v[96:99]
  s_waitcnt lgkmcnt(12)
  ds_read_b64_tr_b16 v[128:129], v5 offset:16384
  v_mfma_f32_16x16x32_bf16 v[96:99], v[164:167], a[184:187], v[96:99]
  ds_read_b64_tr_b16 v[130:131], v5 offset:20480
  v_mfma_f32_16x16x32_bf16 v[100:103], v[160:163], a[180:183], v[100:103]
  buffer_load_dwordx4 v[228:231], v2, s[16:19], s34 offen offset:2112 sc1
  v_mfma_f32_16x16x32_bf16 v[100:103], v[164:167], a[188:191], v[100:103]
  s_waitcnt lgkmcnt(12)
  ds_read_b64_tr_b16 v[132:133], v5 offset:24576
  ds_read_b64_tr_b16 v[134:135], v5 offset:28672
  v_mfma_f32_16x16x32_bf16 v[108:111], v[168:171], a[180:183], v[108:111]
  s_waitcnt lgkmcnt(12)
  ds_read_b64_tr_b16 v[136:137], v6 offset:16384
  v_mfma_f32_16x16x32_bf16 v[108:111], v[172:175], a[188:191], v[108:111]
  ds_read_b64_tr_b16 v[138:139], v6 offset:20480
  v_mfma_f32_16x16x32_bf16 v[104:107], v[168:171], a[176:179], v[104:107]
  buffer_load_dwordx4 v[232:235], v2, s[16:19], s34 offen offset:2304 sc1
  v_mfma_f32_16x16x32_bf16 v[104:107], v[172:175], a[184:187], v[104:107]
  s_waitcnt lgkmcnt(12)
  ds_read_b64_tr_b16 v[140:141], v6 offset:24576
  ds_read_b64_tr_b16 v[142:143], v6 offset:28672
  v_mfma_f32_16x16x32_bf16 v[112:115], v[176:179], a[176:179], v[112:115]
  s_waitcnt lgkmcnt(12)
  ds_read_b64_tr_b16 v[144:145], v7 offset:16384
  v_mfma_f32_16x16x32_bf16 v[112:115], v[180:183], a[184:187], v[112:115]
  ds_read_b64_tr_b16 v[146:147], v7 offset:20480
  v_mfma_f32_16x16x32_bf16 v[116:119], v[176:179], a[180:183], v[116:119]
  buffer_load_dwordx4 v[236:239], v2, s[16:19], s34 offen offset:2368 sc1
  v_mfma_f32_16x16x32_bf16 v[116:119], v[180:183], a[188:191], v[116:119]
  s_waitcnt lgkmcnt(12)
  ds_read_b64_tr_b16 v[148:149], v7 offset:24576
  ds_read_b64_tr_b16 v[150:151], v7 offset:28672
  v_mfma_f32_16x16x32_bf16 v[124:127], v[184:187], a[180:183], v[124:127]
  s_waitcnt lgkmcnt(12)
  ds_read_b64_tr_b16 v[152:153], v8 offset:16384
  v_mfma_f32_16x16x32_bf16 v[124:127], v[188:191], a[188:191], v[124:127]
  ds_read_b64_tr_b16 v[154:155], v8 offset:20480
  v_mfma_f32_16x16x32_bf16 v[120:123], v[184:187], a[176:179], v[120:123]
  buffer_load_dwordx4 v[208:211], v2, s[16:19], s35 offen offset:0 sc1
  v_mfma_f32_16x16x32_bf16 v[120:123], v[188:191], a[184:187], v[120:123]
  s_waitcnt vmcnt(32) lgkmcnt(12)
  ds_read_b64_tr_b16 v[156:157], v8 offset:24576
  ds_read_b64_tr_b16 v[158:159], v8 offset:28672
  v_mfma_f32_16x16x32_bf16 v[64:67], v[128:131], a[192:195], v[64:67]
  s_waitcnt vmcnt(30) lgkmcnt(12)
  ds_read_b64_tr_b16 v[160:161], v9 offset:16384
  v_mfma_f32_16x16x32_bf16 v[64:67], v[132:135], a[200:203], v[64:67]
  ds_read_b64_tr_b16 v[162:163], v9 offset:20480
  v_mfma_f32_16x16x32_bf16 v[68:71], v[128:131], a[196:199], v[68:71]
  s_waitcnt vmcnt(29)
  buffer_load_dwordx4 v[212:215], v2, s[16:19], s35 offen offset:64 sc1
  v_mfma_f32_16x16x32_bf16 v[68:71], v[132:135], a[204:207], v[68:71]
  s_waitcnt lgkmcnt(12)
  ds_read_b64_tr_b16 v[164:165], v9 offset:24576
  ds_read_b64_tr_b16 v[166:167], v9 offset:28672
  v_mfma_f32_16x16x32_bf16 v[76:79], v[136:139], a[196:199], v[76:79]
  s_waitcnt lgkmcnt(12)
  ds_read_b64_tr_b16 v[168:169], v10 offset:16384
  v_mfma_f32_16x16x32_bf16 v[76:79], v[140:143], a[204:207], v[76:79]
  ds_read_b64_tr_b16 v[170:171], v10 offset:20480
  v_mfma_f32_16x16x32_bf16 v[72:75], v[136:139], a[192:195], v[72:75]
  buffer_load_dwordx4 v[216:219], v2, s[16:19], s35 offen offset:256 sc1
  v_mfma_f32_16x16x32_bf16 v[72:75], v[140:143], a[200:203], v[72:75]
  s_waitcnt lgkmcnt(12)
  ds_read_b64_tr_b16 v[172:173], v10 offset:24576
  ds_read_b64_tr_b16 v[174:175], v10 offset:28672
  v_mfma_f32_16x16x32_bf16 v[80:83], v[144:147], a[192:195], v[80:83]
  s_waitcnt lgkmcnt(12)
  ds_read_b64_tr_b16 v[176:177], v11 offset:16384
  v_mfma_f32_16x16x32_bf16 v[80:83], v[148:151], a[200:203], v[80:83]
  ds_read_b64_tr_b16 v[178:179], v11 offset:20480
  v_mfma_f32_16x16x32_bf16 v[84:87], v[144:147], a[196:199], v[84:87]
  buffer_load_dwordx4 v[220:223], v2, s[16:19], s35 offen offset:320 sc1
  v_mfma_f32_16x16x32_bf16 v[84:87], v[148:151], a[204:207], v[84:87]
  s_waitcnt lgkmcnt(12)
  ds_read_b64_tr_b16 v[180:181], v11 offset:24576
  ds_read_b64_tr_b16 v[182:183], v11 offset:28672
  v_mfma_f32_16x16x32_bf16 v[92:95], v[152:155], a[196:199], v[92:95]
  s_waitcnt lgkmcnt(12)
  ds_read_b64_tr_b16 v[184:185], v12 offset:16384
  v_mfma_f32_16x16x32_bf16 v[92:95], v[156:159], a[204:207], v[92:95]
  ds_read_b64_tr_b16 v[186:187], v12 offset:20480
  v_mfma_f32_16x16x32_bf16 v[88:91], v[152:155], a[192:195], v[88:91]
  buffer_load_dwordx4 v[240:243], v2, s[16:19], s35 offen offset:2048 sc1
  v_mfma_f32_16x16x32_bf16 v[88:91], v[156:159], a[200:203], v[88:91]
  s_waitcnt lgkmcnt(12)
  ds_read_b64_tr_b16 v[188:189], v12 offset:24576
  ds_read_b64_tr_b16 v[190:191], v12 offset:28672
  v_mfma_f32_16x16x32_bf16 v[96:99], v[160:163], a[192:195], v[96:99]
  s_waitcnt lgkmcnt(12)
  ds_read_b64_tr_b16 v[128:129], v24 offset:49152
  v_mfma_f32_16x16x32_bf16 v[96:99], v[164:167], a[200:203], v[96:99]
  ds_read_b64_tr_b16 v[130:131], v24 offset:53248
  v_mfma_f32_16x16x32_bf16 v[100:103], v[160:163], a[196:199], v[100:103]
  buffer_load_dwordx4 v[244:247], v2, s[16:19], s35 offen offset:2112 sc1
  v_mfma_f32_16x16x32_bf16 v[100:103], v[164:167], a[204:207], v[100:103]
  s_waitcnt lgkmcnt(12)
  ds_read_b64_tr_b16 v[132:133], v24 offset:57344
  ds_read_b64_tr_b16 v[134:135], v24 offset:61440
  v_mfma_f32_16x16x32_bf16 v[108:111], v[168:171], a[196:199], v[108:111]
  s_waitcnt lgkmcnt(12)
  ds_read_b64_tr_b16 v[136:137], v25 offset:49152
  v_mfma_f32_16x16x32_bf16 v[108:111], v[172:175], a[204:207], v[108:111]
  ds_read_b64_tr_b16 v[138:139], v25 offset:53248
  v_mfma_f32_16x16x32_bf16 v[104:107], v[168:171], a[192:195], v[104:107]
  buffer_load_dwordx4 v[248:251], v2, s[16:19], s35 offen offset:2304 sc1
  v_mfma_f32_16x16x32_bf16 v[104:107], v[172:175], a[200:203], v[104:107]
  s_waitcnt lgkmcnt(12)
  ds_read_b64_tr_b16 v[140:141], v25 offset:57344
  ds_read_b64_tr_b16 v[142:143], v25 offset:61440
  v_mfma_f32_16x16x32_bf16 v[112:115], v[176:179], a[192:195], v[112:115]
  s_waitcnt lgkmcnt(12)
  ds_read_b64_tr_b16 v[144:145], v26 offset:49152
  v_mfma_f32_16x16x32_bf16 v[112:115], v[180:183], a[200:203], v[112:115]
  ds_read_b64_tr_b16 v[146:147], v26 offset:53248
  v_mfma_f32_16x16x32_bf16 v[116:119], v[176:179], a[196:199], v[116:119]
  buffer_load_dwordx4 v[252:255], v2, s[16:19], s35 offen offset:2368 sc1
  v_mfma_f32_16x16x32_bf16 v[116:119], v[180:183], a[204:207], v[116:119]
  s_waitcnt lgkmcnt(12)
  ds_read_b64_tr_b16 v[148:149], v26 offset:57344
  ds_read_b64_tr_b16 v[150:151], v26 offset:61440
  v_mfma_f32_16x16x32_bf16 v[124:127], v[184:187], a[196:199], v[124:127]
  s_waitcnt lgkmcnt(12)
  ds_read_b64_tr_b16 v[152:153], v27 offset:49152
  v_mfma_f32_16x16x32_bf16 v[124:127], v[188:191], a[204:207], v[124:127]
  ds_read_b64_tr_b16 v[154:155], v27 offset:53248
  v_mfma_f32_16x16x32_bf16 v[120:123], v[184:187], a[192:195], v[120:123]
  buffer_load_dwordx2 v[32:33], v1, s[64:67], 0 offen offset:0
  v_mfma_f32_16x16x32_bf16 v[120:123], v[188:191], a[200:203], v[120:123]
  s_waitcnt vmcnt(28) lgkmcnt(12)
  ds_read_b64_tr_b16 v[156:157], v27 offset:57344
  ds_read_b64_tr_b16 v[158:159], v27 offset:61440
  v_mfma_f32_16x16x32_bf16 v[64:67], v[128:131], a[208:211], v[64:67]
  s_waitcnt vmcnt(26) lgkmcnt(12)
  ds_read_b64_tr_b16 v[160:161], v28 offset:49152
  v_mfma_f32_16x16x32_bf16 v[64:67], v[132:135], a[216:219], v[64:67]
  ds_read_b64_tr_b16 v[162:163], v28 offset:53248
  v_mfma_f32_16x16x32_bf16 v[68:71], v[128:131], a[212:215], v[68:71]
  s_waitcnt vmcnt(25)
  buffer_load_dwordx2 v[40:41], v54, s[68:71], 0 offen offset:0
  v_mfma_f32_16x16x32_bf16 v[68:71], v[132:135], a[220:223], v[68:71]
  s_waitcnt lgkmcnt(12)
  ds_read_b64_tr_b16 v[164:165], v28 offset:57344
  ds_read_b64_tr_b16 v[166:167], v28 offset:61440
  v_mfma_f32_16x16x32_bf16 v[76:79], v[136:139], a[212:215], v[76:79]
  s_waitcnt lgkmcnt(12)
  ds_read_b64_tr_b16 v[168:169], v29 offset:49152
  v_mfma_f32_16x16x32_bf16 v[76:79], v[140:143], a[220:223], v[76:79]
  ds_read_b64_tr_b16 v[170:171], v29 offset:53248
  v_mfma_f32_16x16x32_bf16 v[72:75], v[136:139], a[208:211], v[72:75]
  buffer_load_dwordx2 v[34:35], v1, s[64:67], 0 offen offset:32
  v_mfma_f32_16x16x32_bf16 v[72:75], v[140:143], a[216:219], v[72:75]
  s_waitcnt lgkmcnt(12)
  ds_read_b64_tr_b16 v[172:173], v29 offset:57344
  ds_read_b64_tr_b16 v[174:175], v29 offset:61440
  v_mfma_f32_16x16x32_bf16 v[80:83], v[144:147], a[208:211], v[80:83]
  s_waitcnt lgkmcnt(12)
  ds_read_b64_tr_b16 v[176:177], v30 offset:49152
  v_mfma_f32_16x16x32_bf16 v[80:83], v[148:151], a[216:219], v[80:83]
  ds_read_b64_tr_b16 v[178:179], v30 offset:53248
  v_mfma_f32_16x16x32_bf16 v[84:87], v[144:147], a[212:215], v[84:87]
  buffer_load_dwordx2 v[42:43], v54, s[68:71], 0 offen offset:32
  v_mfma_f32_16x16x32_bf16 v[84:87], v[148:151], a[220:223], v[84:87]
  s_waitcnt lgkmcnt(12)
  ds_read_b64_tr_b16 v[180:181], v30 offset:57344
  ds_read_b64_tr_b16 v[182:183], v30 offset:61440
  v_mfma_f32_16x16x32_bf16 v[92:95], v[152:155], a[212:215], v[92:95]
  s_waitcnt lgkmcnt(12)
  ds_read_b64_tr_b16 v[184:185], v31 offset:49152
  v_mfma_f32_16x16x32_bf16 v[92:95], v[156:159], a[220:223], v[92:95]
  ds_read_b64_tr_b16 v[186:187], v31 offset:53248
  v_mfma_f32_16x16x32_bf16 v[88:91], v[152:155], a[208:211], v[88:91]
  buffer_load_dwordx2 v[36:37], v1, s[64:67], 0 offen offset:128
  v_mfma_f32_16x16x32_bf16 v[88:91], v[156:159], a[216:219], v[88:91]
  s_waitcnt lgkmcnt(12)
  s_barrier
  ds_read_b64_tr_b16 v[188:189], v31 offset:57344
  ds_read_b64_tr_b16 v[190:191], v31 offset:61440
  v_mfma_f32_16x16x32_bf16 v[96:99], v[160:163], a[208:211], v[96:99]
  s_waitcnt lgkmcnt(12)
  ds_read_b64_tr_b16 v[128:129], v5 offset:32768
  v_mfma_f32_16x16x32_bf16 v[96:99], v[164:167], a[216:219], v[96:99]
  ds_read_b64_tr_b16 v[130:131], v5 offset:36864
  v_mfma_f32_16x16x32_bf16 v[100:103], v[160:163], a[212:215], v[100:103]
  buffer_load_dwordx2 v[44:45], v54, s[68:71], 0 offen offset:128
  v_mfma_f32_16x16x32_bf16 v[100:103], v[164:167], a[220:223], v[100:103]
  s_waitcnt lgkmcnt(12)
  ds_read_b64_tr_b16 v[132:133], v5 offset:40960
  ds_read_b64_tr_b16 v[134:135], v5 offset:45056
  v_mfma_f32_16x16x32_bf16 v[108:111], v[168:171], a[212:215], v[108:111]
  s_waitcnt lgkmcnt(12)
  ds_read_b64_tr_b16 v[136:137], v5 offset:49152
  v_mfma_f32_16x16x32_bf16 v[108:111], v[172:175], a[220:223], v[108:111]
  ds_read_b64_tr_b16 v[138:139], v5 offset:53248
  v_mfma_f32_16x16x32_bf16 v[104:107], v[168:171], a[208:211], v[104:107]
  buffer_load_dwordx2 v[38:39], v1, s[64:67], 0 offen offset:160
  v_mfma_f32_16x16x32_bf16 v[104:107], v[172:175], a[216:219], v[104:107]
  s_waitcnt lgkmcnt(12)
  ds_read_b64_tr_b16 v[140:141], v5 offset:57344
  ds_read_b64_tr_b16 v[142:143], v5 offset:61440
  v_mfma_f32_16x16x32_bf16 v[112:115], v[176:179], a[208:211], v[112:115]
  s_waitcnt lgkmcnt(12)
  ds_read_b64_tr_b16 v[144:145], v6 offset:32768
  v_mfma_f32_16x16x32_bf16 v[112:115], v[180:183], a[216:219], v[112:115]
  ds_read_b64_tr_b16 v[146:147], v6 offset:36864
  v_mfma_f32_16x16x32_bf16 v[116:119], v[176:179], a[212:215], v[116:119]
  buffer_load_dwordx2 v[46:47], v54, s[68:71], 0 offen offset:160
  v_mfma_f32_16x16x32_bf16 v[116:119], v[180:183], a[220:223], v[116:119]
  s_waitcnt lgkmcnt(12)
  ds_read_b64_tr_b16 v[148:149], v6 offset:40960
  ds_read_b64_tr_b16 v[150:151], v6 offset:45056
  v_mfma_f32_16x16x32_bf16 v[124:127], v[184:187], a[212:215], v[124:127]
  s_waitcnt lgkmcnt(12)
  ds_read_b64_tr_b16 v[152:153], v6 offset:49152
  v_mfma_f32_16x16x32_bf16 v[124:127], v[188:191], a[220:223], v[124:127]
  ds_read_b64_tr_b16 v[154:155], v6 offset:53248
  v_mfma_f32_16x16x32_bf16 v[120:123], v[184:187], a[208:211], v[120:123]
  v_mfma_f32_16x16x32_bf16 v[120:123], v[188:191], a[216:219], v[120:123]
  s_waitcnt vmcnt(31) lgkmcnt(12)
  ds_read_b64_tr_b16 v[156:157], v6 offset:57344
  ds_read_b64_tr_b16 v[158:159], v6 offset:61440
  v_mfma_f32_16x16x32_bf16 v[64:67], v[128:131], a[224:227], v[64:67]
  s_waitcnt vmcnt(29) lgkmcnt(12)
  ds_read_b64_tr_b16 v[160:161], v7 offset:32768
  v_mfma_f32_16x16x32_bf16 v[64:67], v[132:135], a[232:235], v[64:67]
  s_waitcnt vmcnt(27) lgkmcnt(11)
  ds_read_b64_tr_b16 v[162:163], v7 offset:36864
  v_mfma_f32_16x16x32_bf16 v[64:67], v[136:139], a[240:243], v[64:67]
  s_waitcnt vmcnt(25) lgkmcnt(10)
  v_mfma_f32_16x16x32_bf16 v[64:67], v[140:143], a[248:251], v[64:67]
  s_waitcnt vmcnt(24)
  ds_read_b64_tr_b16 v[164:165], v7 offset:40960
  ds_read_b64_tr_b16 v[166:167], v7 offset:45056
  v_mfma_f32_16x16x32_bf16 v[68:71], v[140:143], a[252:255], v[68:71]
  ds_read_b64_tr_b16 v[168:169], v7 offset:49152
  v_mfma_f32_16x16x32_bf16 v[68:71], v[136:139], a[244:247], v[68:71]
  ds_read_b64_tr_b16 v[170:171], v7 offset:53248
  v_mfma_f32_16x16x32_bf16 v[68:71], v[132:135], a[236:239], v[68:71]
  v_mfma_f32_16x16x32_bf16 v[68:71], v[128:131], a[228:231], v[68:71]
  s_waitcnt lgkmcnt(12)
  ds_read_b64_tr_b16 v[172:173], v7 offset:57344
  ds_read_b64_tr_b16 v[174:175], v7 offset:61440
  v_mfma_f32_16x16x32_bf16 v[72:75], v[144:147], a[224:227], v[72:75]
  s_waitcnt lgkmcnt(12)
  ds_read_b64_tr_b16 v[176:177], v8 offset:32768
  v_mfma_f32_16x16x32_bf16 v[72:75], v[148:151], a[232:235], v[72:75]
  s_waitcnt lgkmcnt(11)
  ds_read_b64_tr_b16 v[178:179], v8 offset:36864
  v_mfma_f32_16x16x32_bf16 v[72:75], v[152:155], a[240:243], v[72:75]
  s_waitcnt lgkmcnt(10)
  v_mfma_f32_16x16x32_bf16 v[72:75], v[156:159], a[248:251], v[72:75]
  ds_read_b64_tr_b16 v[180:181], v8 offset:40960
  ds_read_b64_tr_b16 v[182:183], v8 offset:45056
  v_mfma_f32_16x16x32_bf16 v[76:79], v[156:159], a[252:255], v[76:79]
  ds_read_b64_tr_b16 v[184:185], v8 offset:49152
  v_mfma_f32_16x16x32_bf16 v[76:79], v[152:155], a[244:247], v[76:79]
  ds_read_b64_tr_b16 v[186:187], v8 offset:53248
  v_mfma_f32_16x16x32_bf16 v[76:79], v[148:151], a[236:239], v[76:79]
  v_mfma_f32_16x16x32_bf16 v[76:79], v[144:147], a[228:231], v[76:79]
  s_waitcnt lgkmcnt(12)
  ds_read_b64_tr_b16 v[188:189], v8 offset:57344
  ds_read_b64_tr_b16 v[190:191], v8 offset:61440
  v_mfma_f32_16x16x32_bf16 v[80:83], v[160:163], a[224:227], v[80:83]
  s_waitcnt lgkmcnt(12)
  ds_read_b64_tr_b16 v[128:129], v9 offset:32768
  v_cvt_pk_bf16_f32 v48, v64, v65
  v_mfma_f32_16x16x32_bf16 v[80:83], v[164:167], a[232:235], v[80:83]
  s_waitcnt lgkmcnt(11)
  ds_read_b64_tr_b16 v[130:131], v9 offset:36864
  v_cvt_pk_bf16_f32 v49, v66, v67
  v_mfma_f32_16x16x32_bf16 v[80:83], v[168:171], a[240:243], v[80:83]
  s_waitcnt lgkmcnt(10)
  v_mfma_f32_16x16x32_bf16 v[80:83], v[172:175], a[248:251], v[80:83]
  ds_read_b64_tr_b16 v[132:133], v9 offset:40960
  ds_read_b64_tr_b16 v[134:135], v9 offset:45056
  v_mfma_f32_16x16x32_bf16 v[84:87], v[172:175], a[252:255], v[84:87]
  ds_read_b64_tr_b16 v[136:137], v9 offset:49152
  v_cvt_pk_bf16_f32 v50, v72, v73
  v_mfma_f32_16x16x32_bf16 v[84:87], v[168:171], a[244:247], v[84:87]
  ds_read_b64_tr_b16 v[138:139], v9 offset:53248
  v_cvt_pk_bf16_f32 v51, v74, v75
  v_mfma_f32_16x16x32_bf16 v[84:87], v[164:167], a[236:239], v[84:87]
  buffer_store_dwordx4 v[48:51], v52, s[16:19], s56 offen offset:0 sc1
  v_mfma_f32_16x16x32_bf16 v[84:87], v[160:163], a[228:231], v[84:87]
  s_waitcnt lgkmcnt(12)
  ds_read_b64_tr_b16 v[140:141], v9 offset:57344
  ds_read_b64_tr_b16 v[142:143], v9 offset:61440
  v_mfma_f32_16x16x32_bf16 v[88:91], v[176:179], a[224:227], v[88:91]
  s_waitcnt lgkmcnt(12)
  ds_read_b64_tr_b16 v[144:145], v10 offset:32768
  v_cvt_pk_bf16_f32 v60, v68, v69
  v_mfma_f32_16x16x32_bf16 v[88:91], v[180:183], a[232:235], v[88:91]
  s_waitcnt lgkmcnt(11)
  ds_read_b64_tr_b16 v[146:147], v10 offset:36864
  v_cvt_pk_bf16_f32 v61, v70, v71
  v_mfma_f32_16x16x32_bf16 v[88:91], v[184:187], a[240:243], v[88:91]
  s_waitcnt lgkmcnt(10)
  v_mfma_f32_16x16x32_bf16 v[88:91], v[188:191], a[248:251], v[88:91]
  ds_read_b64_tr_b16 v[148:149], v10 offset:40960
  ds_read_b64_tr_b16 v[150:151], v10 offset:45056
  v_mfma_f32_16x16x32_bf16 v[92:95], v[188:191], a[252:255], v[92:95]
  ds_read_b64_tr_b16 v[152:153], v10 offset:49152
  v_cvt_pk_bf16_f32 v62, v76, v77
  v_mfma_f32_16x16x32_bf16 v[92:95], v[184:187], a[244:247], v[92:95]
  ds_read_b64_tr_b16 v[154:155], v10 offset:53248
  v_cvt_pk_bf16_f32 v63, v78, v79
  v_mfma_f32_16x16x32_bf16 v[92:95], v[180:183], a[236:239], v[92:95]
  buffer_store_dwordx4 v[60:63], v52, s[16:19], s57 offen offset:0 sc1
  v_mfma_f32_16x16x32_bf16 v[92:95], v[176:179], a[228:231], v[92:95]
  s_waitcnt lgkmcnt(12)
  ds_read_b64_tr_b16 v[156:157], v10 offset:57344
  ds_read_b64_tr_b16 v[158:159], v10 offset:61440
  v_mfma_f32_16x16x32_bf16 v[96:99], v[128:131], a[224:227], v[96:99]
  s_waitcnt lgkmcnt(12)
  ds_read_b64_tr_b16 v[160:161], v11 offset:32768
  v_cvt_pk_bf16_f32 v48, v80, v81
  v_mfma_f32_16x16x32_bf16 v[96:99], v[132:135], a[232:235], v[96:99]
  s_waitcnt lgkmcnt(11)
  ds_read_b64_tr_b16 v[162:163], v11 offset:36864
  v_cvt_pk_bf16_f32 v49, v82, v83
  v_mfma_f32_16x16x32_bf16 v[96:99], v[136:139], a[240:243], v[96:99]
  s_waitcnt lgkmcnt(10)
  v_mfma_f32_16x16x32_bf16 v[96:99], v[140:143], a[248:251], v[96:99]
  ds_read_b64_tr_b16 v[164:165], v11 offset:40960
  ds_read_b64_tr_b16 v[166:167], v11 offset:45056
  v_mfma_f32_16x16x32_bf16 v[100:103], v[140:143], a[252:255], v[100:103]
  ds_read_b64_tr_b16 v[168:169], v11 offset:49152
  v_cvt_pk_bf16_f32 v50, v88, v89
  v_mfma_f32_16x16x32_bf16 v[100:103], v[136:139], a[244:247], v[100:103]
  ds_read_b64_tr_b16 v[170:171], v11 offset:53248
  v_cvt_pk_bf16_f32 v51, v90, v91
  v_mfma_f32_16x16x32_bf16 v[100:103], v[132:135], a[236:239], v[100:103]
  buffer_store_dwordx4 v[48:51], v52, s[16:19], s56 offen offset:128 sc1
  v_mfma_f32_16x16x32_bf16 v[100:103], v[128:131], a[228:231], v[100:103]
  s_waitcnt lgkmcnt(12)
  ds_read_b64_tr_b16 v[172:173], v11 offset:57344
  ds_read_b64_tr_b16 v[174:175], v11 offset:61440
  v_mfma_f32_16x16x32_bf16 v[104:107], v[144:147], a[224:227], v[104:107]
  s_waitcnt lgkmcnt(12)
  ds_read_b64_tr_b16 v[176:177], v12 offset:32768
  v_cvt_pk_bf16_f32 v60, v84, v85
  v_mfma_f32_16x16x32_bf16 v[104:107], v[148:151], a[232:235], v[104:107]
  s_waitcnt lgkmcnt(11)
  ds_read_b64_tr_b16 v[178:179], v12 offset:36864
  v_cvt_pk_bf16_f32 v61, v86, v87
  v_mfma_f32_16x16x32_bf16 v[104:107], v[152:155], a[240:243], v[104:107]
  s_waitcnt lgkmcnt(10)
  v_mfma_f32_16x16x32_bf16 v[104:107], v[156:159], a[248:251], v[104:107]
  ds_read_b64_tr_b16 v[180:181], v12 offset:40960
  ds_read_b64_tr_b16 v[182:183], v12 offset:45056
  v_mfma_f32_16x16x32_bf16 v[108:111], v[156:159], a[252:255], v[108:111]
  ds_read_b64_tr_b16 v[184:185], v12 offset:49152
  v_cvt_pk_bf16_f32 v62, v92, v93
  v_mfma_f32_16x16x32_bf16 v[108:111], v[152:155], a[244:247], v[108:111]
  ds_read_b64_tr_b16 v[186:187], v12 offset:53248
  v_cvt_pk_bf16_f32 v63, v94, v95
  v_mfma_f32_16x16x32_bf16 v[108:111], v[148:151], a[236:239], v[108:111]
  buffer_store_dwordx4 v[60:63], v52, s[16:19], s57 offen offset:128 sc1
  v_mfma_f32_16x16x32_bf16 v[108:111], v[144:147], a[228:231], v[108:111]
  s_waitcnt lgkmcnt(12)
  ds_read_b64_tr_b16 v[188:189], v12 offset:57344
  ds_read_b64_tr_b16 v[190:191], v12 offset:61440
  v_mfma_f32_16x16x32_bf16 v[112:115], v[160:163], a[224:227], v[112:115]
  s_waitcnt lgkmcnt(12)
  v_cvt_pk_bf16_f32 v48, v96, v97
  v_cvt_pk_bf16_f32 v49, v98, v99
  v_mfma_f32_16x16x32_bf16 v[112:115], v[164:167], a[232:235], v[112:115]
  s_waitcnt lgkmcnt(10)
  v_cvt_pk_bf16_f32 v50, v104, v105
  v_cvt_pk_bf16_f32 v51, v106, v107
  v_mfma_f32_16x16x32_bf16 v[112:115], v[168:171], a[240:243], v[112:115]
  s_waitcnt lgkmcnt(8)
  buffer_store_dwordx4 v[48:51], v52, s[16:19], s56 offen offset:1024 sc1
  v_mfma_f32_16x16x32_bf16 v[112:115], v[172:175], a[248:251], v[112:115]
  v_mfma_f32_16x16x32_bf16 v[116:119], v[172:175], a[252:255], v[116:119]
  v_cvt_pk_bf16_f32 v60, v100, v101
  v_cvt_pk_bf16_f32 v61, v102, v103
  v_mfma_f32_16x16x32_bf16 v[116:119], v[168:171], a[244:247], v[116:119]
  v_cvt_pk_bf16_f32 v62, v108, v109
  v_cvt_pk_bf16_f32 v63, v110, v111
  v_mfma_f32_16x16x32_bf16 v[116:119], v[164:167], a[236:239], v[116:119]
  buffer_store_dwordx4 v[60:63], v52, s[16:19], s57 offen offset:1024 sc1
  v_mfma_f32_16x16x32_bf16 v[116:119], v[160:163], a[228:231], v[116:119]
  s_waitcnt lgkmcnt(6)
  v_mfma_f32_16x16x32_bf16 v[120:123], v[176:179], a[224:227], v[120:123]
  s_waitcnt lgkmcnt(4)
  v_mfma_f32_16x16x32_bf16 v[120:123], v[180:183], a[232:235], v[120:123]
  s_waitcnt lgkmcnt(2)
  v_mfma_f32_16x16x32_bf16 v[120:123], v[184:187], a[240:243], v[120:123]
  s_waitcnt lgkmcnt(0)
  v_mfma_f32_16x16x32_bf16 v[120:123], v[188:191], a[248:251], v[120:123]
  v_mfma_f32_16x16x32_bf16 v[124:127], v[188:191], a[252:255], v[124:127]
  v_mfma_f32_16x16x32_bf16 v[124:127], v[184:187], a[244:247], v[124:127]
  v_mfma_f32_16x16x32_bf16 v[124:127], v[180:183], a[236:239], v[124:127]
  v_mfma_f32_16x16x32_bf16 v[124:127], v[176:179], a[228:231], v[124:127]
  s_nop 4
  v_cvt_pk_bf16_f32 v48, v112, v113
  v_cvt_pk_bf16_f32 v49, v114, v115
  v_cvt_pk_bf16_f32 v50, v120, v121
  v_cvt_pk_bf16_f32 v51, v122, v123
  buffer_store_dwordx4 v[48:51], v52, s[16:19], s56 offen offset:1152 sc1
  v_cvt_pk_bf16_f32 v60, v116, v117
  v_cvt_pk_bf16_f32 v61, v118, v119
  v_cvt_pk_bf16_f32 v62, v124, v125
  v_cvt_pk_bf16_f32 v63, v126, v127
  buffer_store_dwordx4 v[60:63], v52, s[16:19], s57 offen offset:1152 sc1
  s_lshr_b32 s32, s72, 5
  s_lshl_b32 s32, s32, 2
  s_bfe_u32 s33, s72, 0x20002
  s_add_u32 s32, s32, s33
  s_lshl_b32 s32, s32, 3
  s_bfe_u32 s33, s72, 0x10004
  s_add_u32 s32, s32, s33
  s_lshl_b32 s32, s32, 9
  s_add_u32 s32, s32, 2359296
  v_and_b32 v9, 0xc0, v0
  v_and_b32 v10, 0x30, v0
  v_lshlrev_b32 v10, 3, v10
  v_lshl_add_u32 v9, v9, 4, v10
  v_mov_b32 v22, v18
  v_mov_b32 v23, v19
  s_lshl_b32 s36, s72, 15
  s_lshl_b32 s39, s20, 11
  s_add_u32 s36, s36, s39
  s_add_u32 s36, s36, 20971520
  s_cmp_eq_u32 s31, 2
  s_cselect_b32 s39, 13, 12
  s_lshl_b32 s39, s20, s39
  s_min_u32 s39, s39, 16384
  s_add_u32 s39, s39, 132096
  v_add_u32 v5, s39, v0
  ds_read_b128 v[96:99], v5 offset:0
  ds_read_b128 v[100:103], v5 offset:1024
  ds_read_b128 v[104:107], v5 offset:2048
  ds_read_b128 v[108:111], v5 offset:3072
  ds_read_b128 v[112:115], v5 offset:4096
  ds_read_b128 v[116:119], v5 offset:5120
  ds_read_b128 v[120:123], v5 offset:6144
  ds_read_b128 v[124:127], v5 offset:7168
  v_mov_b32 v6, 131072
  v_lshrrev_b32 v7, 4, v4
  v_lshl_add_u32 v7, v7, 3, v6
  s_mov_b32 s37, 0x1111
  s_mov_b32 s34, 0
  s_waitcnt vmcnt(8)
  s_mov_b32 s41, 0
L_t_pc:
  s_lshr_b32 s40, s29, 16
  v_mov_b32 v176, 0
  v_bitop3_b32 v176, v176, v192, s40 bitop3:0xf6
  v_bitop3_b32 v176, v176, v193, s40 bitop3:0xf6
  v_bitop3_b32 v176, v176, v194, s40 bitop3:0xf6
  v_bitop3_b32 v176, v176, v195, s40 bitop3:0xf6
  v_bitop3_b32 v176, v176, v196, s40 bitop3:0xf6
  v_bitop3_b32 v176, v176, v197, s40 bitop3:0xf6
  v_bitop3_b32 v176, v176, v198, s40 bitop3:0xf6
  v_bitop3_b32 v176, v176, v199, s40 bitop3:0xf6
  v_bitop3_b32 v176, v176, v200, s40 bitop3:0xf6
  v_bitop3_b32 v176, v176, v201, s40 bitop3:0xf6
  v_bitop3_b32 v176, v176, v202, s40 bitop3:0xf6
  v_bitop3_b32 v176, v176, v203, s40 bitop3:0xf6
  v_bitop3_b32 v176, v176, v204, s40 bitop3:0xf6
  v_bitop3_b32 v176, v176, v205, s40 bitop3:0xf6
  v_bitop3_b32 v176, v176, v206, s40 bitop3:0xf6
  v_bitop3_b32 v176, v176, v207, s40 bitop3:0xf6
  v_bitop3_b32 v176, v176, v208, s40 bitop3:0xf6
  v_bitop3_b32 v176, v176, v209, s40 bitop3:0xf6
  v_bitop3_b32 v176, v176, v210, s40 bitop3:0xf6
  v_bitop3_b32 v176, v176, v211, s40 bitop3:0xf6
  v_bitop3_b32 v176, v176, v212, s40 bitop3:0xf6
  v_bitop3_b32 v176, v176, v213, s40 bitop3:0xf6
  v_bitop3_b32 v176, v176, v214, s40 bitop3:0xf6
  v_bitop3_b32 v176, v176, v215, s40 bitop3:0xf6
  v_bitop3_b32 v176, v176, v216, s40 bitop3:0xf6
  v_bitop3_b32 v176, v176, v217, s40 bitop3:0xf6
  v_bitop3_b32 v176, v176, v218, s40 bitop3:0xf6
  v_bitop3_b32 v176, v176, v219, s40 bitop3:0xf6
  v_bitop3_b32 v176, v176, v220, s40 bitop3:0xf6
  v_bitop3_b32 v176, v176, v221, s40 bitop3:0xf6
  v_bitop3_b32 v176, v176, v222, s40 bitop3:0xf6
  v_bitop3_b32 v176, v176, v223, s40 bitop3:0xf6
  v_bitop3_b32 v176, v176, v224, s40 bitop3:0xf6
  v_bitop3_b32 v176, v176, v225, s40 bitop3:0xf6
  v_bitop3_b32 v176, v176, v226, s40 bitop3:0xf6
  v_bitop3_b32 v176, v176, v227, s40 bitop3:0xf6
  v_bitop3_b32 v176, v176, v228, s40 bitop3:0xf6
  v_bitop3_b32 v176, v176, v229, s40 bitop3:0xf6
  v_bitop3_b32 v176, v176, v230, s40 bitop3:0xf6
  v_bitop3_b32 v176, v176, v231, s40 bitop3:0xf6
  v_bitop3_b32 v176, v176, v232, s40 bitop3:0xf6
  v_bitop3_b32 v176, v176, v233, s40 bitop3:0xf6
  v_bitop3_b32 v176, v176, v234, s40 bitop3:0xf6
  v_bitop3_b32 v176, v176, v235, s40 bitop3:0xf6
  v_bitop3_b32 v176, v176, v236, s40 bitop3:0xf6
  v_bitop3_b32 v176, v176, v237, s40 bitop3:0xf6
  v_bitop3_b32 v176, v176, v238, s40 bitop3:0xf6
  v_bitop3_b32 v176, v176, v239, s40 bitop3:0xf6
  v_bitop3_b32 v176, v176, v240, s40 bitop3:0xf6
  v_bitop3_b32 v176, v176, v241, s40 bitop3:0xf6
  v_bitop3_b32 v176, v176, v242, s40 bitop3:0xf6
  v_bitop3_b32 v176, v176, v243, s40 bitop3:0xf6
  v_bitop3_b32 v176, v176, v244, s40 bitop3:0xf6
  v_bitop3_b32 v176, v176, v245, s40 bitop3:0xf6
  v_bitop3_b32 v176, v176, v246, s40 bitop3:0xf6
  v_bitop3_b32 v176, v176, v247, s40 bitop3:0xf6
  v_bitop3_b32 v176, v176, v248, s40 bitop3:0xf6
  v_bitop3_b32 v176, v176, v249, s40 bitop3:0xf6
  v_bitop3_b32 v176, v176, v250, s40 bitop3:0xf6
  v_bitop3_b32 v176, v176, v251, s40 bitop3:0xf6
  v_bitop3_b32 v176, v176, v252, s40 bitop3:0xf6
  v_bitop3_b32 v176, v176, v253, s40 bitop3:0xf6
  v_bitop3_b32 v176, v176, v254, s40 bitop3:0xf6
  v_bitop3_b32 v176, v176, v255, s40 bitop3:0xf6
  v_and_b32 v176, 0xffff, v176
  v_cmp_ne_u32 vcc, 0, v176
  s_cmp_lg_u64 vcc, 0
  s_cbranch_scc1 L_t_pr
L_t_pb:
  v_and_b32 v192, 0xffff0000, v192
  v_and_b32 v193, 0xffff0000, v193
  v_and_b32 v194, 0xffff0000, v194
  v_and_b32 v195, 0xffff0000, v195
  v_and_b32 v196, 0xffff0000, v196
  v_and_b32 v197, 0xffff0000, v197
  v_and_b32 v198, 0xffff0000, v198
  v_and_b32 v199, 0xffff0000, v199
  v_and_b32 v200, 0xffff0000, v200
  v_and_b32 v201, 0xffff0000, v201
  v_and_b32 v202, 0xffff0000, v202
  v_and_b32 v203, 0xffff0000, v203
  v_and_b32 v204, 0xffff0000, v204
  v_and_b32 v205, 0xffff0000, v205
  v_and_b32 v206, 0xffff0000, v206
  v_and_b32 v207, 0xffff0000, v207
  v_and_b32 v208, 0xffff0000, v208
  v_and_b32 v209, 0xffff0000, v209
  v_and_b32 v210, 0xffff0000, v210
  v_and_b32 v211, 0xffff0000, v211
  v_and_b32 v212, 0xffff0000, v212
  v_and_b32 v213, 0xffff0000, v213
  v_and_b32 v214, 0xffff0000, v214
  v_and_b32 v215, 0xffff0000, v215
  v_and_b32 v216, 0xffff0000, v216
  v_and_b32 v217, 0xffff0000, v217
  v_and_b32 v218, 0xffff0000, v218
  v_and_b32 v219, 0xffff0000, v219
  v_and_b32 v220, 0xffff0000, v220
  v_and_b32 v221, 0xffff0000, v221
  v_and_b32 v222, 0xffff0000, v222
  v_and_b32 v223, 0xffff0000, v223
  v_and_b32 v224, 0xffff0000, v224
  v_and_b32 v225, 0xffff0000, v225
  v_and_b32 v226, 0xffff0000, v226
  v_and_b32 v227, 0xffff0000, v227
  v_and_b32 v228, 0xffff0000, v228
  v_and_b32 v229, 0xffff0000, v229
  v_and_b32 v230, 0xffff0000, v230
  v_and_b32 v231, 0xffff0000, v231
  v_and_b32 v232, 0xffff0000, v232
  v_and_b32 v233, 0xffff0000, v233
  v_and_b32 v234, 0xffff0000, v234
  v_and_b32 v235, 0xffff0000, v235
  v_and_b32 v236, 0xffff0000, v236
  v_and_b32 v237, 0xffff0000, v237
  v_and_b32 v238, 0xffff0000, v238
  v_and_b32 v239, 0xffff0000, v239
  v_and_b32 v240, 0xffff0000, v240
  v_and_b32 v241, 0xffff0000, v241
  v_and_b32 v242, 0xffff0000, v242
  v_and_b32 v243, 0xffff0000, v243
  v_and_b32 v244, 0xffff0000, v244
  v_and_b32 v245, 0xffff0000, v245
  v_and_b32 v246, 0xffff0000, v246
  v_and_b32 v247, 0xffff0000, v247
  v_and_b32 v248, 0xffff0000, v248
  v_and_b32 v249, 0xffff0000, v249
  v_and_b32 v250, 0xffff0000, v250
  v_and_b32 v251, 0xffff0000, v251
  v_and_b32 v252, 0xffff0000, v252
  v_and_b32 v253, 0xffff0000, v253
  v_and_b32 v254, 0xffff0000, v254
  v_and_b32 v255, 0xffff0000, v255
  v_lshlrev_b32 v128, 16, v32
  v_and_b32 v129, 0xffff0000, v32
  v_lshlrev_b32 v144, 16, v40
  v_and_b32 v145, 0xffff0000, v40
  v_lshlrev_b32 v130, 16, v33
  v_and_b32 v131, 0xffff0000, v33
  v_lshlrev_b32 v146, 16, v41
  v_and_b32 v147, 0xffff0000, v41
  v_lshlrev_b32 v132, 16, v34
  v_and_b32 v133, 0xffff0000, v34
  v_lshlrev_b32 v148, 16, v42
  v_and_b32 v149, 0xffff0000, v42
  v_lshlrev_b32 v134, 16, v35
  v_and_b32 v135, 0xffff0000, v35
  v_lshlrev_b32 v150, 16, v43
  v_and_b32 v151, 0xffff0000, v43
  v_lshlrev_b32 v136, 16, v36
  v_and_b32 v137, 0xffff0000, v36
  v_lshlrev_b32 v152, 16, v44
  v_and_b32 v153, 0xffff0000, v44
  v_lshlrev_b32 v138, 16, v37
  v_and_b32 v139, 0xffff0000, v37
  v_lshlrev_b32 v154, 16, v45
  v_and_b32 v155, 0xffff0000, v45
  v_lshlrev_b32 v140, 16, v38
  v_and_b32 v141, 0xffff0000, v38
  v_lshlrev_b32 v156, 16, v46
  v_and_b32 v157, 0xffff0000, v46
  v_lshlrev_b32 v142, 16, v39
  v_and_b32 v143, 0xffff0000, v39
  v_lshlrev_b32 v158, 16, v47
  v_and_b32 v159, 0xffff0000, v47
  v_pk_mul_f32 v[178:179], v[144:145], v[224:225]
  v_pk_fma_f32 v[178:179], v[146:147], v[226:227], v[178:179]
  v_pk_fma_f32 v[178:179], v[148:149], v[228:229], v[178:179]
  v_pk_fma_f32 v[178:179], v[150:151], v[230:231], v[178:179]
  v_pk_fma_f32 v[178:179], v[152:153], v[232:233], v[178:179]
  v_pk_fma_f32 v[178:179], v[154:155], v[234:235], v[178:179]
  v_pk_fma_f32 v[178:179], v[156:157], v[236:237], v[178:179]
  v_pk_fma_f32 v[178:179], v[158:159], v[238:239], v[178:179]
  v_pk_mul_f32 v[144:145], v[144:145], v[208:209]
  v_pk_mul_f32 v[146:147], v[146:147], v[210:211]
  v_pk_mul_f32 v[148:149], v[148:149], v[212:213]
  v_pk_mul_f32 v[150:151], v[150:151], v[214:215]
  v_pk_mul_f32 v[152:153], v[152:153], v[216:217]
  v_pk_mul_f32 v[154:155], v[154:155], v[218:219]
  v_pk_mul_f32 v[156:157], v[156:157], v[220:221]
  v_pk_mul_f32 v[158:159], v[158:159], v[222:223]
  v_pk_add_f32 v[176:177], v[144:145], v[146:147]
  v_pk_add_f32 v[176:177], v[176:177], v[148:149]
  v_pk_add_f32 v[176:177], v[176:177], v[150:151]
  v_pk_add_f32 v[176:177], v[176:177], v[152:153]
  v_pk_add_f32 v[176:177], v[176:177], v[154:155]
  v_pk_add_f32 v[176:177], v[176:177], v[156:157]
  v_pk_add_f32 v[176:177], v[176:177], v[158:159]
  v_add_f32 v10, v176, v177
  v_add_f32 v11, v178, v179
  s_nop 0
  s_nop 0
  v_add_f32_dpp v10, v10, v10 row_ror:8 row_mask:0xf bank_mask:0xf
  v_add_f32_dpp v11, v11, v11 row_ror:8 row_mask:0xf bank_mask:0xf
  s_nop 0
  v_add_f32_dpp v10, v10, v10 row_ror:4 row_mask:0xf bank_mask:0xf
  v_add_f32_dpp v11, v11, v11 row_ror:4 row_mask:0xf bank_mask:0xf
  s_nop 0
  v_add_f32_dpp v10, v10, v10 row_ror:2 row_mask:0xf bank_mask:0xf
  v_add_f32_dpp v11, v11, v11 row_ror:2 row_mask:0xf bank_mask:0xf
  v_mov_b32 v176, v10
  v_mov_b32 v177, v11
  s_nop 0
  v_permlane16_swap_b32 v176, v10
  v_permlane16_swap_b32 v177, v11
  v_add_f32 v10, v10, v176
  v_add_f32 v11, v11, v177
  v_mov_b32 v176, v10
  v_mov_b32 v177, v11
  s_nop 0
  v_permlane32_swap_b32 v176, v10
  v_permlane32_swap_b32 v177, v11
  v_add_f32 v10, v10, v176
  v_add_f32 v11, v11, v177
  v_sub_u32 v12, 2047, v3
  v_lshrrev_b32 v5, 8, v0
  v_bfe_u32 v8, v0, 5, 3
  v_lshlrev_b32 v5, 25, v5
  v_lshl_add_u32 v5, v8, 4, v5
  v_lshlrev_b32 v8, 7, v4
  s_waitcnt vmcnt(0)
  buffer_store_dwordx4 v[20:23], v17, s[16:19], s53 offen sc1
  buffer_load_dwordx2 v[180:181], v9, s[16:19], s32 offen offset:8 sc1
L_t_gl:
  s_add_u32 s34, s34, 1
  s_waitcnt vmcnt(0)
  v_xor_b32 v176, s29, v180
  v_bitop3_b32 v176, v176, v181, s29 bitop3:0xf9
  v_cmp_eq_u32 vcc, 0, v176
  s_cmp_ge_u32 s34, 400000
  s_cbranch_scc1 L_t_gd
  s_lshr_b32 s38, vcc_lo, 1
  s_and_b32 s38, s38, vcc_lo
  s_lshr_b32 s39, s38, 2
  s_and_b32 s38, s38, s39
  s_and_b32 s38, s38, s37
  s_cbranch_scc1 L_t_gr
  s_sleep 1
  buffer_load_dwordx2 v[180:181], v9, s[16:19], s32 offen offset:8 sc1
  s_branch L_t_gl
L_t_gr:
  s_add_u32 s39, s36, 0
  s_bitcmp1_b32 s38, 0
  s_cselect_b32 s39, s39, 0x7f000000
  buffer_load_dwordx4 v[64:67], v0, s[16:19], s39 offen offset:0 sc1
  buffer_load_dwordx4 v[68:71], v0, s[16:19], s39 offen offset:1024 sc1
  s_add_u32 s39, s36, 8192
  s_bitcmp1_b32 s38, 4
  s_cselect_b32 s39, s39, 0x7f000000
  buffer_load_dwordx4 v[72:75], v0, s[16:19], s39 offen offset:0 sc1
  buffer_load_dwordx4 v[76:79], v0, s[16:19], s39 offen offset:1024 sc1
  s_add_u32 s39, s36, 16384
  s_bitcmp1_b32 s38, 8
  s_cselect_b32 s39, s39, 0x7f000000
  buffer_load_dwordx4 v[80:83], v0, s[16:19], s39 offen offset:0 sc1
  buffer_load_dwordx4 v[84:87], v0, s[16:19], s39 offen offset:1024 sc1
  s_add_u32 s39, s36, 24576
  s_bitcmp1_b32 s38, 12
  s_cselect_b32 s39, s39, 0x7f000000
  buffer_load_dwordx4 v[88:91], v0, s[16:19], s39 offen offset:0 sc1
  buffer_load_dwordx4 v[92:95], v0, s[16:19], s39 offen offset:1024 sc1
  buffer_load_dwordx2 v[180:181], v9, s[16:19], s32 offen offset:8 sc1
  s_waitcnt vmcnt(7)
  s_bitcmp1_b32 s38, 0
  s_cbranch_scc0 L_t_i0
  s_bitset0_b32 s37, 0
  v_lshlrev_b32 v176, 16, v64
  v_and_b32 v177, 0xffff0000, v64
  v_pk_fma_f32 v[128:129], v[176:177], v[192:193], v[128:129]
  v_lshlrev_b32 v178, 16, v65
  v_and_b32 v179, 0xffff0000, v65
  v_pk_fma_f32 v[130:131], v[178:179], v[194:195], v[130:131]
  v_lshlrev_b32 v176, 16, v66
  v_and_b32 v177, 0xffff0000, v66
  v_pk_fma_f32 v[132:133], v[176:177], v[196:197], v[132:133]
  v_lshlrev_b32 v178, 16, v67
  v_and_b32 v179, 0xffff0000, v67
  v_pk_fma_f32 v[134:135], v[178:179], v[198:199], v[134:135]
  v_lshlrev_b32 v176, 16, v68
  v_and_b32 v177, 0xffff0000, v68
  v_pk_fma_f32 v[136:137], v[176:177], v[200:201], v[136:137]
  v_lshlrev_b32 v178, 16, v69
  v_and_b32 v179, 0xffff0000, v69
  v_pk_fma_f32 v[138:139], v[178:179], v[202:203], v[138:139]
  v_lshlrev_b32 v176, 16, v70
  v_and_b32 v177, 0xffff0000, v70
  v_pk_fma_f32 v[140:141], v[176:177], v[204:205], v[140:141]
  v_lshlrev_b32 v178, 16, v71
  v_and_b32 v179, 0xffff0000, v71
  v_pk_fma_f32 v[142:143], v[178:179], v[206:207], v[142:143]
L_t_i0:
  s_waitcnt vmcnt(5)
  s_bitcmp1_b32 s38, 4
  s_cbranch_scc0 L_t_i1
  s_bitset0_b32 s37, 4
  v_lshlrev_b32 v176, 16, v72
  v_and_b32 v177, 0xffff0000, v72
  v_pk_fma_f32 v[128:129], v[176:177], v[192:193], v[128:129]
  v_lshlrev_b32 v178, 16, v73
  v_and_b32 v179, 0xffff0000, v73
  v_pk_fma_f32 v[130:131], v[178:179], v[194:195], v[130:131]
  v_lshlrev_b32 v176, 16, v74
  v_and_b32 v177, 0xffff0000, v74
  v_pk_fma_f32 v[132:133], v[176:177], v[196:197], v[132:133]
  v_lshlrev_b32 v178, 16, v75
  v_and_b32 v179, 0xffff0000, v75
  v_pk_fma_f32 v[134:135], v[178:179], v[198:199], v[134:135]
  v_lshlrev_b32 v176, 16, v76
  v_and_b32 v177, 0xffff0000, v76
  v_pk_fma_f32 v[136:137], v[176:177], v[200:201], v[136:137]
  v_lshlrev_b32 v178, 16, v77
  v_and_b32 v179, 0xffff0000, v77
  v_pk_fma_f32 v[138:139], v[178:179], v[202:203], v[138:139]
  v_lshlrev_b32 v176, 16, v78
  v_and_b32 v177, 0xffff0000, v78
  v_pk_fma_f32 v[140:141], v[176:177], v[204:205], v[140:141]
  v_lshlrev_b32 v178, 16, v79
  v_and_b32 v179, 0xffff0000, v79
  v_pk_fma_f32 v[142:143], v[178:179], v[206:207], v[142:143]
L_t_i1:
  s_waitcnt vmcnt(3)
  s_bitcmp1_b32 s38, 8
  s_cbranch_scc0 L_t_i2
  s_bitset0_b32 s37, 8
  v_lshlrev_b32 v176, 16, v80
  v_and_b32 v177, 0xffff0000, v80
  v_pk_fma_f32 v[128:129], v[176:177], v[192:193], v[128:129]
  v_lshlrev_b32 v178, 16, v81
  v_and_b32 v179, 0xffff0000, v81
  v_pk_fma_f32 v[130:131], v[178:179], v[194:195], v[130:131]
  v_lshlrev_b32 v176, 16, v82
  v_and_b32 v177, 0xffff0000, v82
  v_pk_fma_f32 v[132:133], v[176:177], v[196:197], v[132:133]
  v_lshlrev_b32 v178, 16, v83
  v_and_b32 v179, 0xffff0000, v83
  v_pk_fma_f32 v[134:135], v[178:179], v[198:199], v[134:135]
  v_lshlrev_b32 v176, 16, v84
  v_and_b32 v177, 0xffff0000, v84
  v_pk_fma_f32 v[136:137], v[176:177], v[200:201], v[136:137]
  v_lshlrev_b32 v178, 16, v85
  v_and_b32 v179, 0xffff0000, v85
  v_pk_fma_f32 v[138:139], v[178:179], v[202:203], v[138:139]
  v_lshlrev_b32 v176, 16, v86
  v_and_b32 v177, 0xffff0000, v86
  v_pk_fma_f32 v[140:141], v[176:177], v[204:205], v[140:141]
  v_lshlrev_b32 v178, 16, v87
  v_and_b32 v179, 0xffff0000, v87
  v_pk_fma_f32 v[142:143], v[178:179], v[206:207], v[142:143]
L_t_i2:
  s_waitcnt vmcnt(1)
  s_bitcmp1_b32 s38, 12
  s_cbranch_scc0 L_t_i3
  s_bitset0_b32 s37, 12
  v_lshlrev_b32 v176, 16, v88
  v_and_b32 v177, 0xffff0000, v88
  v_pk_fma_f32 v[128:129], v[176:177], v[192:193], v[128:129]
  v_lshlrev_b32 v178, 16, v89
  v_and_b32 v179, 0xffff0000, v89
  v_pk_fma_f32 v[130:131], v[178:179], v[194:195], v[130:131]
  v_lshlrev_b32 v176, 16, v90
  v_and_b32 v177, 0xffff0000, v90
  v_pk_fma_f32 v[132:133], v[176:177], v[196:197], v[132:133]
  v_lshlrev_b32 v178, 16, v91
  v_and_b32 v179, 0xffff0000, v91
  v_pk_fma_f32 v[134:135], v[178:179], v[198:199], v[134:135]
  v_lshlrev_b32 v176, 16, v92
  v_and_b32 v177, 0xffff0000, v92
  v_pk_fma_f32 v[136:137], v[176:177], v[200:201], v[136:137]
  v_lshlrev_b32 v178, 16, v93
  v_and_b32 v179, 0xffff0000, v93
  v_pk_fma_f32 v[138:139], v[178:179], v[202:203], v[138:139]
  v_lshlrev_b32 v176, 16, v94
  v_and_b32 v177, 0xffff0000, v94
  v_pk_fma_f32 v[140:141], v[176:177], v[204:205], v[140:141]
  v_lshlrev_b32 v178, 16, v95
  v_and_b32 v179, 0xffff0000, v95
  v_pk_fma_f32 v[142:143], v[178:179], v[206:207], v[142:143]
L_t_i3:
  s_cmp_lg_u32 s37, 0
  s_cbranch_scc1 L_t_gl
L_t_gd:
  v_pk_add_f32 v[182:183], v[128:129], v[130:131]
  v_pk_mul_f32 v[184:185], v[128:129], v[128:129]
  v_pk_mul_f32 v[186:187], v[128:129], v[144:145]
  v_pk_fma_f32 v[184:185], v[130:131], v[130:131], v[184:185]
  v_pk_fma_f32 v[186:187], v[130:131], v[146:147], v[186:187]
  v_pk_add_f32 v[182:183], v[182:183], v[132:133]
  v_pk_fma_f32 v[184:185], v[132:133], v[132:133], v[184:185]
  v_pk_fma_f32 v[186:187], v[132:133], v[148:149], v[186:187]
  v_pk_add_f32 v[182:183], v[182:183], v[134:135]
  v_pk_fma_f32 v[184:185], v[134:135], v[134:135], v[184:185]
  v_pk_fma_f32 v[186:187], v[134:135], v[150:151], v[186:187]
  v_pk_add_f32 v[182:183], v[182:183], v[136:137]
  v_pk_fma_f32 v[184:185], v[136:137], v[136:137], v[184:185]
  v_pk_fma_f32 v[186:187], v[136:137], v[152:153], v[186:187]
  v_pk_add_f32 v[182:183], v[182:183], v[138:139]
  v_pk_fma_f32 v[184:185], v[138:139], v[138:139], v[184:185]
  v_pk_fma_f32 v[186:187], v[138:139], v[154:155], v[186:187]
  v_pk_add_f32 v[182:183], v[182:183], v[140:141]
  v_pk_fma_f32 v[184:185], v[140:141], v[140:141], v[184:185]
  v_pk_fma_f32 v[186:187], v[140:141], v[156:157], v[186:187]
  v_pk_add_f32 v[182:183], v[182:183], v[142:143]
  v_pk_fma_f32 v[184:185], v[142:143], v[142:143], v[184:185]
  v_pk_fma_f32 v[186:187], v[142:143], v[158:159], v[186:187]
  v_add_f32 v182, v182, v183
  v_add_f32 v184, v184, v185
  v_add_f32 v186, v186, v187
  v_add_f32_dpp v182, v182, v182 row_ror:8 row_mask:0xf bank_mask:0xf
  v_add_f32_dpp v184, v184, v184 row_ror:8 row_mask:0xf bank_mask:0xf
  v_add_f32_dpp v186, v186, v186 row_ror:8 row_mask:0xf bank_mask:0xf
  v_add_f32_dpp v182, v182, v182 row_ror:4 row_mask:0xf bank_mask:0xf
  v_add_f32_dpp v184, v184, v184 row_ror:4 row_mask:0xf bank_mask:0xf
  v_add_f32_dpp v186, v186, v186 row_ror:4 row_mask:0xf bank_mask:0xf
  v_add_f32_dpp v182, v182, v182 row_ror:2 row_mask:0xf bank_mask:0xf
  v_add_f32_dpp v184, v184, v184 row_ror:2 row_mask:0xf bank_mask:0xf
  v_add_f32_dpp v186, v186, v186 row_ror:2 row_mask:0xf bank_mask:0xf
  v_mov_b32 v183, v182
  v_mov_b32 v185, v184
  v_mov_b32 v187, v186
  v_permlane16_swap_b32 v183, v182
  v_permlane16_swap_b32 v185, v184
  v_permlane16_swap_b32 v187, v186
  v_add_f32 v182, v182, v183
  v_add_f32 v184, v184, v185
  v_add_f32 v186, v186, v187
  v_mov_b32 v183, v182
  v_mov_b32 v185, v184
  v_mov_b32 v187, v186
  v_permlane32_swap_b32 v183, v182
  v_permlane32_swap_b32 v185, v184
  v_permlane32_swap_b32 v187, v186
  v_add_f32 v182, v182, v183
  v_add_f32 v184, v184, v185
  v_add_f32 v186, v186, v187
  v_mul_f32 v182, 0xbb000000, v182
  v_mul_f32 v184, 0x3b000000, v184
  v_fma_f32 v184, -v182, v182, v184
  v_fmac_f32 v186, v182, v10
  v_max_f32 v184, 0, v184
  v_add_f32 v184, 0x3727c5ac, v184
  v_rsq_f32 v184, v184
  s_mov_b32 s39, 0x7ff
  v_fma_f32 v186, v186, v184, v11
  v_ashrrev_i32 v187, 31, v186
  v_or_b32 v187, 0x80000000, v187
  v_xor_b32 v186, v186, v187
  v_bfi_b32 v186, s39, v12, v186
  s_mov_b64 exec, 3
  ds_max_u32 v6, v186
  s_mov_b64 exec, -1
  v_pk_add_f32 v[144:145], v[128:129], v[182:183] op_sel_hi:[1,0]
  v_pk_add_f32 v[146:147], v[130:131], v[182:183] op_sel_hi:[1,0]
  v_pk_add_f32 v[148:149], v[132:133], v[182:183] op_sel_hi:[1,0]
  v_pk_add_f32 v[150:151], v[134:135], v[182:183] op_sel_hi:[1,0]
  v_pk_add_f32 v[152:153], v[136:137], v[182:183] op_sel_hi:[1,0]
  v_pk_add_f32 v[154:155], v[138:139], v[182:183] op_sel_hi:[1,0]
  v_pk_add_f32 v[156:157], v[140:141], v[182:183] op_sel_hi:[1,0]
  v_pk_add_f32 v[158:159], v[142:143], v[182:183] op_sel_hi:[1,0]
  s_waitcnt lgkmcnt(0)
  s_barrier
  ds_read_b32 v176, v6
  v_pk_mul_f32 v[144:145], v[144:145], v[208:209]
  v_pk_mul_f32 v[146:147], v[146:147], v[210:211]
  v_pk_mul_f32 v[148:149], v[148:149], v[212:213]
  v_pk_mul_f32 v[150:151], v[150:151], v[214:215]
  v_pk_mul_f32 v[152:153], v[152:153], v[216:217]
  v_pk_mul_f32 v[154:155], v[154:155], v[218:219]
  v_pk_mul_f32 v[156:157], v[156:157], v[220:221]
  v_pk_mul_f32 v[158:159], v[158:159], v[222:223]
  v_pk_fma_f32 v[144:145], v[144:145], v[184:185], v[224:225] op_sel_hi:[1,0,1]
  v_pk_fma_f32 v[146:147], v[146:147], v[184:185], v[226:227] op_sel_hi:[1,0,1]
  v_pk_fma_f32 v[148:149], v[148:149], v[184:185], v[228:229] op_sel_hi:[1,0,1]
  v_pk_fma_f32 v[150:151], v[150:151], v[184:185], v[230:231] op_sel_hi:[1,0,1]
  v_pk_fma_f32 v[152:153], v[152:153], v[184:185], v[232:233] op_sel_hi:[1,0,1]
  v_pk_fma_f32 v[154:155], v[154:155], v[184:185], v[234:235] op_sel_hi:[1,0,1]
  v_pk_fma_f32 v[156:157], v[156:157], v[184:185], v[236:237] op_sel_hi:[1,0,1]
  v_pk_fma_f32 v[158:159], v[158:159], v[184:185], v[238:239] op_sel_hi:[1,0,1]
  s_lshl_b32 s32, s72, 12
  s_add_u32 s32, s32, 29360128
  s_lshl_b32 s34, s72, 7
  s_add_u32 s34, s34, 2490368
  v_mov_b32 v178, v18
  v_mov_b32 v179, v19
  s_waitcnt lgkmcnt(0)
  v_cmp_eq_u32 s[36:37], v176, v186
  v_xor_b32 v177, s29, v176
  s_cmp_eq_u64 s[36:37], 0
  s_cbranch_scc1 L_t_nc
  s_mov_b64 exec, s[36:37]
  buffer_store_dwordx4 v[176:179], v5, s[16:19], s34 offen sc1
  buffer_store_dwordx4 v[144:147], v2, s[16:19], s32 offen offset:0 sc1
  buffer_store_dwordx4 v[148:151], v2, s[16:19], s32 offen offset:64 sc1
  buffer_store_dwordx4 v[152:155], v2, s[16:19], s32 offen offset:256 sc1
  buffer_store_dwordx4 v[156:159], v2, s[16:19], s32 offen offset:320 sc1
  s_mov_b64 exec, -1
L_t_nc:
  v_pk_fma_f32 v[128:129], v[144:145], v[240:241], v[128:129]
  v_pk_fma_f32 v[130:131], v[146:147], v[242:243], v[130:131]
  v_pk_fma_f32 v[132:133], v[148:149], v[244:245], v[132:133]
  v_pk_fma_f32 v[134:135], v[150:151], v[246:247], v[134:135]
  v_pk_fma_f32 v[136:137], v[152:153], v[248:249], v[136:137]
  v_pk_fma_f32 v[138:139], v[154:155], v[250:251], v[138:139]
  v_pk_fma_f32 v[140:141], v[156:157], v[252:253], v[140:141]
  v_pk_fma_f32 v[142:143], v[158:159], v[254:255], v[142:143]
  s_cmp_eq_u64 s[36:37], 0
  s_cbranch_scc1 L_t_nc2
  s_mov_b64 exec, s[36:37]
  buffer_store_dwordx4 v[128:131], v2, s[16:19], s32 offen offset:2048 sc1
  buffer_store_dwordx4 v[132:135], v2, s[16:19], s32 offen offset:2112 sc1
  buffer_store_dwordx4 v[136:139], v2, s[16:19], s32 offen offset:2304 sc1
  buffer_store_dwordx4 v[140:143], v2, s[16:19], s32 offen offset:2368 sc1
  s_mov_b64 exec, -1
L_t_nc2:
  v_cvt_pk_bf16_f32 v160, v128, v129
  v_cvt_pk_bf16_f32 v161, v130, v131
  v_cvt_pk_bf16_f32 v162, v132, v133
  v_cvt_pk_bf16_f32 v163, v134, v135
  v_cvt_pk_bf16_f32 v164, v136, v137
  v_cvt_pk_bf16_f32 v165, v138, v139
  v_cvt_pk_bf16_f32 v166, v140, v141
  v_cvt_pk_bf16_f32 v167, v142, v143
  s_andn2_b64 exec, -1, s[36:37]
  buffer_store_dwordx2 v[160:161], v1, s[8:11], 0 offen offset:0
  buffer_store_dwordx2 v[162:163], v1, s[8:11], 0 offen offset:32
  buffer_store_dwordx2 v[164:165], v1, s[8:11], 0 offen offset:128
  buffer_store_dwordx2 v[166:167], v1, s[8:11], 0 offen offset:160
  s_mov_b64 exec, -1
  v_lshlrev_b32 v64, 16, v96
  v_and_b32 v65, 0xffff0000, v96
  v_lshlrev_b32 v66, 16, v97
  v_and_b32 v67, 0xffff0000, v97
  v_lshlrev_b32 v68, 16, v98
  v_and_b32 v69, 0xffff0000, v98
  v_lshlrev_b32 v70, 16, v99
  v_and_b32 v71, 0xffff0000, v99
  v_lshlrev_b32 v72, 16, v100
  v_and_b32 v73, 0xffff0000, v100
  v_lshlrev_b32 v74, 16, v101
  v_and_b32 v75, 0xffff0000, v101
  v_lshlrev_b32 v76, 16, v102
  v_and_b32 v77, 0xffff0000, v102
  v_lshlrev_b32 v78, 16, v103
  v_and_b32 v79, 0xffff0000, v103
  v_lshlrev_b32 v80, 16, v104
  v_and_b32 v81, 0xffff0000, v104
  v_lshlrev_b32 v82, 16, v105
  v_and_b32 v83, 0xffff0000, v105
  v_lshlrev_b32 v84, 16, v106
  v_and_b32 v85, 0xffff0000, v106
  v_lshlrev_b32 v86, 16, v107
  v_and_b32 v87, 0xffff0000, v107
  v_lshlrev_b32 v88, 16, v108
  v_and_b32 v89, 0xffff0000, v108
  v_lshlrev_b32 v90, 16, v109
  v_and_b32 v91, 0xffff0000, v109
  v_lshlrev_b32 v92, 16, v110
  v_and_b32 v93, 0xffff0000, v110
  v_lshlrev_b32 v94, 16, v111
  v_and_b32 v95, 0xffff0000, v111
  s_cmp_lg_u32 s31, 2
  s_cbranch_scc1 L_t_up
  v_lshlrev_b32 v96, 16, v112
  v_and_b32 v97, 0xffff0000, v112
  v_lshlrev_b32 v98, 16, v113
  v_and_b32 v99, 0xffff0000, v113
  v_lshlrev_b32 v100, 16, v114
  v_and_b32 v101, 0xffff0000, v114
  v_lshlrev_b32 v102, 16, v115
  v_and_b32 v103, 0xffff0000, v115
  v_lshlrev_b32 v104, 16, v116
  v_and_b32 v105, 0xffff0000, v116
  v_lshlrev_b32 v106, 16, v117
  v_and_b32 v107, 0xffff0000, v117
  v_lshlrev_b32 v108, 16, v118
  v_and_b32 v109, 0xffff0000, v118
  v_lshlrev_b32 v110, 16, v119
  v_and_b32 v111, 0xffff0000, v119
  v_lshlrev_b32 v112, 16, v120
  v_and_b32 v113, 0xffff0000, v120
  v_lshlrev_b32 v114, 16, v121
  v_and_b32 v115, 0xffff0000, v121
  v_lshlrev_b32 v116, 16, v122
  v_and_b32 v117, 0xffff0000, v122
  v_lshlrev_b32 v118, 16, v123
  v_and_b32 v119, 0xffff0000, v123
  v_lshlrev_b32 v120, 16, v124
  v_and_b32 v121, 0xffff0000, v124
  v_lshlrev_b32 v122, 16, v125
  v_and_b32 v123, 0xffff0000, v125
  v_lshlrev_b32 v124, 16, v126
  v_and_b32 v125, 0xffff0000, v126
  v_lshlrev_b32 v126, 16, v127
  v_and_b32 v127, 0xffff0000, v127
L_t_up:
  v_and_b32 v9, 7, v4
  v_lshlrev_b32 v9, 2, v9
  v_add_u32 v10, v9, v6
  v_and_b32 v5, 127, v4
  v_lshlrev_b32 v5, 4, v5
  s_mov_b32 s32, 2490368
  s_mov_b32 s34, 0
L_t_p2:
  buffer_load_dwordx4 v[176:179], v8, s[16:19], s32 offen sc1
  s_add_u32 s34, s34, 1
  s_waitcnt vmcnt(0)
  v_bitop3_b32 v177, v176, v177, s29 bitop3:0x96
  v_bitop3_b32 v177, v177, v178, s29 bitop3:0xf6
  v_bitop3_b32 v177, v177, v179, s29 bitop3:0xf9
  v_cmp_ne_u32 vcc, 0, v177
  s_and_b64 exec, exec, vcc
  s_cbranch_scc0 L_t_p2_ok
  s_cmp_lt_u32 s34, 400000
  s_cbranch_scc1 L_t_p2
L_t_p2_ok:
  s_mov_b64 exec, -1
  v_max_u32_dpp v176, v176, v176 row_ror:8 row_mask:0xf bank_mask:0xf
  s_nop 1
  v_max_u32_dpp v176, v176, v176 row_ror:4 row_mask:0xf bank_mask:0xf
  s_nop 1
  v_max_u32_dpp v176, v176, v176 row_ror:2 row_mask:0xf bank_mask:0xf
  s_nop 1
  v_max_u32_dpp v176, v176, v176 row_ror:1 row_mask:0xf bank_mask:0xf
  s_mov_b32 exec_lo, 0x10001
  s_mov_b32 exec_hi, 0x10001
  ds_max_u32 v6, v176 offset:4
  s_mov_b64 exec, -1
  s_waitcnt lgkmcnt(0)
  s_barrier
  ds_read_b32 v176, v6 offset:4
  s_waitcnt lgkmcnt(0)
  v_readfirstlane_b32 s39, v176
  s_andn2_b32 s38, 0x7ff, s39
  s_lshr_b32 s40, s38, 3
  s_lshl_b32 s32, s40, 12
  s_add_u32 s32, s32, 29360128
  s_cmp_eq_u32 s31, 1
  s_cbranch_scc0 L_t_n1
  s_mov_b32 s34, 0
L_t_p3:
  buffer_load_dwordx4 v[176:179], v5, s[16:19], s32 offen sc1
  s_add_u32 s34, s34, 1
  s_waitcnt vmcnt(0)
  v_max3_u32 v184, v176, v177, v178
  v_max_u32 v184, v184, v179
  v_cmp_ne_u32 vcc, -1, v184
  s_andn2_b64 exec, exec, vcc
  s_cbranch_scc0 L_t_p3_ok
  s_cmp_lt_u32 s34, 400000
  s_cbranch_scc1 L_t_p3
L_t_p3_ok:
  s_mov_b64 exec, -1
  v_pk_mul_f32 v[168:169], v[64:65], v[176:177] op_sel_hi:[1,0]
  v_pk_mul_f32 v[170:171], v[66:67], v[176:177] op_sel_hi:[1,0]
  v_pk_mul_f32 v[172:173], v[68:69], v[176:177] op_sel_hi:[1,0]
  v_pk_mul_f32 v[174:175], v[70:71], v[176:177] op_sel_hi:[1,0]
  v_pk_fma_f32 v[168:169], v[72:73], v[176:177], v[168:169] op_sel:[0,1,0] op_sel_hi:[1,1,1]
  v_pk_fma_f32 v[170:171], v[74:75], v[176:177], v[170:171] op_sel:[0,1,0] op_sel_hi:[1,1,1]
  v_pk_fma_f32 v[172:173], v[76:77], v[176:177], v[172:173] op_sel:[0,1,0] op_sel_hi:[1,1,1]
  v_pk_fma_f32 v[174:175], v[78:79], v[176:177], v[174:175] op_sel:[0,1,0] op_sel_hi:[1,1,1]
  v_pk_fma_f32 v[168:169], v[80:81], v[178:179], v[168:169] op_sel:[0,0,0] op_sel_hi:[1,0,1]
  v_pk_fma_f32 v[170:171], v[82:83], v[178:179], v[170:171] op_sel:[0,0,0] op_sel_hi:[1,0,1]
  v_pk_fma_f32 v[172:173], v[84:85], v[178:179], v[172:173] op_sel:[0,0,0] op_sel_hi:[1,0,1]
  v_pk_fma_f32 v[174:175], v[86:87], v[178:179], v[174:175] op_sel:[0,0,0] op_sel_hi:[1,0,1]
  v_pk_fma_f32 v[168:169], v[88:89], v[178:179], v[168:169] op_sel:[0,1,0] op_sel_hi:[1,1,1]
  v_pk_fma_f32 v[170:171], v[90:91], v[178:179], v[170:171] op_sel:[0,1,0] op_sel_hi:[1,1,1]
  v_pk_fma_f32 v[172:173], v[92:93], v[178:179], v[172:173] op_sel:[0,1,0] op_sel_hi:[1,1,1]
  v_pk_fma_f32 v[174:175], v[94:95], v[178:179], v[174:175] op_sel:[0,1,0] op_sel_hi:[1,1,1]
  s_nop 0
  v_permlane32_swap_b32 v168, v172
  v_permlane32_swap_b32 v169, v173
  v_permlane32_swap_b32 v170, v174
  v_permlane32_swap_b32 v171, v175
  v_pk_add_f32 v[168:169], v[168:169], v[172:173]
  v_pk_add_f32 v[170:171], v[170:171], v[174:175]
  s_nop 1
  v_permlane16_swap_b32 v168, v170
  v_permlane16_swap_b32 v169, v171
  v_pk_add_f32 v[168:169], v[168:169], v[170:171]
  s_nop 0
  s_nop 0
  v_add_f32_dpp v168, v168, v168 row_ror:8 row_mask:0xf bank_mask:0xf
  v_add_f32_dpp v169, v169, v169 row_ror:8 row_mask:0xf bank_mask:0xf
  s_nop 0
  v_add_f32_dpp v168, v168, v168 row_ror:4 row_mask:0xf bank_mask:0xf
  v_add_f32_dpp v169, v169, v169 row_ror:4 row_mask:0xf bank_mask:0xf
  s_nop 0
  v_add_f32_dpp v168, v168, v168 row_ror:2 row_mask:0xf bank_mask:0xf
  v_add_f32_dpp v169, v169, v169 row_ror:2 row_mask:0xf bank_mask:0xf
  s_nop 0
  v_add_f32_dpp v168, v168, v168 row_ror:1 row_mask:0xf bank_mask:0xf
  v_add_f32_dpp v169, v169, v169 row_ror:1 row_mask:0xf bank_mask:0xf
  ds_write_b64 v7, v[168:169] offset:64
  s_waitcnt lgkmcnt(0)
  s_barrier
  s_cmp_lg_u32 s20, 0
  s_cbranch_scc1 L_t_e1
  ds_read2_b32 v[176:177], v10 offset0:16 offset1:32
  ds_read2_b32 v[178:179], v10 offset0:24 offset1:40
  s_lshl_b32 s32, s3, 7
  s_add_u32 s32, s32, 2523136
  s_lshr_b32 s33, s29, 16
  v_lshrrev_b32 v9, 2, v0
  s_waitcnt lgkmcnt(0)
  v_add_f32 v176, v176, v178
  v_add_f32 v177, v177, v179
  v_mul_f32 v178, 0xbfb8aa3b, v176
  v_exp_f32 v178, v178
  v_mul_f32 v176, v176, v177
  v_add_f32 v178, 1.0, v178
  v_rcp_f32 v178, v178
  s_mov_b32 exec_hi, 0
  v_mul_f32 v176, v176, v178
  v_cvt_pk_bf16_f32 v176, 0, v176
  v_or_b32 v176, s33, v176
  buffer_store_dword v176, v9, s[16:19], s32 offen sc1
  s_mov_b32 exec_hi, -1
  s_cmp_lg_u32 s2, 0
  s_cbranch_scc1 L_t_e1
  v_mov_b32 v177, s30
  s_mov_b32 s33, 2203648
  buffer_store_dword v177, v55, s[16:19], s33 offen
L_t_e1:
  s_cmp_eq_u32 s40, s72
  s_cbranch_scc1 L_t_l1a
  s_cmp_eq_u64 s[36:37], 0
  s_cbranch_scc1 L_t_l1a
  s_mov_b64 exec, s[36:37]
  buffer_store_dwordx2 v[160:161], v1, s[8:11], 0 offen offset:0
  buffer_store_dwordx2 v[162:163], v1, s[8:11], 0 offen offset:32
  buffer_store_dwordx2 v[164:165], v1, s[8:11], 0 offen offset:128
  buffer_store_dwordx2 v[166:167], v1, s[8:11], 0 offen offset:160
  s_mov_b64 exec, -1
L_t_l1a:
  s_branch L_attn_fin
L_t_n1:
  s_cmp_eq_u32 s40, s72
  s_cbranch_scc1 L_t_l2a
  s_cmp_eq_u64 s[36:37], 0
  s_cbranch_scc1 L_t_l2a
  s_mov_b64 exec, s[36:37]
  buffer_store_dwordx2 v[160:161], v1, s[8:11], 0 offen offset:0
  buffer_store_dwordx2 v[162:163], v1, s[8:11], 0 offen offset:32
  buffer_store_dwordx2 v[164:165], v1, s[8:11], 0 offen offset:128
  buffer_store_dwordx2 v[166:167], v1, s[8:11], 0 offen offset:160
  s_mov_b64 exec, -1
L_t_l2a:
  s_cmp_eq_u32 s31, 0
  s_cbranch_scc1 L_attn_fin
  s_cmp_eq_u32 s20, 3
  s_cbranch_scc1 L_attn_fin
  s_lshl_b32 s33, s3, 5
  s_add_u32 s32, s32, s33
  s_add_u32 s33, s33, 2201600
  buffer_load_dword v12, v9, s[16:19], s33 offen sc1
  s_not_b32 s33, s39
  s_ashr_i32 s33, s33, 31
  s_or_b32 s33, s33, 0x80000000
  s_xor_b32 s39, s39, s33
  v_mov_b32 v13, s39
  v_mul_f32 v13, 0xbfb8aa3b, v13
  v_exp_f32 v13, v13
  s_nop 0
  v_add_f32 v13, 1.0, v13
  v_rcp_f32 v13, v13
  s_mov_b32 s34, 0
L_t_p4:
  buffer_load_dword v11, v9, s[16:19], s32 offen offset:2048 sc1
  s_add_u32 s34, s34, 1
  s_waitcnt vmcnt(0)
  v_cmp_ne_u32 vcc, -1, v11
  s_andn2_b64 exec, exec, vcc
  s_cbranch_scc0 L_t_p4_ok
  s_cmp_lt_u32 s34, 400000
  s_cbranch_scc1 L_t_p4
L_t_p4_ok:
  s_mov_b64 exec, -1
  v_and_b32 v12, 0xffff0000, v12
  v_mul_f32 v12, v12, v13
  v_min_u32 v5, 171, v4
  v_lshlrev_b32 v5, 7, v5
  s_mov_b32 s32, 2523136
  s_lshr_b32 s33, s29, 16
  s_mov_b32 s34, 0
L_t_p5:
  buffer_load_dwordx4 v[176:179], v5, s[16:19], s32 offen offset:0 sc1
  buffer_load_dwordx4 v[180:183], v5, s[16:19], s32 offen offset:16 sc1
  s_add_u32 s34, s34, 1
  s_waitcnt vmcnt(0)
  v_xor_b32 v184, s33, v176
  v_bitop3_b32 v184, v184, v177, s33 bitop3:0xf6
  v_bitop3_b32 v184, v184, v178, s33 bitop3:0xf6
  v_bitop3_b32 v184, v184, v179, s33 bitop3:0xf6
  v_bitop3_b32 v184, v184, v180, s33 bitop3:0xf6
  v_bitop3_b32 v184, v184, v181, s33 bitop3:0xf6
  v_bitop3_b32 v184, v184, v182, s33 bitop3:0xf6
  v_bitop3_b32 v184, v184, v183, s33 bitop3:0xf6
  v_lshlrev_b32 v184, 16, v184
  v_cmp_ne_u32 vcc, 0, v184
  v_and_b32 v176, 0xffff0000, v176
  v_and_b32 v177, 0xffff0000, v177
  v_and_b32 v178, 0xffff0000, v178
  v_and_b32 v179, 0xffff0000, v179
  v_and_b32 v180, 0xffff0000, v180
  v_and_b32 v181, 0xffff0000, v181
  v_and_b32 v182, 0xffff0000, v182
  v_and_b32 v183, 0xffff0000, v183
  s_and_b64 exec, exec, vcc
  s_cbranch_scc0 L_t_p5_ok
  s_cmp_lt_u32 s34, 400000
  s_cbranch_scc1 L_t_p5
L_t_p5_ok:
  s_mov_b64 exec, -1
  v_pk_mul_f32 v[168:169], v[64:65], v[176:177] op_sel_hi:[1,0]
  v_pk_mul_f32 v[170:171], v[66:67], v[176:177] op_sel_hi:[1,0]
  v_pk_mul_f32 v[172:173], v[68:69], v[176:177] op_sel_hi:[1,0]
  v_pk_mul_f32 v[174:175], v[70:71], v[176:177] op_sel_hi:[1,0]
  v_pk_fma_f32 v[168:169], v[72:73], v[176:177], v[168:169] op_sel:[0,1,0] op_sel_hi:[1,1,1]
  v_pk_fma_f32 v[170:171], v[74:75], v[176:177], v[170:171] op_sel:[0,1,0] op_sel_hi:[1,1,1]
  v_pk_fma_f32 v[172:173], v[76:77], v[176:177], v[172:173] op_sel:[0,1,0] op_sel_hi:[1,1,1]
  v_pk_fma_f32 v[174:175], v[78:79], v[176:177], v[174:175] op_sel:[0,1,0] op_sel_hi:[1,1,1]
  v_pk_fma_f32 v[168:169], v[80:81], v[178:179], v[168:169] op_sel:[0,0,0] op_sel_hi:[1,0,1]
  v_pk_fma_f32 v[170:171], v[82:83], v[178:179], v[170:171] op_sel:[0,0,0] op_sel_hi:[1,0,1]
  v_pk_fma_f32 v[172:173], v[84:85], v[178:179], v[172:173] op_sel:[0,0,0] op_sel_hi:[1,0,1]
  v_pk_fma_f32 v[174:175], v[86:87], v[178:179], v[174:175] op_sel:[0,0,0] op_sel_hi:[1,0,1]
  v_pk_fma_f32 v[168:169], v[88:89], v[178:179], v[168:169] op_sel:[0,1,0] op_sel_hi:[1,1,1]
  v_pk_fma_f32 v[170:171], v[90:91], v[178:179], v[170:171] op_sel:[0,1,0] op_sel_hi:[1,1,1]
  v_pk_fma_f32 v[172:173], v[92:93], v[178:179], v[172:173] op_sel:[0,1,0] op_sel_hi:[1,1,1]
  v_pk_fma_f32 v[174:175], v[94:95], v[178:179], v[174:175] op_sel:[0,1,0] op_sel_hi:[1,1,1]
  v_pk_fma_f32 v[168:169], v[96:97], v[180:181], v[168:169] op_sel:[0,0,0] op_sel_hi:[1,0,1]
  v_pk_fma_f32 v[170:171], v[98:99], v[180:181], v[170:171] op_sel:[0,0,0] op_sel_hi:[1,0,1]
  v_pk_fma_f32 v[172:173], v[100:101], v[180:181], v[172:173] op_sel:[0,0,0] op_sel_hi:[1,0,1]
  v_pk_fma_f32 v[174:175], v[102:103], v[180:181], v[174:175] op_sel:[0,0,0] op_sel_hi:[1,0,1]
  v_pk_fma_f32 v[168:169], v[104:105], v[180:181], v[168:169] op_sel:[0,1,0] op_sel_hi:[1,1,1]
  v_pk_fma_f32 v[170:171], v[106:107], v[180:181], v[170:171] op_sel:[0,1,0] op_sel_hi:[1,1,1]
  v_pk_fma_f32 v[172:173], v[108:109], v[180:181], v[172:173] op_sel:[0,1,0] op_sel_hi:[1,1,1]
  v_pk_fma_f32 v[174:175], v[110:111], v[180:181], v[174:175] op_sel:[0,1,0] op_sel_hi:[1,1,1]
  v_pk_fma_f32 v[168:169], v[112:113], v[182:183], v[168:169] op_sel:[0,0,0] op_sel_hi:[1,0,1]
  v_pk_fma_f32 v[170:171], v[114:115], v[182:183], v[170:171] op_sel:[0,0,0] op_sel_hi:[1,0,1]
  v_pk_fma_f32 v[172:173], v[116:117], v[182:183], v[172:173] op_sel:[0,0,0] op_sel_hi:[1,0,1]
  v_pk_fma_f32 v[174:175], v[118:119], v[182:183], v[174:175] op_sel:[0,0,0] op_sel_hi:[1,0,1]
  v_pk_fma_f32 v[168:169], v[120:121], v[182:183], v[168:169] op_sel:[0,1,0] op_sel_hi:[1,1,1]
  v_pk_fma_f32 v[170:171], v[122:123], v[182:183], v[170:171] op_sel:[0,1,0] op_sel_hi:[1,1,1]
  v_pk_fma_f32 v[172:173], v[124:125], v[182:183], v[172:173] op_sel:[0,1,0] op_sel_hi:[1,1,1]
  v_pk_fma_f32 v[174:175], v[126:127], v[182:183], v[174:175] op_sel:[0,1,0] op_sel_hi:[1,1,1]
  s_nop 0
  v_permlane32_swap_b32 v168, v172
  v_permlane32_swap_b32 v169, v173
  v_permlane32_swap_b32 v170, v174
  v_permlane32_swap_b32 v171, v175
  v_pk_add_f32 v[168:169], v[168:169], v[172:173]
  v_pk_add_f32 v[170:171], v[170:171], v[174:175]
  s_nop 1
  v_permlane16_swap_b32 v168, v170
  v_permlane16_swap_b32 v169, v171
  v_pk_add_f32 v[168:169], v[168:169], v[170:171]
  s_nop 0
  s_nop 0
  v_add_f32_dpp v168, v168, v168 row_ror:8 row_mask:0xf bank_mask:0xf
  v_add_f32_dpp v169, v169, v169 row_ror:8 row_mask:0xf bank_mask:0xf
  s_nop 0
  v_add_f32_dpp v168, v168, v168 row_ror:4 row_mask:0xf bank_mask:0xf
  v_add_f32_dpp v169, v169, v169 row_ror:4 row_mask:0xf bank_mask:0xf
  s_nop 0
  v_add_f32_dpp v168, v168, v168 row_ror:2 row_mask:0xf bank_mask:0xf
  v_add_f32_dpp v169, v169, v169 row_ror:2 row_mask:0xf bank_mask:0xf
  s_nop 0
  v_add_f32_dpp v168, v168, v168 row_ror:1 row_mask:0xf bank_mask:0xf
  v_add_f32_dpp v169, v169, v169 row_ror:1 row_mask:0xf bank_mask:0xf
  ds_write_b64 v7, v[168:169] offset:64
  s_waitcnt lgkmcnt(0)
  s_barrier
  s_cmp_lg_u32 s20, 0
  s_cbranch_scc1 L_attn_fin
  ds_read2_b32 v[176:177], v10 offset0:16 offset1:24
  ds_read_b32 v178, v10 offset:128
  s_lshl_b32 s32, s38, 10
  s_lshl_b32 s33, s3, 4
  s_add_u32 s32, s32, s33
  v_lshrrev_b32 v9, 1, v9
  s_waitcnt lgkmcnt(0)
  v_add_f32 v176, v176, v177
  v_add_f32 v176, v176, v178
  v_fmac_f32 v11, v176, v12
  v_cvt_pk_bf16_f32 v11, v11, v11
  s_mov_b64 exec, 0xff
  buffer_store_short v11, v9, s[8:11], s32 offen
L_attn_fin:
L_attn_done:
  s_endpgm
L_g_w:
  s_mov_b32 s32, 0
  s_mov_b64 s[38:39], 0
L_g_p:
  s_add_u32 s32, s32, 1
  s_and_b32 s33, s32, 7
  s_cbranch_scc1 L_g_f
  buffer_store_dwordx4 v[20:23], v17, s[16:19], s53 offen sc1
  buffer_load_dwordx2 v[56:57], v53, s[16:19], s54 offen sc1
  s_branch L_g_c
L_g_f:
  buffer_load_dwordx2 v[56:57], v58, s[16:19], s45 offen sc1
L_g_c:
  s_waitcnt vmcnt(0)
  v_xor_b32 v59, s29, v56
  v_bitop3_b32 v59, v59, v57, s29 bitop3:0xf9
  v_cmp_eq_u32 vcc, 0, v59
  s_or_b64 s[38:39], s[38:39], vcc
  s_cmp_eq_u64 s[38:39], exec
  s_cbranch_scc1 L_g_ok
  s_cmp_lt_u32 s32, 400000
  s_cbranch_scc1 L_g_p
L_g_ok:
  s_cmp_eq_u32 s36, 0
  s_cbranch_scc1 L_g_b0
  s_branch L_g_b1
L_attn_codeend:
L_t_pr:
  s_mov_b32 s42, 2195456
  s_mov_b32 s43, 2199552
  buffer_load_dwordx4 v[192:195], v2, s[16:19], s42 offen offset:0 sc1
  buffer_load_dwordx4 v[196:199], v2, s[16:19], s42 offen offset:64 sc1
  buffer_load_dwordx4 v[200:203], v2, s[16:19], s42 offen offset:256 sc1
  buffer_load_dwordx4 v[204:207], v2, s[16:19], s42 offen offset:320 sc1
  buffer_load_dwordx4 v[224:227], v2, s[16:19], s42 offen offset:2048 sc1
  buffer_load_dwordx4 v[228:231], v2, s[16:19], s42 offen offset:2112 sc1
  buffer_load_dwordx4 v[232:235], v2, s[16:19], s42 offen offset:2304 sc1
  buffer_load_dwordx4 v[236:239], v2, s[16:19], s42 offen offset:2368 sc1
  buffer_load_dwordx4 v[208:211], v2, s[16:19], s43 offen offset:0 sc1
  buffer_load_dwordx4 v[212:215], v2, s[16:19], s43 offen offset:64 sc1
  buffer_load_dwordx4 v[216:219], v2, s[16:19], s43 offen offset:256 sc1
  buffer_load_dwordx4 v[220:223], v2, s[16:19], s43 offen offset:320 sc1
  buffer_load_dwordx4 v[240:243], v2, s[16:19], s43 offen offset:2048 sc1
  buffer_load_dwordx4 v[244:247], v2, s[16:19], s43 offen offset:2112 sc1
  buffer_load_dwordx4 v[248:251], v2, s[16:19], s43 offen offset:2304 sc1
  buffer_load_dwordx4 v[252:255], v2, s[16:19], s43 offen offset:2368 sc1
  s_add_u32 s41, s41, 1
  s_waitcnt vmcnt(0)
  s_cmp_lt_u32 s41, 400000
  s_cbranch_scc1 L_t_pc
  s_branch L_t_pb
L_attn_redo:
  s_mov_b32 s28, 1
  s_waitcnt vmcnt(0) lgkmcnt(0)
  s_barrier
  s_lshl_b32 s32, s20, 6
  v_lshrrev_b32 v0, 4, v0
  v_add_u32 v0, s32, v0
  s_branch L_attn_start
L_attn_fb:
  v_and_b32 v28, 0xf0, v0
  v_lshlrev_b32 v28, 4, v28
  v_lshrrev_b32 v29, 8, v0
  v_lshl_add_u32 v28, v29, 4, v28
  v_mov_b32 v24, 0xff800000
  v_mov_b32 v25, 0xff800000
  v_mov_b32 v26, 0xff800000
  v_mov_b32 v27, 0xff800000
  s_mov_b32 s34, 0
L_attn_fb_loop:
  buffer_load_dwordx4 a[0:3], v28, s[4:7], s34 offen offset:0
  buffer_load_dwordx4 a[4:7], v28, s[4:7], s34 offen offset:64
  buffer_load_dwordx4 a[8:11], v28, s[4:7], s34 offen offset:128
  buffer_load_dwordx4 a[12:15], v28, s[4:7], s34 offen offset:192
  s_waitcnt vmcnt(0)
  v_mfma_f32_16x16x32_bf16 v[64:67], a[0:3], v[192:195], 0
  v_mfma_f32_16x16x32_bf16 v[64:67], a[4:7], v[196:199], v[64:67]
  v_mfma_f32_16x16x32_bf16 v[64:67], a[8:11], v[200:203], v[64:67]
  v_mfma_f32_16x16x32_bf16 v[64:67], a[12:15], v[204:207], v[64:67]
  v_mfma_f32_16x16x32_bf16 v[68:71], a[0:3], v[208:211], 0
  v_mfma_f32_16x16x32_bf16 v[68:71], a[4:7], v[212:215], v[68:71]
  v_mfma_f32_16x16x32_bf16 v[68:71], a[8:11], v[216:219], v[68:71]
  v_mfma_f32_16x16x32_bf16 v[68:71], a[12:15], v[220:223], v[68:71]
  v_mfma_f32_16x16x32_bf16 v[72:75], a[0:3], v[224:227], 0
  v_mfma_f32_16x16x32_bf16 v[72:75], a[4:7], v[228:231], v[72:75]
  v_mfma_f32_16x16x32_bf16 v[72:75], a[8:11], v[232:235], v[72:75]
  v_mfma_f32_16x16x32_bf16 v[72:75], a[12:15], v[236:239], v[72:75]
  v_mfma_f32_16x16x32_bf16 v[76:79], a[0:3], v[240:243], 0
  v_mfma_f32_16x16x32_bf16 v[76:79], a[4:7], v[244:247], v[76:79]
  v_mfma_f32_16x16x32_bf16 v[76:79], a[8:11], v[248:251], v[76:79]
  v_mfma_f32_16x16x32_bf16 v[76:79], a[12:15], v[252:255], v[76:79]
  s_nop 7
  v_max3_f32 v24, v24, v64, v65
  v_max3_f32 v24, v24, v66, v67
  v_max3_f32 v25, v25, v68, v69
  v_max3_f32 v25, v25, v70, v71
  v_max3_f32 v26, v26, v72, v73
  v_max3_f32 v26, v26, v74, v75
  v_max3_f32 v27, v27, v76, v77
  v_max3_f32 v27, v27, v78, v79
  s_add_u32 s34, s34, 4096
  s_cmp_lt_u32 s34, 524288
  s_cbranch_scc1 L_attn_fb_loop
  s_branch L_attn_setm
.section .rodata,"a"
.p2align 6
.amdhsa_kernel adaLN_cond__gqa_block_cached__moe_arch_mod__prompt_kernel
.amdhsa_next_free_vgpr 512
.amdhsa_next_free_sgpr 74
.amdhsa_accum_offset 256
.amdhsa_group_segment_fixed_size 0
.amdhsa_kernarg_size 120
.amdhsa_user_sgpr_count 2
.amdhsa_user_sgpr_kernarg_segment_ptr 1
.amdhsa_system_sgpr_workgroup_id_x 1
.amdhsa_float_denorm_mode_32 3
.end_amdhsa_kernel
```
